```python
import torch

def _softmax(x, axis=-1):
    return torch.softmax(x, dim=axis)

def _gelu(x):
    return torch.nn.functional.gelu(x, approximate='tanh')

def _silu(x):
    return torch.nn.functional.silu(x)

def _sigmoid(x):
    return torch.sigmoid(x)

def _layernorm(x, axis=-1, eps=1e-05):
    m = x.mean(dim=axis, keepdim=True)
    v = x.var(dim=axis, keepdim=True, unbiased=False)
    return (x - m) / torch.sqrt(v + eps)

def _scatter_add(tgt, idx, src, axis=0):
    return tgt.clone().index_add_(axis, idx, src)

def _segment_sum(src, seg, n):
    out = torch.zeros((n,) + src.shape[1:], dtype=src.dtype)
    return out.index_add_(0, seg, src)

def _pad(x, pw):
    flat = tuple((v for pair in reversed(pw) for v in pair))
    return torch.nn.functional.pad(x, flat)
kernel_name = 'adaLN_cond__grouped_kv_mqa__geglu_ffn__prompt'

def setup_inputs():

    _w = lambda a: (lambda t: t.to(torch.bfloat16) if t.is_floating_point() else t)(torch.as_tensor(a))

    def _A_setup():
        B, S, D, H = (1, 2048, 1024, 32)
        Dh = D // H
        return {'x': _w((lambda *s: torch.randn(*s, dtype=torch.bfloat16) * 0.05)(B, S, D)), 'wq': _w((lambda *s: torch.randn(*s, dtype=torch.bfloat16) * 0.05)(D, H * Dh)), 'wk': _w((lambda *s: torch.randn(*s, dtype=torch.bfloat16) * 0.05)(D, Dh)), 'wv': _w((lambda *s: torch.randn(*s, dtype=torch.bfloat16) * 0.05)(D, Dh)), 'wo': _w((lambda *s: torch.randn(*s, dtype=torch.bfloat16) * 0.05)(H * Dh, D))}
    _A_in = _A_setup()

    def _B_setup():
        B, S, D, F = (1, 2048, 1024, 3584)
        return {'x': _w((lambda *s: torch.randn(*s, dtype=torch.bfloat16) * 0.05)(B, S, D)), 'w_gate': _w((lambda *s: torch.randn(*s, dtype=torch.bfloat16) * 0.05)(D, F)), 'w_up': _w((lambda *s: torch.randn(*s, dtype=torch.bfloat16) * 0.05)(D, F)), 'w_down': _w((lambda *s: torch.randn(*s, dtype=torch.bfloat16) * 0.05)(F, D))}
    _B_in = _B_setup()
    return {'A_x': _A_in['x'], 'A_wq': _A_in['wq'], 'A_wk': _A_in['wk'], 'A_wv': _A_in['wv'], 'A_wo': _A_in['wo'], 'B_x': _B_in['x'], 'B_w_gate': _B_in['w_gate'], 'B_w_up': _B_in['w_up'], 'B_w_down': _B_in['w_down'], 'c': _w((lambda *s: torch.randn(*s, dtype=torch.bfloat16) * 0.1)(1, 1024) * 8.0), 'w_mod': _w((lambda *s: torch.randn(*s, dtype=torch.bfloat16) * 0.1)(1024, 6 * 1024) * 1024 ** (-0.5) * 8.0)}

def reference(A_x, A_wq, A_wk, A_wv, A_wo, B_x, B_w_gate, B_w_up, B_w_down, c, w_mod):

    def _A_ref(x, wq, wk, wv, wo):
        B, S, D = x.shape
        H = 32
        Dh = D // H
        q = (lambda x, *d: x.permute(*d))((x @ wq).reshape(B, S, H, Dh), 0, 2, 1, 3)
        k = x @ wk
        v = x @ wv
        scores = torch.einsum('bhqd,bkd->bhqk', q, k) * Dh ** (-0.5)
        p = _softmax(scores, axis=-1)
        o = torch.einsum('bhqk,bkd->bhqd', p, v)
        return (lambda x, *d: x.permute(*d))(o, 0, 2, 1, 3).reshape(B, S, H * Dh) @ wo

    def _B_ref(x, w_gate, w_up, w_down):
        return _gelu(x @ w_gate) * (x @ w_up) @ w_down
    x = A_x
    mod = (_silu(c) @ w_mod).reshape(c.shape[0], 6, 1, -1)
    sa, ca, ga, sb, cb, gb = (mod[:, 0].clone(), mod[:, 1].clone(), mod[:, 2].clone(), mod[:, 3].clone(), mod[:, 4].clone(), mod[:, 5].clone())
    h = _layernorm(x, axis=-1) * (1 + ca) + sa
    x = x + ga * _A_ref(h, A_wq, A_wk, A_wv, A_wo)
    h = _layernorm(x, axis=-1) * (1 + cb) + sb
    x = x + gb * _B_ref(h, B_w_gate, B_w_up, B_w_down)
    return x
```

```asm
; @launch kernel=k1_kernel grid=(256,1,1) block=(512,1,1) lds=163840
; @launch kernel=k3_kernel grid=(256,1,1) block=(512,1,1) lds=163840
; @launch kernel=k4_kernel grid=(256,1,1) block=(256,1,1) lds=147456
; @launch kernel=k5_kernel grid=(256,1,1) block=(256,1,1) lds=155648
; @launch kernel=k6_kernel grid=(256,1,1) block=(256,1,1) lds=147456
.amdgcn_target "amdgcn-amd-amdhsa--gfx950"
.text
.globl k1_kernel
.p2align 8
.type k1_kernel,@function
k1_kernel:
    s_cmp_ge_u32 s2, 256
    s_cbranch_scc1 L_k1_kernel_exit
    s_load_dwordx2 s[4:5], s[0:1], 104
    s_load_dwordx2 s[8:9], s[0:1], 0
    s_load_dwordx2 s[12:13], s[0:1], 80
    s_load_dwordx2 s[16:17], s[0:1], 72
    s_load_dwordx2 s[24:25], s[0:1], 32
    s_load_dwordx2 s[28:29], s[0:1], 8
    s_load_dwordx2 s[48:49], s[0:1], 16
    s_load_dwordx2 s[52:53], s[0:1], 24
    s_load_dwordx2 s[56:57], s[0:1], 96
    v_lshrrev_b32 v1, 6, v0
    s_nop 0
    v_readfirstlane_b32 s22, v1
    s_mov_b32 s6, 268435456
    s_mov_b32 s7, 0x00020000
    s_mov_b32 s10, 4194304
    s_mov_b32 s11, 0x00020000
    s_mov_b32 s14, 12582912
    s_mov_b32 s15, 0x00020000
    s_mov_b32 s18, 2048
    s_mov_b32 s19, 0x00020000
    s_mov_b32 s26, 2097152
    s_mov_b32 s27, 0x00020000
    s_mov_b32 s30, 2097152
    s_mov_b32 s31, 0x00020000
    s_mov_b32 s50, 65536
    s_mov_b32 s51, 0x00020000
    s_mov_b32 s54, 65536
    s_mov_b32 s55, 0x00020000
    s_mov_b32 s58, 256
    s_mov_b32 s59, 0x00020000
    s_and_b32 s76, s2, 0x78
    s_add_u32 s76, s76, s22
    s_cmp_lg_u32 s76, 6
    s_waitcnt lgkmcnt(0)
    s_cbranch_scc1 L_ct_k1s_skip
    s_getpc_b64 s[76:77]
L_ct_k1s:
    v_and_b32 v30, 63, v0
    v_lshlrev_b32 v30, 7, v30
    s_mov_b32 s78, L_k1_kernel_exit-L_ct_k1s-4
    v_min_u32 v31, s78, v30
    global_load_dword v191, v31, s[76:77]
L_ct_k1s_skip:
    s_cmp_ge_u32 s2, 128
    s_cbranch_scc1 L_k1_main
    v_lshrrev_b32 v2, 3, v0
    v_and_b32 v3, 7, v0
    s_mov_b32 s35, 12288
    v_mul_lo_u32 v4, v2, s35
    v_lshl_add_u32 v4, v3, 4, v4
    v_lshlrev_b32 v5, 1, v2
    s_and_b32 s32, s2, 3
    s_lshr_b32 s33, s2, 2
    s_lshl_b32 s34, s32, 9
    s_mul_i32 s36, s32, 3145728
    s_lshl_b32 s37, s33, 7
    s_add_u32 s36, s36, s37
    buffer_load_ushort v8, v5, s[16:19], s34 offen offset:0
    buffer_load_ushort v9, v5, s[16:19], s34 offen offset:128
    buffer_load_ushort v10, v5, s[16:19], s34 offen offset:256
    buffer_load_ushort v11, v5, s[16:19], s34 offen offset:384
    s_add_u32 s37, s36, 0
    buffer_load_dwordx4 v[64:67], v4, s[12:15], s37 offen
    s_add_u32 s37, s36, 786432
    buffer_load_dwordx4 v[68:71], v4, s[12:15], s37 offen
    s_add_u32 s37, s36, 1572864
    buffer_load_dwordx4 v[72:75], v4, s[12:15], s37 offen
    s_add_u32 s37, s36, 2359296
    buffer_load_dwordx4 v[76:79], v4, s[12:15], s37 offen
    s_mov_b32 s41, 0
    s_and_b32 s38, s2, 1
    s_lshr_b32 s39, s2, 1
    s_lshl_b32 s34, s38, 10
    s_mul_i32 s36, s38, 6291456
    s_lshl_b32 s37, s39, 7
    s_add_u32 s36, s36, s37
    s_add_u32 s36, s36, 4096
    s_mov_b32 s45, s36
    s_mov_b32 s46, s34
    v_lshlrev_b32 v20, 5, v3
    s_lshl_b32 s37, s22, 8
    v_add_u32 v20, s37, v20
    v_lshlrev_b32 v21, 2, v0
    v_mov_b32 v22, 1
    v_mov_b32 v48, 0
    v_mov_b32 v49, 0
    v_mov_b32 v50, 0
    v_mov_b32 v51, 0
    v_mov_b32 v52, 0
    v_mov_b32 v53, 0
    v_mov_b32 v54, 0
    v_mov_b32 v55, 0
    s_waitcnt vmcnt(4)
    v_lshlrev_b32 v8, 16, v8
    v_mul_f32 v56, 0x3fb8aa3b, v8
    v_exp_f32 v56, -v56
    s_nop 0
    v_add_f32 v56, 1.0, v56
    v_rcp_f32 v56, v56
    s_nop 0
    v_mul_f32 v8, v8, v56
    v_cvt_pk_bf16_f32 v8, v8, v8
    v_lshlrev_b32 v8, 16, v8
    v_lshlrev_b32 v9, 16, v9
    v_mul_f32 v56, 0x3fb8aa3b, v9
    v_exp_f32 v56, -v56
    s_nop 0
    v_add_f32 v56, 1.0, v56
    v_rcp_f32 v56, v56
    s_nop 0
    v_mul_f32 v9, v9, v56
    v_cvt_pk_bf16_f32 v9, v9, v9
    v_lshlrev_b32 v9, 16, v9
    v_lshlrev_b32 v10, 16, v10
    v_mul_f32 v56, 0x3fb8aa3b, v10
    v_exp_f32 v56, -v56
    s_nop 0
    v_add_f32 v56, 1.0, v56
    v_rcp_f32 v56, v56
    s_nop 0
    v_mul_f32 v10, v10, v56
    v_cvt_pk_bf16_f32 v10, v10, v10
    v_lshlrev_b32 v10, 16, v10
    v_lshlrev_b32 v11, 16, v11
    v_mul_f32 v56, 0x3fb8aa3b, v11
    v_exp_f32 v56, -v56
    s_nop 0
    v_add_f32 v56, 1.0, v56
    v_rcp_f32 v56, v56
    s_nop 0
    v_mul_f32 v11, v11, v56
    v_cvt_pk_bf16_f32 v11, v11, v11
    v_lshlrev_b32 v11, 16, v11
    s_waitcnt vmcnt(3)
    v_lshlrev_b32 v56, 16, v64
    v_and_b32 v57, 0xffff0000, v64
    v_fmac_f32 v48, v56, v8
    v_fmac_f32 v49, v57, v8
    v_lshlrev_b32 v56, 16, v65
    v_and_b32 v57, 0xffff0000, v65
    v_fmac_f32 v50, v56, v8
    v_fmac_f32 v51, v57, v8
    v_lshlrev_b32 v56, 16, v66
    v_and_b32 v57, 0xffff0000, v66
    v_fmac_f32 v52, v56, v8
    v_fmac_f32 v53, v57, v8
    v_lshlrev_b32 v56, 16, v67
    v_and_b32 v57, 0xffff0000, v67
    v_fmac_f32 v54, v56, v8
    v_fmac_f32 v55, v57, v8
    s_waitcnt vmcnt(2)
    v_lshlrev_b32 v56, 16, v68
    v_and_b32 v57, 0xffff0000, v68
    v_fmac_f32 v48, v56, v9
    v_fmac_f32 v49, v57, v9
    v_lshlrev_b32 v56, 16, v69
    v_and_b32 v57, 0xffff0000, v69
    v_fmac_f32 v50, v56, v9
    v_fmac_f32 v51, v57, v9
    v_lshlrev_b32 v56, 16, v70
    v_and_b32 v57, 0xffff0000, v70
    v_fmac_f32 v52, v56, v9
    v_fmac_f32 v53, v57, v9
    v_lshlrev_b32 v56, 16, v71
    v_and_b32 v57, 0xffff0000, v71
    v_fmac_f32 v54, v56, v9
    v_fmac_f32 v55, v57, v9
    s_waitcnt vmcnt(1)
    v_lshlrev_b32 v56, 16, v72
    v_and_b32 v57, 0xffff0000, v72
    v_fmac_f32 v48, v56, v10
    v_fmac_f32 v49, v57, v10
    v_lshlrev_b32 v56, 16, v73
    v_and_b32 v57, 0xffff0000, v73
    v_fmac_f32 v50, v56, v10
    v_fmac_f32 v51, v57, v10
    v_lshlrev_b32 v56, 16, v74
    v_and_b32 v57, 0xffff0000, v74
    v_fmac_f32 v52, v56, v10
    v_fmac_f32 v53, v57, v10
    v_lshlrev_b32 v56, 16, v75
    v_and_b32 v57, 0xffff0000, v75
    v_fmac_f32 v54, v56, v10
    v_fmac_f32 v55, v57, v10
    s_waitcnt vmcnt(0)
    v_lshlrev_b32 v56, 16, v76
    v_and_b32 v57, 0xffff0000, v76
    v_fmac_f32 v48, v56, v11
    v_fmac_f32 v49, v57, v11
    v_lshlrev_b32 v56, 16, v77
    v_and_b32 v57, 0xffff0000, v77
    v_fmac_f32 v50, v56, v11
    v_fmac_f32 v51, v57, v11
    v_lshlrev_b32 v56, 16, v78
    v_and_b32 v57, 0xffff0000, v78
    v_fmac_f32 v52, v56, v11
    v_fmac_f32 v53, v57, v11
    v_lshlrev_b32 v56, 16, v79
    v_and_b32 v57, 0xffff0000, v79
    v_fmac_f32 v54, v56, v11
    v_fmac_f32 v55, v57, v11
    v_add_f32 v48, v48, v48 row_ror:8 row_mask:0xf bank_mask:0xf
    v_add_f32 v49, v49, v49 row_ror:8 row_mask:0xf bank_mask:0xf
    v_add_f32 v50, v50, v50 row_ror:8 row_mask:0xf bank_mask:0xf
    v_add_f32 v51, v51, v51 row_ror:8 row_mask:0xf bank_mask:0xf
    v_add_f32 v52, v52, v52 row_ror:8 row_mask:0xf bank_mask:0xf
    v_add_f32 v53, v53, v53 row_ror:8 row_mask:0xf bank_mask:0xf
    v_add_f32 v54, v54, v54 row_ror:8 row_mask:0xf bank_mask:0xf
    v_add_f32 v55, v55, v55 row_ror:8 row_mask:0xf bank_mask:0xf
    v_mov_b32 v56, v48
    v_mov_b32 v57, v49
    v_mov_b32 v58, v50
    v_mov_b32 v59, v51
    v_mov_b32 v60, v52
    v_mov_b32 v61, v53
    v_mov_b32 v62, v54
    v_mov_b32 v63, v55
    v_permlane16_swap_b32 v48, v56
    v_permlane16_swap_b32 v49, v57
    v_permlane16_swap_b32 v50, v58
    v_permlane16_swap_b32 v51, v59
    v_permlane16_swap_b32 v52, v60
    v_permlane16_swap_b32 v53, v61
    v_permlane16_swap_b32 v54, v62
    v_permlane16_swap_b32 v55, v63
    v_add_f32 v48, v48, v56
    v_add_f32 v49, v49, v57
    v_add_f32 v50, v50, v58
    v_add_f32 v51, v51, v59
    v_add_f32 v52, v52, v60
    v_add_f32 v53, v53, v61
    v_add_f32 v54, v54, v62
    v_add_f32 v55, v55, v63
    v_mov_b32 v56, v48
    v_mov_b32 v57, v49
    v_mov_b32 v58, v50
    v_mov_b32 v59, v51
    v_mov_b32 v60, v52
    v_mov_b32 v61, v53
    v_mov_b32 v62, v54
    v_mov_b32 v63, v55
    v_permlane32_swap_b32 v48, v56
    v_permlane32_swap_b32 v49, v57
    v_permlane32_swap_b32 v50, v58
    v_permlane32_swap_b32 v51, v59
    v_permlane32_swap_b32 v52, v60
    v_permlane32_swap_b32 v53, v61
    v_permlane32_swap_b32 v54, v62
    v_permlane32_swap_b32 v55, v63
    v_add_f32 v48, v48, v56
    v_add_f32 v49, v49, v57
    v_add_f32 v50, v50, v58
    v_add_f32 v51, v51, v59
    v_add_f32 v52, v52, v60
    v_add_f32 v53, v53, v61
    v_add_f32 v54, v54, v62
    v_add_f32 v55, v55, v63
    ds_write_b128 v20, v[48:51] offset:0
    ds_write_b128 v20, v[52:55] offset:16
    s_waitcnt lgkmcnt(0)
    s_barrier
    s_cmp_lg_u32 s22, 0
    s_cbranch_scc1 L_k1_g1
    ds_read_b32 v24, v21 offset:0
    ds_read_b32 v25, v21 offset:256
    ds_read_b32 v26, v21 offset:512
    ds_read_b32 v27, v21 offset:768
    ds_read_b32 v28, v21 offset:1024
    ds_read_b32 v29, v21 offset:1280
    ds_read_b32 v30, v21 offset:1536
    ds_read_b32 v31, v21 offset:1792
    s_waitcnt lgkmcnt(0)
    v_add_f32 v24, v24, v28
    v_add_f32 v25, v25, v29
    v_add_f32 v26, v26, v30
    v_add_f32 v27, v27, v31
    v_add_f32 v24, v24, v26
    v_add_f32 v25, v25, v27
    v_add_f32 v24, v24, v25
    s_lshl_b32 s34, s32, 13
    s_lshl_b32 s36, s33, 8
    s_add_u32 s34, s34, s36
    s_add_u32 s34, s34, 0
    buffer_store_dword v24, v21, s[4:7], s34 offen sc1
    v_mov_b32 v23, 0
    v_mov_b32 v28, 1
    s_waitcnt vmcnt(0)
    v_cmp_eq_u32 vcc, 0, v0
    s_nop 0
    s_and_saveexec_b64 s[36:37], vcc
    buffer_atomic_add v28, v23, s[56:59], 0 offen offset:124 sc0 sc1
    s_barrier
    s_waitcnt vmcnt(0)
    v_readfirstlane_b32 s34, v28
    s_nop 0
    s_cmp_lg_u32 s34, 127
    s_cbranch_scc1 L_k1_nag
    buffer_store_dword v22, v23, s[56:59], 0 offen offset:128 sc1
L_k1_nag:
    s_mov_b64 exec, s[36:37]
    s_branch L_k1_g2
L_k1_g1:
    s_barrier
L_k1_g2:
L_k1_nokv2:
    buffer_load_ushort v12, v5, s[16:19], s46 offen offset:0
    buffer_load_ushort v13, v5, s[16:19], s46 offen offset:128
    buffer_load_ushort v14, v5, s[16:19], s46 offen offset:256
    buffer_load_ushort v15, v5, s[16:19], s46 offen offset:384
    buffer_load_ushort v16, v5, s[16:19], s46 offen offset:512
    buffer_load_ushort v17, v5, s[16:19], s46 offen offset:640
    buffer_load_ushort v18, v5, s[16:19], s46 offen offset:768
    buffer_load_ushort v19, v5, s[16:19], s46 offen offset:896
    s_add_u32 s47, s45, 0
    buffer_load_dwordx4 v[80:83], v4, s[12:15], s47 offen
    s_add_u32 s47, s45, 786432
    buffer_load_dwordx4 v[84:87], v4, s[12:15], s47 offen
    s_add_u32 s47, s45, 1572864
    buffer_load_dwordx4 v[88:91], v4, s[12:15], s47 offen
    s_add_u32 s47, s45, 2359296
    buffer_load_dwordx4 v[92:95], v4, s[12:15], s47 offen
    s_add_u32 s47, s45, 3145728
    buffer_load_dwordx4 v[96:99], v4, s[12:15], s47 offen
    s_add_u32 s47, s45, 3932160
    buffer_load_dwordx4 v[100:103], v4, s[12:15], s47 offen
    s_add_u32 s47, s45, 4718592
    buffer_load_dwordx4 v[104:107], v4, s[12:15], s47 offen
    s_add_u32 s47, s45, 5505024
    buffer_load_dwordx4 v[108:111], v4, s[12:15], s47 offen
    s_lshl_b32 s44, s2, 3
    s_add_u32 s44, s44, s22
    s_cmp_lg_u32 s44, 1022
    s_cbranch_scc1 L_ct_k1_skip
    s_getpc_b64 s[76:77]
L_ct_k1:
    v_and_b32 v30, 63, v0
    v_lshlrev_b32 v30, 7, v30
    s_mov_b32 s78, L_code_end-L_ct_k1-4
    v_min_u32 v31, s78, v30
    global_load_dword v127, v31, s[76:77]
    v_add_u32 v30, 8192, v30
    v_min_u32 v31, s78, v30
    global_load_dword v127, v31, s[76:77]
    v_add_u32 v30, 8192, v30
    v_min_u32 v31, s78, v30
    global_load_dword v127, v31, s[76:77]
    v_add_u32 v30, 8192, v30
    v_min_u32 v31, s78, v30
    global_load_dword v127, v31, s[76:77]
    v_add_u32 v30, 8192, v30
    v_min_u32 v31, s78, v30
    global_load_dword v127, v31, s[76:77]
    v_add_u32 v30, 8192, v30
    v_min_u32 v31, s78, v30
    global_load_dword v127, v31, s[76:77]
L_ct_k1_skip:
    v_mov_b32 v48, 0
    v_mov_b32 v49, 0
    v_mov_b32 v50, 0
    v_mov_b32 v51, 0
    v_mov_b32 v52, 0
    v_mov_b32 v53, 0
    v_mov_b32 v54, 0
    v_mov_b32 v55, 0
    s_waitcnt vmcnt(8)
    v_lshlrev_b32 v12, 16, v12
    v_mul_f32 v56, 0x3fb8aa3b, v12
    v_exp_f32 v56, -v56
    s_nop 0
    v_add_f32 v56, 1.0, v56
    v_rcp_f32 v56, v56
    s_nop 0
    v_mul_f32 v12, v12, v56
    v_cvt_pk_bf16_f32 v12, v12, v12
    v_lshlrev_b32 v12, 16, v12
    v_lshlrev_b32 v13, 16, v13
    v_mul_f32 v56, 0x3fb8aa3b, v13
    v_exp_f32 v56, -v56
    s_nop 0
    v_add_f32 v56, 1.0, v56
    v_rcp_f32 v56, v56
    s_nop 0
    v_mul_f32 v13, v13, v56
    v_cvt_pk_bf16_f32 v13, v13, v13
    v_lshlrev_b32 v13, 16, v13
    v_lshlrev_b32 v14, 16, v14
    v_mul_f32 v56, 0x3fb8aa3b, v14
    v_exp_f32 v56, -v56
    s_nop 0
    v_add_f32 v56, 1.0, v56
    v_rcp_f32 v56, v56
    s_nop 0
    v_mul_f32 v14, v14, v56
    v_cvt_pk_bf16_f32 v14, v14, v14
    v_lshlrev_b32 v14, 16, v14
    v_lshlrev_b32 v15, 16, v15
    v_mul_f32 v56, 0x3fb8aa3b, v15
    v_exp_f32 v56, -v56
    s_nop 0
    v_add_f32 v56, 1.0, v56
    v_rcp_f32 v56, v56
    s_nop 0
    v_mul_f32 v15, v15, v56
    v_cvt_pk_bf16_f32 v15, v15, v15
    v_lshlrev_b32 v15, 16, v15
    v_lshlrev_b32 v16, 16, v16
    v_mul_f32 v56, 0x3fb8aa3b, v16
    v_exp_f32 v56, -v56
    s_nop 0
    v_add_f32 v56, 1.0, v56
    v_rcp_f32 v56, v56
    s_nop 0
    v_mul_f32 v16, v16, v56
    v_cvt_pk_bf16_f32 v16, v16, v16
    v_lshlrev_b32 v16, 16, v16
    v_lshlrev_b32 v17, 16, v17
    v_mul_f32 v56, 0x3fb8aa3b, v17
    v_exp_f32 v56, -v56
    s_nop 0
    v_add_f32 v56, 1.0, v56
    v_rcp_f32 v56, v56
    s_nop 0
    v_mul_f32 v17, v17, v56
    v_cvt_pk_bf16_f32 v17, v17, v17
    v_lshlrev_b32 v17, 16, v17
    v_lshlrev_b32 v18, 16, v18
    v_mul_f32 v56, 0x3fb8aa3b, v18
    v_exp_f32 v56, -v56
    s_nop 0
    v_add_f32 v56, 1.0, v56
    v_rcp_f32 v56, v56
    s_nop 0
    v_mul_f32 v18, v18, v56
    v_cvt_pk_bf16_f32 v18, v18, v18
    v_lshlrev_b32 v18, 16, v18
    v_lshlrev_b32 v19, 16, v19
    v_mul_f32 v56, 0x3fb8aa3b, v19
    v_exp_f32 v56, -v56
    s_nop 0
    v_add_f32 v56, 1.0, v56
    v_rcp_f32 v56, v56
    s_nop 0
    v_mul_f32 v19, v19, v56
    v_cvt_pk_bf16_f32 v19, v19, v19
    v_lshlrev_b32 v19, 16, v19
    s_waitcnt vmcnt(7)
    v_lshlrev_b32 v56, 16, v80
    v_and_b32 v57, 0xffff0000, v80
    v_fmac_f32 v48, v56, v12
    v_fmac_f32 v49, v57, v12
    v_lshlrev_b32 v56, 16, v81
    v_and_b32 v57, 0xffff0000, v81
    v_fmac_f32 v50, v56, v12
    v_fmac_f32 v51, v57, v12
    v_lshlrev_b32 v56, 16, v82
    v_and_b32 v57, 0xffff0000, v82
    v_fmac_f32 v52, v56, v12
    v_fmac_f32 v53, v57, v12
    v_lshlrev_b32 v56, 16, v83
    v_and_b32 v57, 0xffff0000, v83
    v_fmac_f32 v54, v56, v12
    v_fmac_f32 v55, v57, v12
    s_waitcnt vmcnt(6)
    v_lshlrev_b32 v56, 16, v84
    v_and_b32 v57, 0xffff0000, v84
    v_fmac_f32 v48, v56, v13
    v_fmac_f32 v49, v57, v13
    v_lshlrev_b32 v56, 16, v85
    v_and_b32 v57, 0xffff0000, v85
    v_fmac_f32 v50, v56, v13
    v_fmac_f32 v51, v57, v13
    v_lshlrev_b32 v56, 16, v86
    v_and_b32 v57, 0xffff0000, v86
    v_fmac_f32 v52, v56, v13
    v_fmac_f32 v53, v57, v13
    v_lshlrev_b32 v56, 16, v87
    v_and_b32 v57, 0xffff0000, v87
    v_fmac_f32 v54, v56, v13
    v_fmac_f32 v55, v57, v13
    s_waitcnt vmcnt(5)
    v_lshlrev_b32 v56, 16, v88
    v_and_b32 v57, 0xffff0000, v88
    v_fmac_f32 v48, v56, v14
    v_fmac_f32 v49, v57, v14
    v_lshlrev_b32 v56, 16, v89
    v_and_b32 v57, 0xffff0000, v89
    v_fmac_f32 v50, v56, v14
    v_fmac_f32 v51, v57, v14
    v_lshlrev_b32 v56, 16, v90
    v_and_b32 v57, 0xffff0000, v90
    v_fmac_f32 v52, v56, v14
    v_fmac_f32 v53, v57, v14
    v_lshlrev_b32 v56, 16, v91
    v_and_b32 v57, 0xffff0000, v91
    v_fmac_f32 v54, v56, v14
    v_fmac_f32 v55, v57, v14
    s_waitcnt vmcnt(4)
    v_lshlrev_b32 v56, 16, v92
    v_and_b32 v57, 0xffff0000, v92
    v_fmac_f32 v48, v56, v15
    v_fmac_f32 v49, v57, v15
    v_lshlrev_b32 v56, 16, v93
    v_and_b32 v57, 0xffff0000, v93
    v_fmac_f32 v50, v56, v15
    v_fmac_f32 v51, v57, v15
    v_lshlrev_b32 v56, 16, v94
    v_and_b32 v57, 0xffff0000, v94
    v_fmac_f32 v52, v56, v15
    v_fmac_f32 v53, v57, v15
    v_lshlrev_b32 v56, 16, v95
    v_and_b32 v57, 0xffff0000, v95
    v_fmac_f32 v54, v56, v15
    v_fmac_f32 v55, v57, v15
    s_waitcnt vmcnt(3)
    v_lshlrev_b32 v56, 16, v96
    v_and_b32 v57, 0xffff0000, v96
    v_fmac_f32 v48, v56, v16
    v_fmac_f32 v49, v57, v16
    v_lshlrev_b32 v56, 16, v97
    v_and_b32 v57, 0xffff0000, v97
    v_fmac_f32 v50, v56, v16
    v_fmac_f32 v51, v57, v16
    v_lshlrev_b32 v56, 16, v98
    v_and_b32 v57, 0xffff0000, v98
    v_fmac_f32 v52, v56, v16
    v_fmac_f32 v53, v57, v16
    v_lshlrev_b32 v56, 16, v99
    v_and_b32 v57, 0xffff0000, v99
    v_fmac_f32 v54, v56, v16
    v_fmac_f32 v55, v57, v16
    s_waitcnt vmcnt(2)
    v_lshlrev_b32 v56, 16, v100
    v_and_b32 v57, 0xffff0000, v100
    v_fmac_f32 v48, v56, v17
    v_fmac_f32 v49, v57, v17
    v_lshlrev_b32 v56, 16, v101
    v_and_b32 v57, 0xffff0000, v101
    v_fmac_f32 v50, v56, v17
    v_fmac_f32 v51, v57, v17
    v_lshlrev_b32 v56, 16, v102
    v_and_b32 v57, 0xffff0000, v102
    v_fmac_f32 v52, v56, v17
    v_fmac_f32 v53, v57, v17
    v_lshlrev_b32 v56, 16, v103
    v_and_b32 v57, 0xffff0000, v103
    v_fmac_f32 v54, v56, v17
    v_fmac_f32 v55, v57, v17
    s_waitcnt vmcnt(1)
    v_lshlrev_b32 v56, 16, v104
    v_and_b32 v57, 0xffff0000, v104
    v_fmac_f32 v48, v56, v18
    v_fmac_f32 v49, v57, v18
    v_lshlrev_b32 v56, 16, v105
    v_and_b32 v57, 0xffff0000, v105
    v_fmac_f32 v50, v56, v18
    v_fmac_f32 v51, v57, v18
    v_lshlrev_b32 v56, 16, v106
    v_and_b32 v57, 0xffff0000, v106
    v_fmac_f32 v52, v56, v18
    v_fmac_f32 v53, v57, v18
    v_lshlrev_b32 v56, 16, v107
    v_and_b32 v57, 0xffff0000, v107
    v_fmac_f32 v54, v56, v18
    v_fmac_f32 v55, v57, v18
    s_waitcnt vmcnt(0)
    v_lshlrev_b32 v56, 16, v108
    v_and_b32 v57, 0xffff0000, v108
    v_fmac_f32 v48, v56, v19
    v_fmac_f32 v49, v57, v19
    v_lshlrev_b32 v56, 16, v109
    v_and_b32 v57, 0xffff0000, v109
    v_fmac_f32 v50, v56, v19
    v_fmac_f32 v51, v57, v19
    v_lshlrev_b32 v56, 16, v110
    v_and_b32 v57, 0xffff0000, v110
    v_fmac_f32 v52, v56, v19
    v_fmac_f32 v53, v57, v19
    v_lshlrev_b32 v56, 16, v111
    v_and_b32 v57, 0xffff0000, v111
    v_fmac_f32 v54, v56, v19
    v_fmac_f32 v55, v57, v19
    v_add_f32 v48, v48, v48 row_ror:8 row_mask:0xf bank_mask:0xf
    v_add_f32 v49, v49, v49 row_ror:8 row_mask:0xf bank_mask:0xf
    v_add_f32 v50, v50, v50 row_ror:8 row_mask:0xf bank_mask:0xf
    v_add_f32 v51, v51, v51 row_ror:8 row_mask:0xf bank_mask:0xf
    v_add_f32 v52, v52, v52 row_ror:8 row_mask:0xf bank_mask:0xf
    v_add_f32 v53, v53, v53 row_ror:8 row_mask:0xf bank_mask:0xf
    v_add_f32 v54, v54, v54 row_ror:8 row_mask:0xf bank_mask:0xf
    v_add_f32 v55, v55, v55 row_ror:8 row_mask:0xf bank_mask:0xf
    v_mov_b32 v56, v48
    v_mov_b32 v57, v49
    v_mov_b32 v58, v50
    v_mov_b32 v59, v51
    v_mov_b32 v60, v52
    v_mov_b32 v61, v53
    v_mov_b32 v62, v54
    v_mov_b32 v63, v55
    v_permlane16_swap_b32 v48, v56
    v_permlane16_swap_b32 v49, v57
    v_permlane16_swap_b32 v50, v58
    v_permlane16_swap_b32 v51, v59
    v_permlane16_swap_b32 v52, v60
    v_permlane16_swap_b32 v53, v61
    v_permlane16_swap_b32 v54, v62
    v_permlane16_swap_b32 v55, v63
    v_add_f32 v48, v48, v56
    v_add_f32 v49, v49, v57
    v_add_f32 v50, v50, v58
    v_add_f32 v51, v51, v59
    v_add_f32 v52, v52, v60
    v_add_f32 v53, v53, v61
    v_add_f32 v54, v54, v62
    v_add_f32 v55, v55, v63
    v_mov_b32 v56, v48
    v_mov_b32 v57, v49
    v_mov_b32 v58, v50
    v_mov_b32 v59, v51
    v_mov_b32 v60, v52
    v_mov_b32 v61, v53
    v_mov_b32 v62, v54
    v_mov_b32 v63, v55
    v_permlane32_swap_b32 v48, v56
    v_permlane32_swap_b32 v49, v57
    v_permlane32_swap_b32 v50, v58
    v_permlane32_swap_b32 v51, v59
    v_permlane32_swap_b32 v52, v60
    v_permlane32_swap_b32 v53, v61
    v_permlane32_swap_b32 v54, v62
    v_permlane32_swap_b32 v55, v63
    v_add_f32 v48, v48, v56
    v_add_f32 v49, v49, v57
    v_add_f32 v50, v50, v58
    v_add_f32 v51, v51, v59
    v_add_f32 v52, v52, v60
    v_add_f32 v53, v53, v61
    v_add_f32 v54, v54, v62
    v_add_f32 v55, v55, v63
    ds_write_b128 v20, v[48:51] offset:2048
    ds_write_b128 v20, v[52:55] offset:2064
    s_waitcnt lgkmcnt(0)
    s_barrier
    s_cmp_lg_u32 s22, 0
    s_cbranch_scc1 L_k1_kernel_end
    ds_read_b32 v24, v21 offset:2048
    ds_read_b32 v25, v21 offset:2304
    ds_read_b32 v26, v21 offset:2560
    ds_read_b32 v27, v21 offset:2816
    ds_read_b32 v28, v21 offset:3072
    ds_read_b32 v29, v21 offset:3328
    ds_read_b32 v30, v21 offset:3584
    ds_read_b32 v31, v21 offset:3840
    s_waitcnt lgkmcnt(0)
    v_add_f32 v24, v24, v28
    v_add_f32 v25, v25, v29
    v_add_f32 v26, v26, v30
    v_add_f32 v27, v27, v31
    v_add_f32 v24, v24, v26
    v_add_f32 v25, v25, v27
    v_add_f32 v24, v24, v25
    s_lshl_b32 s34, s38, 14
    s_lshl_b32 s36, s39, 8
    s_add_u32 s34, s34, s36
    s_add_u32 s34, s34, 65536
    buffer_store_dword v24, v21, s[4:7], s34 offen
    s_branch L_k1_kernel_end
L_k1_main:
    s_sub_u32 s3, s2, 128
    v_and_b32 v2, 63, v0
    v_lshlrev_b32 v3, 4, v2
    v_lshlrev_b32 v4, 4, v0
    s_lshl_b32 s33, s3, 4
    s_lshl_b32 s34, s22, 1
    s_add_u32 s33, s33, s34
    s_lshl_b32 s33, s33, 11
    buffer_load_dwordx4 v[16:19], v3, s[8:11], s33 offen offset:0
    buffer_load_dwordx4 v[20:23], v3, s[8:11], s33 offen offset:1024
    buffer_load_dwordx4 v[24:27], v3, s[8:11], s33 offen offset:2048
    buffer_load_dwordx4 v[28:31], v3, s[8:11], s33 offen offset:3072
    s_lshl_b32 s34, s22, 13
    s_add_u32 m0, s34, 0
    s_add_u32 s43, s34, 0
    buffer_load_dwordx4 v3, s[48:51], s43 offen offset:0 lds
    buffer_load_dwordx4 v3, s[48:51], s43 offen offset:1024 lds
    buffer_load_dwordx4 v3, s[48:51], s43 offen offset:2048 lds
    buffer_load_dwordx4 v3, s[48:51], s43 offen offset:3072 lds
    s_add_u32 m0, s34, 4096
    s_add_u32 s43, s34, 4096
    buffer_load_dwordx4 v3, s[48:51], s43 offen offset:0 lds
    buffer_load_dwordx4 v3, s[48:51], s43 offen offset:1024 lds
    buffer_load_dwordx4 v3, s[48:51], s43 offen offset:2048 lds
    buffer_load_dwordx4 v3, s[48:51], s43 offen offset:3072 lds
    s_add_u32 m0, s34, 65536
    s_add_u32 s43, s34, 0
    buffer_load_dwordx4 v3, s[52:55], s43 offen offset:0 lds
    buffer_load_dwordx4 v3, s[52:55], s43 offen offset:1024 lds
    buffer_load_dwordx4 v3, s[52:55], s43 offen offset:2048 lds
    buffer_load_dwordx4 v3, s[52:55], s43 offen offset:3072 lds
    s_add_u32 m0, s34, 69632
    s_add_u32 s43, s34, 4096
    buffer_load_dwordx4 v3, s[52:55], s43 offen offset:0 lds
    buffer_load_dwordx4 v3, s[52:55], s43 offen offset:1024 lds
    buffer_load_dwordx4 v3, s[52:55], s43 offen offset:2048 lds
    buffer_load_dwordx4 v3, s[52:55], s43 offen offset:3072 lds
    v_lshrrev_b32 v32, 4, v2
    v_lshlrev_b32 v32, 3, v32
    v_bfe_u32 v33, v2, 2, 2
    v_add_u32 v32, v32, v33
    v_lshlrev_b32 v32, 6, v32
    v_add_u32 v32, s34, v32
    v_and_b32 v33, 3, v2
    v_lshl_add_u32 v34, v33, 4, v32
    v_and_b32 v35, 1, v2
    v_lshl_add_u32 v35, v35, 4, v32
    v_bfe_u32 v33, v2, 1, 1
    v_lshl_add_u32 v35, v33, 3, v35
    v_add_u32 v35, 65536, v35
    v_mov_b32 v15, 0
    s_waitcnt vmcnt(16)
    v_lshlrev_b32 v128, 16, v16
    v_and_b32 v129, 0xffff0000, v16
    v_lshlrev_b32 v130, 16, v17
    v_and_b32 v131, 0xffff0000, v17
    v_lshlrev_b32 v132, 16, v18
    v_and_b32 v133, 0xffff0000, v18
    v_lshlrev_b32 v134, 16, v19
    v_and_b32 v135, 0xffff0000, v19
    v_lshlrev_b32 v136, 16, v20
    v_and_b32 v137, 0xffff0000, v20
    v_lshlrev_b32 v138, 16, v21
    v_and_b32 v139, 0xffff0000, v21
    v_lshlrev_b32 v140, 16, v22
    v_and_b32 v141, 0xffff0000, v22
    v_lshlrev_b32 v142, 16, v23
    v_and_b32 v143, 0xffff0000, v23
    v_lshlrev_b32 v144, 16, v24
    v_and_b32 v145, 0xffff0000, v24
    v_lshlrev_b32 v146, 16, v25
    v_and_b32 v147, 0xffff0000, v25
    v_lshlrev_b32 v148, 16, v26
    v_and_b32 v149, 0xffff0000, v26
    v_lshlrev_b32 v150, 16, v27
    v_and_b32 v151, 0xffff0000, v27
    v_lshlrev_b32 v152, 16, v28
    v_and_b32 v153, 0xffff0000, v28
    v_lshlrev_b32 v154, 16, v29
    v_and_b32 v155, 0xffff0000, v29
    v_lshlrev_b32 v156, 16, v30
    v_and_b32 v157, 0xffff0000, v30
    v_lshlrev_b32 v158, 16, v31
    v_and_b32 v159, 0xffff0000, v31
    v_pk_add_f32 v[8:9], v[128:129], v[130:131]
    v_pk_add_f32 v[8:9], v[8:9], v[132:133]
    v_pk_add_f32 v[8:9], v[8:9], v[134:135]
    v_pk_add_f32 v[8:9], v[8:9], v[136:137]
    v_pk_add_f32 v[8:9], v[8:9], v[138:139]
    v_pk_add_f32 v[8:9], v[8:9], v[140:141]
    v_pk_add_f32 v[8:9], v[8:9], v[142:143]
    v_add_f32 v8, v8, v9
    v_pk_add_f32 v[12:13], v[144:145], v[146:147]
    v_pk_add_f32 v[12:13], v[12:13], v[148:149]
    v_pk_add_f32 v[12:13], v[12:13], v[150:151]
    v_pk_add_f32 v[12:13], v[12:13], v[152:153]
    v_pk_add_f32 v[12:13], v[12:13], v[154:155]
    v_pk_add_f32 v[12:13], v[12:13], v[156:157]
    v_pk_add_f32 v[12:13], v[12:13], v[158:159]
    v_add_f32 v12, v12, v13
    v_add_f32 v8, v8, v8 row_ror:8 row_mask:0xf bank_mask:0xf
    s_nop 1
    v_add_f32 v8, v8, v8 row_ror:4 row_mask:0xf bank_mask:0xf
    s_nop 1
    v_add_f32 v8, v8, v8 row_ror:2 row_mask:0xf bank_mask:0xf
    s_nop 1
    v_add_f32 v8, v8, v8 row_ror:1 row_mask:0xf bank_mask:0xf
    v_mov_b32 v9, v8
    s_nop 1
    v_permlane16_swap_b32 v8, v9
    v_add_f32 v8, v8, v9
    v_mov_b32 v9, v8
    s_nop 1
    v_permlane32_swap_b32 v8, v9
    v_add_f32 v8, v8, v9
    v_add_f32 v12, v12, v12 row_ror:8 row_mask:0xf bank_mask:0xf
    s_nop 1
    v_add_f32 v12, v12, v12 row_ror:4 row_mask:0xf bank_mask:0xf
    s_nop 1
    v_add_f32 v12, v12, v12 row_ror:2 row_mask:0xf bank_mask:0xf
    s_nop 1
    v_add_f32 v12, v12, v12 row_ror:1 row_mask:0xf bank_mask:0xf
    v_mov_b32 v13, v12
    s_nop 1
    v_permlane16_swap_b32 v12, v13
    v_add_f32 v12, v12, v13
    v_mov_b32 v13, v12
    s_nop 1
    v_permlane32_swap_b32 v12, v13
    v_add_f32 v12, v12, v13
    v_mul_f32 v8, 0x3a800000, v8
    v_mov_b32 v36, 0
    v_mov_b32 v37, 0
    v_pk_add_f32 v[6:7], v[128:129], v[8:9] op_sel_hi:[1,0] neg_lo:[0,1] neg_hi:[0,1]
    v_pk_fma_f32 v[36:37], v[6:7], v[6:7], v[36:37]
    v_pk_add_f32 v[6:7], v[130:131], v[8:9] op_sel_hi:[1,0] neg_lo:[0,1] neg_hi:[0,1]
    v_pk_fma_f32 v[36:37], v[6:7], v[6:7], v[36:37]
    v_pk_add_f32 v[6:7], v[132:133], v[8:9] op_sel_hi:[1,0] neg_lo:[0,1] neg_hi:[0,1]
    v_pk_fma_f32 v[36:37], v[6:7], v[6:7], v[36:37]
    v_pk_add_f32 v[6:7], v[134:135], v[8:9] op_sel_hi:[1,0] neg_lo:[0,1] neg_hi:[0,1]
    v_pk_fma_f32 v[36:37], v[6:7], v[6:7], v[36:37]
    v_pk_add_f32 v[6:7], v[136:137], v[8:9] op_sel_hi:[1,0] neg_lo:[0,1] neg_hi:[0,1]
    v_pk_fma_f32 v[36:37], v[6:7], v[6:7], v[36:37]
    v_pk_add_f32 v[6:7], v[138:139], v[8:9] op_sel_hi:[1,0] neg_lo:[0,1] neg_hi:[0,1]
    v_pk_fma_f32 v[36:37], v[6:7], v[6:7], v[36:37]
    v_pk_add_f32 v[6:7], v[140:141], v[8:9] op_sel_hi:[1,0] neg_lo:[0,1] neg_hi:[0,1]
    v_pk_fma_f32 v[36:37], v[6:7], v[6:7], v[36:37]
    v_pk_add_f32 v[6:7], v[142:143], v[8:9] op_sel_hi:[1,0] neg_lo:[0,1] neg_hi:[0,1]
    v_pk_fma_f32 v[36:37], v[6:7], v[6:7], v[36:37]
    v_add_f32 v10, v36, v37
    v_mul_f32 v12, 0x3a800000, v12
    v_mov_b32 v38, 0
    v_mov_b32 v39, 0
    v_pk_add_f32 v[6:7], v[144:145], v[12:13] op_sel_hi:[1,0] neg_lo:[0,1] neg_hi:[0,1]
    v_pk_fma_f32 v[38:39], v[6:7], v[6:7], v[38:39]
    v_pk_add_f32 v[6:7], v[146:147], v[12:13] op_sel_hi:[1,0] neg_lo:[0,1] neg_hi:[0,1]
    v_pk_fma_f32 v[38:39], v[6:7], v[6:7], v[38:39]
    v_pk_add_f32 v[6:7], v[148:149], v[12:13] op_sel_hi:[1,0] neg_lo:[0,1] neg_hi:[0,1]
    v_pk_fma_f32 v[38:39], v[6:7], v[6:7], v[38:39]
    v_pk_add_f32 v[6:7], v[150:151], v[12:13] op_sel_hi:[1,0] neg_lo:[0,1] neg_hi:[0,1]
    v_pk_fma_f32 v[38:39], v[6:7], v[6:7], v[38:39]
    v_pk_add_f32 v[6:7], v[152:153], v[12:13] op_sel_hi:[1,0] neg_lo:[0,1] neg_hi:[0,1]
    v_pk_fma_f32 v[38:39], v[6:7], v[6:7], v[38:39]
    v_pk_add_f32 v[6:7], v[154:155], v[12:13] op_sel_hi:[1,0] neg_lo:[0,1] neg_hi:[0,1]
    v_pk_fma_f32 v[38:39], v[6:7], v[6:7], v[38:39]
    v_pk_add_f32 v[6:7], v[156:157], v[12:13] op_sel_hi:[1,0] neg_lo:[0,1] neg_hi:[0,1]
    v_pk_fma_f32 v[38:39], v[6:7], v[6:7], v[38:39]
    v_pk_add_f32 v[6:7], v[158:159], v[12:13] op_sel_hi:[1,0] neg_lo:[0,1] neg_hi:[0,1]
    v_pk_fma_f32 v[38:39], v[6:7], v[6:7], v[38:39]
    v_add_f32 v14, v38, v39
    v_add_f32 v10, v10, v10 row_ror:8 row_mask:0xf bank_mask:0xf
    s_nop 1
    v_add_f32 v10, v10, v10 row_ror:4 row_mask:0xf bank_mask:0xf
    s_nop 1
    v_add_f32 v10, v10, v10 row_ror:2 row_mask:0xf bank_mask:0xf
    s_nop 1
    v_add_f32 v10, v10, v10 row_ror:1 row_mask:0xf bank_mask:0xf
    v_mov_b32 v9, v10
    s_nop 1
    v_permlane16_swap_b32 v10, v9
    v_add_f32 v10, v10, v9
    v_mov_b32 v9, v10
    s_nop 1
    v_permlane32_swap_b32 v10, v9
    v_add_f32 v10, v10, v9
    v_add_f32 v14, v14, v14 row_ror:8 row_mask:0xf bank_mask:0xf
    s_nop 1
    v_add_f32 v14, v14, v14 row_ror:4 row_mask:0xf bank_mask:0xf
    s_nop 1
    v_add_f32 v14, v14, v14 row_ror:2 row_mask:0xf bank_mask:0xf
    s_nop 1
    v_add_f32 v14, v14, v14 row_ror:1 row_mask:0xf bank_mask:0xf
    v_mov_b32 v13, v14
    s_nop 1
    v_permlane16_swap_b32 v14, v13
    v_add_f32 v14, v14, v13
    v_mov_b32 v13, v14
    s_nop 1
    v_permlane32_swap_b32 v14, v13
    v_add_f32 v14, v14, v13
    s_lshl_b32 s64, s3, 3
    s_add_u32 s64, s64, s22
    v_and_b32 v160, 63, v0
    v_lshlrev_b32 v161, 4, v160
    v_lshrrev_b32 v162, 4, v160
    v_lshlrev_b32 v165, 2, v162
    v_and_b32 v163, 15, v160
    v_xor_b32 v163, v165, v163
    v_lshlrev_b32 v163, 4, v163
    v_bfe_u32 v164, v160, 1, 1
    v_lshlrev_b32 v164, 3, v164
    v_and_b32 v165, 1, v160
    v_lshl_or_b32 v164, v165, 4, v164
    v_bfe_u32 v165, v160, 4, 1
    v_lshl_or_b32 v164, v165, 5, v164
    v_bfe_u32 v165, v160, 2, 2
    v_lshl_or_b32 v164, v165, 6, v164
    v_lshl_or_b32 v164, v165, 8, v164
    v_bfe_u32 v165, v160, 5, 1
    v_lshl_or_b32 v164, v165, 11, v164
    v_lshl_add_u32 v166, v162, 11, v163
    s_cmp_lt_u32 s64, 512
    s_cselect_b64 s[68:69], s[28:29], s[24:25]
    s_mov_b32 s70, 2097152
    s_mov_b32 s71, 0x00020000
    s_mov_b32 s72, 4194304
    s_cselect_b32 s72, 2097152, s72
    s_and_b32 s64, s64, 511
    s_lshl_b32 s65, s22, 12
    s_add_u32 s65, s65, 131072
    s_lshr_b32 s66, s64, 3
    s_and_b32 s67, s64, 7
    s_lshl_b32 s73, s66, 15
    s_lshl_b32 s74, s67, 8
    s_add_u32 s73, s73, s74
    s_add_u32 m0, s65, 0
    s_add_u32 s74, s73, 0
    buffer_load_dwordx4 v166, s[68:71], s74 offen lds
    s_add_u32 m0, s65, 1024
    s_add_u32 s74, s73, 8192
    buffer_load_dwordx4 v166, s[68:71], s74 offen lds
    s_add_u32 m0, s65, 2048
    s_add_u32 s74, s73, 16384
    buffer_load_dwordx4 v166, s[68:71], s74 offen lds
    s_add_u32 m0, s65, 3072
    s_add_u32 s74, s73, 24576
    buffer_load_dwordx4 v166, s[68:71], s74 offen lds
    s_lshl_b32 s67, s67, 18
    s_lshl_b32 s66, s66, 10
    s_add_u32 s72, s72, s67
    s_add_u32 s72, s72, s66
    v_add_u32 v164, s65, v164
    v_mul_f32 v10, 0x3a800000, v10
    v_cvt_pk_bf16_f32 v10, v10, v10
    v_lshlrev_b32 v10, 16, v10
    v_add_f32 v10, 0x3727c5ac, v10
    v_cvt_pk_bf16_f32 v10, v10, v10
    v_lshlrev_b32 v10, 16, v10
    v_sqrt_f32 v10, v10
    s_nop 0
    v_cvt_pk_bf16_f32 v10, v10, v10
    v_lshlrev_b32 v10, 16, v10
    v_rcp_f32 v10, v10
    v_cvt_pk_bf16_f32 v8, v8, v8
    v_lshlrev_b32 v8, 16, v8
    v_mul_f32 v14, 0x3a800000, v14
    v_cvt_pk_bf16_f32 v14, v14, v14
    v_lshlrev_b32 v14, 16, v14
    v_add_f32 v14, 0x3727c5ac, v14
    v_cvt_pk_bf16_f32 v14, v14, v14
    v_lshlrev_b32 v14, 16, v14
    v_sqrt_f32 v14, v14
    s_nop 0
    v_cvt_pk_bf16_f32 v14, v14, v14
    v_lshlrev_b32 v14, 16, v14
    v_rcp_f32 v14, v14
    v_cvt_pk_bf16_f32 v12, v12, v12
    v_lshlrev_b32 v12, 16, v12
    v_pk_add_f32 v[128:129], v[128:129], v[8:9] op_sel_hi:[1,0] neg_lo:[0,1] neg_hi:[0,1]
    v_cvt_pk_bf16_f32 v6, v128, v129
    v_lshlrev_b32 v128, 16, v6
    v_and_b32 v129, 0xffff0000, v6
    v_pk_mul_f32 v[128:129], v[128:129], v[10:11] op_sel_hi:[1,0]
    v_cvt_pk_bf16_f32 v7, v128, v129
    v_lshlrev_b32 v128, 16, v7
    v_and_b32 v129, 0xffff0000, v7
    v_pk_add_f32 v[130:131], v[130:131], v[8:9] op_sel_hi:[1,0] neg_lo:[0,1] neg_hi:[0,1]
    v_cvt_pk_bf16_f32 v6, v130, v131
    v_lshlrev_b32 v130, 16, v6
    v_and_b32 v131, 0xffff0000, v6
    v_pk_mul_f32 v[130:131], v[130:131], v[10:11] op_sel_hi:[1,0]
    v_cvt_pk_bf16_f32 v7, v130, v131
    v_lshlrev_b32 v130, 16, v7
    v_and_b32 v131, 0xffff0000, v7
    v_pk_add_f32 v[132:133], v[132:133], v[8:9] op_sel_hi:[1,0] neg_lo:[0,1] neg_hi:[0,1]
    v_cvt_pk_bf16_f32 v6, v132, v133
    v_lshlrev_b32 v132, 16, v6
    v_and_b32 v133, 0xffff0000, v6
    v_pk_mul_f32 v[132:133], v[132:133], v[10:11] op_sel_hi:[1,0]
    v_cvt_pk_bf16_f32 v7, v132, v133
    v_lshlrev_b32 v132, 16, v7
    v_and_b32 v133, 0xffff0000, v7
    v_pk_add_f32 v[134:135], v[134:135], v[8:9] op_sel_hi:[1,0] neg_lo:[0,1] neg_hi:[0,1]
    v_cvt_pk_bf16_f32 v6, v134, v135
    v_lshlrev_b32 v134, 16, v6
    v_and_b32 v135, 0xffff0000, v6
    v_pk_mul_f32 v[134:135], v[134:135], v[10:11] op_sel_hi:[1,0]
    v_cvt_pk_bf16_f32 v7, v134, v135
    v_lshlrev_b32 v134, 16, v7
    v_and_b32 v135, 0xffff0000, v7
    v_pk_add_f32 v[136:137], v[136:137], v[8:9] op_sel_hi:[1,0] neg_lo:[0,1] neg_hi:[0,1]
    v_cvt_pk_bf16_f32 v6, v136, v137
    v_lshlrev_b32 v136, 16, v6
    v_and_b32 v137, 0xffff0000, v6
    v_pk_mul_f32 v[136:137], v[136:137], v[10:11] op_sel_hi:[1,0]
    v_cvt_pk_bf16_f32 v7, v136, v137
    v_lshlrev_b32 v136, 16, v7
    v_and_b32 v137, 0xffff0000, v7
    v_pk_add_f32 v[138:139], v[138:139], v[8:9] op_sel_hi:[1,0] neg_lo:[0,1] neg_hi:[0,1]
    v_cvt_pk_bf16_f32 v6, v138, v139
    v_lshlrev_b32 v138, 16, v6
    v_and_b32 v139, 0xffff0000, v6
    v_pk_mul_f32 v[138:139], v[138:139], v[10:11] op_sel_hi:[1,0]
    v_cvt_pk_bf16_f32 v7, v138, v139
    v_lshlrev_b32 v138, 16, v7
    v_and_b32 v139, 0xffff0000, v7
    v_pk_add_f32 v[140:141], v[140:141], v[8:9] op_sel_hi:[1,0] neg_lo:[0,1] neg_hi:[0,1]
    v_cvt_pk_bf16_f32 v6, v140, v141
    v_lshlrev_b32 v140, 16, v6
    v_and_b32 v141, 0xffff0000, v6
    v_pk_mul_f32 v[140:141], v[140:141], v[10:11] op_sel_hi:[1,0]
    v_cvt_pk_bf16_f32 v7, v140, v141
    v_lshlrev_b32 v140, 16, v7
    v_and_b32 v141, 0xffff0000, v7
    v_pk_add_f32 v[142:143], v[142:143], v[8:9] op_sel_hi:[1,0] neg_lo:[0,1] neg_hi:[0,1]
    v_cvt_pk_bf16_f32 v6, v142, v143
    v_lshlrev_b32 v142, 16, v6
    v_and_b32 v143, 0xffff0000, v6
    v_pk_mul_f32 v[142:143], v[142:143], v[10:11] op_sel_hi:[1,0]
    v_cvt_pk_bf16_f32 v7, v142, v143
    v_lshlrev_b32 v142, 16, v7
    v_and_b32 v143, 0xffff0000, v7
    v_pk_add_f32 v[144:145], v[144:145], v[12:13] op_sel_hi:[1,0] neg_lo:[0,1] neg_hi:[0,1]
    v_cvt_pk_bf16_f32 v6, v144, v145
    v_lshlrev_b32 v144, 16, v6
    v_and_b32 v145, 0xffff0000, v6
    v_pk_mul_f32 v[144:145], v[144:145], v[14:15] op_sel_hi:[1,0]
    v_cvt_pk_bf16_f32 v7, v144, v145
    v_lshlrev_b32 v144, 16, v7
    v_and_b32 v145, 0xffff0000, v7
    v_pk_add_f32 v[146:147], v[146:147], v[12:13] op_sel_hi:[1,0] neg_lo:[0,1] neg_hi:[0,1]
    v_cvt_pk_bf16_f32 v6, v146, v147
    v_lshlrev_b32 v146, 16, v6
    v_and_b32 v147, 0xffff0000, v6
    v_pk_mul_f32 v[146:147], v[146:147], v[14:15] op_sel_hi:[1,0]
    v_cvt_pk_bf16_f32 v7, v146, v147
    v_lshlrev_b32 v146, 16, v7
    v_and_b32 v147, 0xffff0000, v7
    v_pk_add_f32 v[148:149], v[148:149], v[12:13] op_sel_hi:[1,0] neg_lo:[0,1] neg_hi:[0,1]
    v_cvt_pk_bf16_f32 v6, v148, v149
    v_lshlrev_b32 v148, 16, v6
    v_and_b32 v149, 0xffff0000, v6
    v_pk_mul_f32 v[148:149], v[148:149], v[14:15] op_sel_hi:[1,0]
    v_cvt_pk_bf16_f32 v7, v148, v149
    v_lshlrev_b32 v148, 16, v7
    v_and_b32 v149, 0xffff0000, v7
    v_pk_add_f32 v[150:151], v[150:151], v[12:13] op_sel_hi:[1,0] neg_lo:[0,1] neg_hi:[0,1]
    v_cvt_pk_bf16_f32 v6, v150, v151
    v_lshlrev_b32 v150, 16, v6
    v_and_b32 v151, 0xffff0000, v6
    v_pk_mul_f32 v[150:151], v[150:151], v[14:15] op_sel_hi:[1,0]
    v_cvt_pk_bf16_f32 v7, v150, v151
    v_lshlrev_b32 v150, 16, v7
    v_and_b32 v151, 0xffff0000, v7
    v_pk_add_f32 v[152:153], v[152:153], v[12:13] op_sel_hi:[1,0] neg_lo:[0,1] neg_hi:[0,1]
    v_cvt_pk_bf16_f32 v6, v152, v153
    v_lshlrev_b32 v152, 16, v6
    v_and_b32 v153, 0xffff0000, v6
    v_pk_mul_f32 v[152:153], v[152:153], v[14:15] op_sel_hi:[1,0]
    v_cvt_pk_bf16_f32 v7, v152, v153
    v_lshlrev_b32 v152, 16, v7
    v_and_b32 v153, 0xffff0000, v7
    v_pk_add_f32 v[154:155], v[154:155], v[12:13] op_sel_hi:[1,0] neg_lo:[0,1] neg_hi:[0,1]
    v_cvt_pk_bf16_f32 v6, v154, v155
    v_lshlrev_b32 v154, 16, v6
    v_and_b32 v155, 0xffff0000, v6
    v_pk_mul_f32 v[154:155], v[154:155], v[14:15] op_sel_hi:[1,0]
    v_cvt_pk_bf16_f32 v7, v154, v155
    v_lshlrev_b32 v154, 16, v7
    v_and_b32 v155, 0xffff0000, v7
    v_pk_add_f32 v[156:157], v[156:157], v[12:13] op_sel_hi:[1,0] neg_lo:[0,1] neg_hi:[0,1]
    v_cvt_pk_bf16_f32 v6, v156, v157
    v_lshlrev_b32 v156, 16, v6
    v_and_b32 v157, 0xffff0000, v6
    v_pk_mul_f32 v[156:157], v[156:157], v[14:15] op_sel_hi:[1,0]
    v_cvt_pk_bf16_f32 v7, v156, v157
    v_lshlrev_b32 v156, 16, v7
    v_and_b32 v157, 0xffff0000, v7
    v_pk_add_f32 v[158:159], v[158:159], v[12:13] op_sel_hi:[1,0] neg_lo:[0,1] neg_hi:[0,1]
    v_cvt_pk_bf16_f32 v6, v158, v159
    v_lshlrev_b32 v158, 16, v6
    v_and_b32 v159, 0xffff0000, v6
    v_pk_mul_f32 v[158:159], v[158:159], v[14:15] op_sel_hi:[1,0]
    v_cvt_pk_bf16_f32 v7, v158, v159
    v_lshlrev_b32 v158, 16, v7
    v_and_b32 v159, 0xffff0000, v7
    s_waitcnt vmcnt(4)
    ds_read_b64_tr_b16 v[64:65], v34 offset:0
    ds_read_b64_tr_b16 v[66:67], v34 offset:256
    ds_read_b64_tr_b16 v[68:69], v34 offset:8
    ds_read_b64_tr_b16 v[70:71], v34 offset:264
    ds_read_b64_tr_b16 v[80:81], v34 offset:2048
    ds_read_b64_tr_b16 v[82:83], v34 offset:2304
    ds_read_b64_tr_b16 v[84:85], v34 offset:2056
    ds_read_b64_tr_b16 v[86:87], v34 offset:2312
    s_waitcnt lgkmcnt(4)
    ds_read_b64_tr_b16 v[96:97], v34 offset:4096
    ds_read_b64_tr_b16 v[98:99], v34 offset:4352
    ds_read_b64_tr_b16 v[100:101], v34 offset:4104
    ds_read_b64_tr_b16 v[102:103], v34 offset:4360
    ds_read_b64_tr_b16 v[112:113], v34 offset:6144
    ds_read_b64_tr_b16 v[114:115], v34 offset:6400
    ds_read_b64_tr_b16 v[116:117], v34 offset:6152
    ds_read_b64_tr_b16 v[118:119], v34 offset:6408
    s_waitcnt lgkmcnt(4)
    ds_read_b64_tr_b16 v[72:73], v35 offset:0
    ds_read_b64_tr_b16 v[74:75], v35 offset:256
    ds_read_b64_tr_b16 v[76:77], v35 offset:32
    ds_read_b64_tr_b16 v[78:79], v35 offset:288
    ds_read_b64_tr_b16 v[88:89], v35 offset:2048
    ds_read_b64_tr_b16 v[90:91], v35 offset:2304
    ds_read_b64_tr_b16 v[92:93], v35 offset:2080
    ds_read_b64_tr_b16 v[94:95], v35 offset:2336
    s_waitcnt lgkmcnt(4)
    ds_read_b64_tr_b16 v[104:105], v35 offset:4096
    ds_read_b64_tr_b16 v[106:107], v35 offset:4352
    ds_read_b64_tr_b16 v[108:109], v35 offset:4128
    ds_read_b64_tr_b16 v[110:111], v35 offset:4384
    ds_read_b64_tr_b16 v[120:121], v35 offset:6144
    ds_read_b64_tr_b16 v[122:123], v35 offset:6400
    ds_read_b64_tr_b16 v[124:125], v35 offset:6176
    ds_read_b64_tr_b16 v[126:127], v35 offset:6432
    s_waitcnt lgkmcnt(4)
    v_and_b32 v6, 15, v2
    v_lshrrev_b32 v7, 4, v2
    v_mul_u32_u24 v11, 2064, v6
    v_lshl_add_u32 v11, v7, 4, v11
    s_lshl_b32 s35, s22, 8
    v_add_u32 v11, s35, v11
    v_lshlrev_b32 v8, 9, v7
    v_lshl_add_u32 v8, v6, 4, v8
    s_lshr_b32 s35, s3, 1
    s_lshl_b32 s36, s35, 16
    s_and_b32 s37, s3, 1
    s_lshl_b32 s38, s37, 8
    s_add_u32 s36, s36, s38
    s_lshl_b32 s38, s22, 13
    s_add_u32 s36, s36, s38
    s_add_u32 s36, s36, 8388608
    s_add_u32 s39, s36, 4096
    s_cmp_eq_u32 s22, 7
    s_cbranch_scc1 L_k1_p0
    s_waitcnt vmcnt(0) lgkmcnt(0)
    v_xor_b32 v168, 0, v164
    v_xor_b32 v169, 64, v164
    v_xor_b32 v170, 128, v164
    v_xor_b32 v171, 192, v164
    ds_read_b64_tr_b16 v[172:173], v168
    ds_read_b64_tr_b16 v[174:175], v168 offset:1024
    ds_read_b64_tr_b16 v[176:177], v169
    ds_read_b64_tr_b16 v[178:179], v169 offset:1024
    ds_read_b64_tr_b16 v[180:181], v170
    ds_read_b64_tr_b16 v[182:183], v170 offset:1024
    ds_read_b64_tr_b16 v[184:185], v171
    ds_read_b64_tr_b16 v[186:187], v171 offset:1024
    s_add_u32 s74, s72, 0
    s_waitcnt lgkmcnt(6)
    buffer_store_dwordx4 v[172:175], v161, s[4:7], s74 offen sc0 sc1
    s_add_u32 s74, s72, 65536
    s_waitcnt lgkmcnt(4)
    buffer_store_dwordx4 v[176:179], v161, s[4:7], s74 offen sc0 sc1
    s_add_u32 s74, s72, 131072
    s_waitcnt lgkmcnt(2)
    buffer_store_dwordx4 v[180:183], v161, s[4:7], s74 offen sc0 sc1
    s_add_u32 s74, s72, 196608
    s_waitcnt lgkmcnt(0)
    buffer_store_dwordx4 v[184:187], v161, s[4:7], s74 offen sc0 sc1
    s_branch L_k1_pd
L_k1_p0:
    s_waitcnt lgkmcnt(0)
    s_mov_b32 s42, 0x20000
L_k1_pl:
    buffer_load_dword v14, v15, s[56:59], 0 offen offset:128 sc1
    s_waitcnt vmcnt(0)
    v_readfirstlane_b32 s40, v14
    s_nop 0
    s_cmp_lg_u32 s40, 0
    s_cbranch_scc1 L_k1_pd
    s_sleep 8
    s_sub_u32 s42, s42, 1
    s_cmp_lg_u32 s42, 0
    s_cbranch_scc1 L_k1_pl
L_k1_pd:
    s_barrier
    s_mov_b32 s32, 0
    buffer_load_dwordx4 v[32:35], v4, s[4:7], s32 offen sc1
    s_mov_b32 s32, 8192
    buffer_load_dwordx4 v[36:39], v4, s[4:7], s32 offen sc1
    s_mov_b32 s32, 16384
    buffer_load_dwordx4 v[40:43], v4, s[4:7], s32 offen sc1
    s_mov_b32 s32, 24576
    buffer_load_dwordx4 v[44:47], v4, s[4:7], s32 offen sc1
    s_waitcnt vmcnt(0)
    v_pk_add_f32 v[32:33], v[32:33], v[36:37]
    v_pk_add_f32 v[40:41], v[40:41], v[44:45]
    v_pk_add_f32 v[32:33], v[32:33], v[40:41]
    v_pk_add_f32 v[34:35], v[34:35], v[38:39]
    v_pk_add_f32 v[42:43], v[42:43], v[46:47]
    v_pk_add_f32 v[34:35], v[34:35], v[42:43]
    v_cvt_pk_bf16_f32 v12, v32, v33
    v_lshlrev_b32 v32, 16, v12
    v_and_b32 v33, 0xffff0000, v12
    v_cvt_pk_bf16_f32 v13, v34, v35
    v_lshlrev_b32 v34, 16, v13
    v_and_b32 v35, 0xffff0000, v13
    s_cmp_lt_u32 s22, 4
    s_cbranch_scc1 L_k1_sa
    v_add_f32 v32, 1.0, v32
    v_add_f32 v33, 1.0, v33
    v_add_f32 v34, 1.0, v34
    v_add_f32 v35, 1.0, v35
    v_cvt_pk_bf16_f32 v12, v32, v33
    v_lshlrev_b32 v32, 16, v12
    v_and_b32 v33, 0xffff0000, v12
    v_cvt_pk_bf16_f32 v13, v34, v35
    v_lshlrev_b32 v34, 16, v13
    v_and_b32 v35, 0xffff0000, v13
L_k1_sa:
    ds_write_b128 v4, v[32:35] offset:32768
    v_lshlrev_b32 v5, 5, v2
    s_waitcnt lgkmcnt(0)
    s_barrier
    ds_read_b128 v[48:51], v5 offset:36864
    ds_read_b128 v[52:55], v5 offset:36880
    ds_read_b128 v[32:35], v5 offset:32768
    ds_read_b128 v[36:39], v5 offset:32784
    ds_read_b128 v[56:59], v5 offset:38912
    ds_read_b128 v[60:63], v5 offset:38928
    ds_read_b128 v[40:43], v5 offset:34816
    ds_read_b128 v[44:47], v5 offset:34832
    s_mul_i32 s43, s22, 4128
    v_add_u32 v5, s43, v3
    s_waitcnt lgkmcnt(4)
    v_pk_mul_f32 v[128:129], v[128:129], v[48:49]
    v_cvt_pk_bf16_f32 v12, v128, v129
    v_lshlrev_b32 v128, 16, v12
    v_and_b32 v129, 0xffff0000, v12
    v_pk_add_f32 v[128:129], v[128:129], v[32:33]
    v_cvt_pk_bf16_f32 v16, v128, v129
    v_pk_mul_f32 v[144:145], v[144:145], v[48:49]
    v_cvt_pk_bf16_f32 v13, v144, v145
    v_lshlrev_b32 v144, 16, v13
    v_and_b32 v145, 0xffff0000, v13
    v_pk_add_f32 v[144:145], v[144:145], v[32:33]
    v_cvt_pk_bf16_f32 v24, v144, v145
    v_pk_mul_f32 v[130:131], v[130:131], v[50:51]
    v_cvt_pk_bf16_f32 v12, v130, v131
    v_lshlrev_b32 v130, 16, v12
    v_and_b32 v131, 0xffff0000, v12
    v_pk_add_f32 v[130:131], v[130:131], v[34:35]
    v_cvt_pk_bf16_f32 v17, v130, v131
    v_pk_mul_f32 v[146:147], v[146:147], v[50:51]
    v_cvt_pk_bf16_f32 v13, v146, v147
    v_lshlrev_b32 v146, 16, v13
    v_and_b32 v147, 0xffff0000, v13
    v_pk_add_f32 v[146:147], v[146:147], v[34:35]
    v_cvt_pk_bf16_f32 v25, v146, v147
    v_pk_mul_f32 v[132:133], v[132:133], v[52:53]
    v_cvt_pk_bf16_f32 v12, v132, v133
    v_lshlrev_b32 v132, 16, v12
    v_and_b32 v133, 0xffff0000, v12
    v_pk_add_f32 v[132:133], v[132:133], v[36:37]
    v_cvt_pk_bf16_f32 v18, v132, v133
    v_pk_mul_f32 v[148:149], v[148:149], v[52:53]
    v_cvt_pk_bf16_f32 v13, v148, v149
    v_lshlrev_b32 v148, 16, v13
    v_and_b32 v149, 0xffff0000, v13
    v_pk_add_f32 v[148:149], v[148:149], v[36:37]
    v_cvt_pk_bf16_f32 v26, v148, v149
    v_pk_mul_f32 v[134:135], v[134:135], v[54:55]
    v_cvt_pk_bf16_f32 v12, v134, v135
    v_lshlrev_b32 v134, 16, v12
    v_and_b32 v135, 0xffff0000, v12
    v_pk_add_f32 v[134:135], v[134:135], v[38:39]
    v_cvt_pk_bf16_f32 v19, v134, v135
    v_pk_mul_f32 v[150:151], v[150:151], v[54:55]
    v_cvt_pk_bf16_f32 v13, v150, v151
    v_lshlrev_b32 v150, 16, v13
    v_and_b32 v151, 0xffff0000, v13
    v_pk_add_f32 v[150:151], v[150:151], v[38:39]
    v_cvt_pk_bf16_f32 v27, v150, v151
    s_waitcnt lgkmcnt(0)
    v_pk_mul_f32 v[136:137], v[136:137], v[56:57]
    v_cvt_pk_bf16_f32 v12, v136, v137
    v_lshlrev_b32 v136, 16, v12
    v_and_b32 v137, 0xffff0000, v12
    v_pk_add_f32 v[136:137], v[136:137], v[40:41]
    v_cvt_pk_bf16_f32 v20, v136, v137
    v_pk_mul_f32 v[152:153], v[152:153], v[56:57]
    v_cvt_pk_bf16_f32 v13, v152, v153
    v_lshlrev_b32 v152, 16, v13
    v_and_b32 v153, 0xffff0000, v13
    v_pk_add_f32 v[152:153], v[152:153], v[40:41]
    v_cvt_pk_bf16_f32 v28, v152, v153
    v_pk_mul_f32 v[138:139], v[138:139], v[58:59]
    v_cvt_pk_bf16_f32 v12, v138, v139
    v_lshlrev_b32 v138, 16, v12
    v_and_b32 v139, 0xffff0000, v12
    v_pk_add_f32 v[138:139], v[138:139], v[42:43]
    v_cvt_pk_bf16_f32 v21, v138, v139
    v_pk_mul_f32 v[154:155], v[154:155], v[58:59]
    v_cvt_pk_bf16_f32 v13, v154, v155
    v_lshlrev_b32 v154, 16, v13
    v_and_b32 v155, 0xffff0000, v13
    v_pk_add_f32 v[154:155], v[154:155], v[42:43]
    v_cvt_pk_bf16_f32 v29, v154, v155
    v_pk_mul_f32 v[140:141], v[140:141], v[60:61]
    v_cvt_pk_bf16_f32 v12, v140, v141
    v_lshlrev_b32 v140, 16, v12
    v_and_b32 v141, 0xffff0000, v12
    v_pk_add_f32 v[140:141], v[140:141], v[44:45]
    v_cvt_pk_bf16_f32 v22, v140, v141
    v_pk_mul_f32 v[156:157], v[156:157], v[60:61]
    v_cvt_pk_bf16_f32 v13, v156, v157
    v_lshlrev_b32 v156, 16, v13
    v_and_b32 v157, 0xffff0000, v13
    v_pk_add_f32 v[156:157], v[156:157], v[44:45]
    v_cvt_pk_bf16_f32 v30, v156, v157
    v_pk_mul_f32 v[142:143], v[142:143], v[62:63]
    v_cvt_pk_bf16_f32 v12, v142, v143
    v_lshlrev_b32 v142, 16, v12
    v_and_b32 v143, 0xffff0000, v12
    v_pk_add_f32 v[142:143], v[142:143], v[46:47]
    v_cvt_pk_bf16_f32 v23, v142, v143
    v_pk_mul_f32 v[158:159], v[158:159], v[62:63]
    v_cvt_pk_bf16_f32 v13, v158, v159
    v_lshlrev_b32 v158, 16, v13
    v_and_b32 v159, 0xffff0000, v13
    v_pk_add_f32 v[158:159], v[158:159], v[46:47]
    v_cvt_pk_bf16_f32 v31, v158, v159
    ds_write_b128 v5, v[16:19] offset:40960
    ds_write_b128 v5, v[20:23] offset:41984
    ds_write_b128 v5, v[24:27] offset:43024
    ds_write_b128 v5, v[28:31] offset:44048
    s_waitcnt lgkmcnt(0)
    s_barrier
    ds_read_b128 v[16:19], v11 offset:40960
    ds_read_b128 v[20:23], v11 offset:41024
    ds_read_b128 v[24:27], v11 offset:41088
    ds_read_b128 v[28:31], v11 offset:41152
    s_waitcnt lgkmcnt(3)
    v_mfma_f32_16x16x32_bf16 v[32:35], v[64:67], v[16:19], 0
    v_mfma_f32_16x16x32_bf16 v[36:39], v[68:71], v[16:19], 0
    v_mfma_f32_16x16x32_bf16 v[40:43], v[16:19], v[72:75], 0
    v_mfma_f32_16x16x32_bf16 v[44:47], v[16:19], v[76:79], 0
    buffer_store_dwordx4 v[16:19], v8, s[4:7], s36 offen offset:0 sc0 sc1
    s_waitcnt lgkmcnt(2)
    v_mfma_f32_16x16x32_bf16 v[32:35], v[80:83], v[20:23], v[32:35]
    v_mfma_f32_16x16x32_bf16 v[36:39], v[84:87], v[20:23], v[36:39]
    v_mfma_f32_16x16x32_bf16 v[40:43], v[20:23], v[88:91], v[40:43]
    v_mfma_f32_16x16x32_bf16 v[44:47], v[20:23], v[92:95], v[44:47]
    buffer_store_dwordx4 v[20:23], v8, s[4:7], s36 offen offset:2048 sc0 sc1
    s_waitcnt lgkmcnt(1)
    v_mfma_f32_16x16x32_bf16 v[32:35], v[96:99], v[24:27], v[32:35]
    v_mfma_f32_16x16x32_bf16 v[36:39], v[100:103], v[24:27], v[36:39]
    v_mfma_f32_16x16x32_bf16 v[40:43], v[24:27], v[104:107], v[40:43]
    v_mfma_f32_16x16x32_bf16 v[44:47], v[24:27], v[108:111], v[44:47]
    buffer_store_dwordx4 v[24:27], v8, s[4:7], s39 offen offset:0 sc0 sc1
    s_waitcnt lgkmcnt(0)
    v_mfma_f32_16x16x32_bf16 v[32:35], v[112:115], v[28:31], v[32:35]
    v_mfma_f32_16x16x32_bf16 v[36:39], v[116:119], v[28:31], v[36:39]
    v_mfma_f32_16x16x32_bf16 v[40:43], v[28:31], v[120:123], v[40:43]
    v_mfma_f32_16x16x32_bf16 v[44:47], v[28:31], v[124:127], v[44:47]
    buffer_store_dwordx4 v[28:31], v8, s[4:7], s39 offen offset:2048 sc0 sc1
    s_lshl_b32 s38, s22, 12
    v_add_u32 v5, s38, v3
    s_nop 1
    ds_write_b128 v5, v[32:35] offset:0
    ds_write_b128 v5, v[36:39] offset:1024
    ds_write_b128 v5, v[40:43] offset:2048
    ds_write_b128 v5, v[44:47] offset:3072
    s_waitcnt lgkmcnt(0)
    s_barrier
    s_cmp_lt_u32 s22, 3
    s_cbranch_scc1 L_k1_kv
    s_cmp_lg_u32 s22, 7
    s_cbranch_scc1 L_k1_kernel_end
    v_xor_b32 v168, 0, v164
    v_xor_b32 v169, 64, v164
    v_xor_b32 v170, 128, v164
    v_xor_b32 v171, 192, v164
    ds_read_b64_tr_b16 v[172:173], v168
    ds_read_b64_tr_b16 v[174:175], v168 offset:1024
    ds_read_b64_tr_b16 v[176:177], v169
    ds_read_b64_tr_b16 v[178:179], v169 offset:1024
    ds_read_b64_tr_b16 v[180:181], v170
    ds_read_b64_tr_b16 v[182:183], v170 offset:1024
    ds_read_b64_tr_b16 v[184:185], v171
    ds_read_b64_tr_b16 v[186:187], v171 offset:1024
    s_add_u32 s74, s72, 0
    s_waitcnt lgkmcnt(6)
    buffer_store_dwordx4 v[172:175], v161, s[4:7], s74 offen sc0 sc1
    s_add_u32 s74, s72, 65536
    s_waitcnt lgkmcnt(4)
    buffer_store_dwordx4 v[176:179], v161, s[4:7], s74 offen sc0 sc1
    s_add_u32 s74, s72, 131072
    s_waitcnt lgkmcnt(2)
    buffer_store_dwordx4 v[180:183], v161, s[4:7], s74 offen sc0 sc1
    s_add_u32 s74, s72, 196608
    s_waitcnt lgkmcnt(0)
    buffer_store_dwordx4 v[184:187], v161, s[4:7], s74 offen sc0 sc1
    s_branch L_k1_kernel_end
L_k1_kv:
    s_lshl_b32 s36, s35, 12
    s_add_u32 s36, s36, 1310720
    s_cmp_lg_u32 s22, 0
    s_cbranch_scc1 L_k1_v
    ds_read_b128 v[64:67], v3 offset:0
    ds_read_b128 v[68:71], v3 offset:4096
    ds_read_b128 v[72:75], v3 offset:8192
    ds_read_b128 v[76:79], v3 offset:12288
    ds_read_b128 v[80:83], v3 offset:16384
    ds_read_b128 v[84:87], v3 offset:20480
    ds_read_b128 v[88:91], v3 offset:24576
    ds_read_b128 v[92:95], v3 offset:28672
    s_waitcnt lgkmcnt(0)
    ds_read_b128 v[96:99], v3 offset:1024
    ds_read_b128 v[100:103], v3 offset:5120
    ds_read_b128 v[104:107], v3 offset:9216
    ds_read_b128 v[108:111], v3 offset:13312
    ds_read_b128 v[112:115], v3 offset:17408
    ds_read_b128 v[116:119], v3 offset:21504
    ds_read_b128 v[120:123], v3 offset:25600
    ds_read_b128 v[124:127], v3 offset:29696
    s_waitcnt lgkmcnt(0)
    v_pk_add_f32 v[64:65], v[64:65], v[80:81]
    v_pk_add_f32 v[66:67], v[66:67], v[82:83]
    v_pk_add_f32 v[68:69], v[68:69], v[84:85]
    v_pk_add_f32 v[70:71], v[70:71], v[86:87]
    v_pk_add_f32 v[72:73], v[72:73], v[88:89]
    v_pk_add_f32 v[74:75], v[74:75], v[90:91]
    v_pk_add_f32 v[76:77], v[76:77], v[92:93]
    v_pk_add_f32 v[78:79], v[78:79], v[94:95]
    v_pk_add_f32 v[64:65], v[64:65], v[72:73]
    v_pk_add_f32 v[66:67], v[66:67], v[74:75]
    v_pk_add_f32 v[68:69], v[68:69], v[76:77]
    v_pk_add_f32 v[70:71], v[70:71], v[78:79]
    v_pk_add_f32 v[64:65], v[64:65], v[68:69]
    v_pk_add_f32 v[66:67], v[66:67], v[70:71]
    v_pk_add_f32 v[96:97], v[96:97], v[112:113]
    v_pk_add_f32 v[98:99], v[98:99], v[114:115]
    v_pk_add_f32 v[100:101], v[100:101], v[116:117]
    v_pk_add_f32 v[102:103], v[102:103], v[118:119]
    v_pk_add_f32 v[104:105], v[104:105], v[120:121]
    v_pk_add_f32 v[106:107], v[106:107], v[122:123]
    v_pk_add_f32 v[108:109], v[108:109], v[124:125]
    v_pk_add_f32 v[110:111], v[110:111], v[126:127]
    v_pk_add_f32 v[96:97], v[96:97], v[104:105]
    v_pk_add_f32 v[98:99], v[98:99], v[106:107]
    v_pk_add_f32 v[100:101], v[100:101], v[108:109]
    v_pk_add_f32 v[102:103], v[102:103], v[110:111]
    v_pk_add_f32 v[96:97], v[96:97], v[100:101]
    v_pk_add_f32 v[98:99], v[98:99], v[102:103]
    v_cvt_pk_bf16_f32 v16, v64, v65
    v_cvt_pk_bf16_f32 v17, v66, v67
    v_cvt_pk_bf16_f32 v18, v96, v97
    v_cvt_pk_bf16_f32 v19, v98, v99
    v_and_b32 v9, 3, v6
    v_bfe_u32 v10, v6, 2, 1
    v_lshl_or_b32 v9, v10, 3, v9
    v_bfe_u32 v10, v6, 3, 1
    v_lshl_or_b32 v9, v10, 2, v9
    v_lshlrev_b32 v9, 4, v9
    v_lshl_add_u32 v9, v7, 9, v9
    s_lshl_b32 s38, s37, 8
    s_add_u32 s36, s36, s38
    buffer_store_dwordx4 v[16:19], v9, s[4:7], s36 offen sc0 sc1
    v_mov_b32 v20, 0
    v_lshlrev_b32 v21, 16, v16
    v_and_b32 v22, 0xffff0000, v16
    v_fmac_f32 v20, v21, v21
    v_fmac_f32 v20, v22, v22
    v_lshlrev_b32 v21, 16, v17
    v_and_b32 v22, 0xffff0000, v17
    v_fmac_f32 v20, v21, v21
    v_fmac_f32 v20, v22, v22
    v_lshlrev_b32 v21, 16, v18
    v_and_b32 v22, 0xffff0000, v18
    v_fmac_f32 v20, v21, v21
    v_fmac_f32 v20, v22, v22
    v_lshlrev_b32 v21, 16, v19
    v_and_b32 v22, 0xffff0000, v19
    v_fmac_f32 v20, v21, v21
    v_fmac_f32 v20, v22, v22
    v_mov_b32 v21, v20
    s_nop 1
    v_permlane16_swap_b32 v20, v21
    v_add_f32 v20, v20, v21
    v_mov_b32 v21, v20
    s_nop 1
    v_permlane32_swap_b32 v20, v21
    v_add_f32 v20, v20, v21
    s_nop 1
    v_max_f32 v20, v20, v20 row_ror:8 row_mask:0xf bank_mask:0xf
    s_nop 1
    v_max_f32 v20, v20, v20 row_ror:4 row_mask:0xf bank_mask:0xf
    s_nop 1
    v_max_f32 v20, v20, v20 row_ror:2 row_mask:0xf bank_mask:0xf
    s_nop 1
    v_max_f32 v20, v20, v20 row_ror:1 row_mask:0xf bank_mask:0xf
    s_lshl_b32 s38, s3, 3
    s_add_u32 s38, s38, 163840
    v_lshlrev_b32 v21, 2, v2
    v_cmp_gt_u32 vcc, 2, v2
    s_nop 0
    s_and_saveexec_b64 s[40:41], vcc
    buffer_store_dword v20, v21, s[4:7], s38 offen
    s_branch L_k1_kernel_end
L_k1_v:
    s_add_u32 s38, s22, 1
    s_lshl_b32 s38, s38, 10
    v_add_u32 v5, s38, v3
    ds_read_b128 v[64:67], v5 offset:0
    ds_read_b128 v[68:71], v5 offset:4096
    ds_read_b128 v[72:75], v5 offset:8192
    ds_read_b128 v[76:79], v5 offset:12288
    ds_read_b128 v[80:83], v5 offset:16384
    ds_read_b128 v[84:87], v5 offset:20480
    ds_read_b128 v[88:91], v5 offset:24576
    ds_read_b128 v[92:95], v5 offset:28672
    s_waitcnt lgkmcnt(0)
    v_pk_add_f32 v[64:65], v[64:65], v[80:81]
    v_pk_add_f32 v[66:67], v[66:67], v[82:83]
    v_pk_add_f32 v[68:69], v[68:69], v[84:85]
    v_pk_add_f32 v[70:71], v[70:71], v[86:87]
    v_pk_add_f32 v[72:73], v[72:73], v[88:89]
    v_pk_add_f32 v[74:75], v[74:75], v[90:91]
    v_pk_add_f32 v[76:77], v[76:77], v[92:93]
    v_pk_add_f32 v[78:79], v[78:79], v[94:95]
    v_pk_add_f32 v[64:65], v[64:65], v[72:73]
    v_pk_add_f32 v[66:67], v[66:67], v[74:75]
    v_pk_add_f32 v[68:69], v[68:69], v[76:77]
    v_pk_add_f32 v[70:71], v[70:71], v[78:79]
    v_pk_add_f32 v[64:65], v[64:65], v[68:69]
    v_pk_add_f32 v[66:67], v[66:67], v[70:71]
    v_cvt_pk_bf16_f32 v16, v64, v65
    v_cvt_pk_bf16_f32 v17, v66, v67
    v_lshrrev_b32 v9, 1, v7
    v_lshlrev_b32 v9, 9, v9
    v_lshl_add_u32 v9, v6, 4, v9
    v_and_b32 v10, 1, v7
    v_lshl_add_u32 v9, v10, 3, v9
    s_lshl_b32 s38, s37, 10
    s_add_u32 s36, s36, s38
    s_lshl_b32 s38, s22, 8
    s_add_u32 s36, s36, s38
    s_add_u32 s36, s36, 1792
    buffer_store_dwordx2 v[16:17], v9, s[4:7], s36 offen
L_k1_kernel_end:
L_k1_kernel_exit:
    s_endpgm

.globl k3_kernel
.p2align 8
.type k3_kernel,@function
k3_kernel:
    s_cmp_ge_u32 s2, 256
    s_cbranch_scc1 L_k3_kernel_exit
    s_load_dwordx2 s[4:5], s[0:1], 104
    s_load_dwordx2 s[60:61], s[0:1], 48
    s_load_dwordx2 s[64:65], s[0:1], 56
    s_load_dwordx2 s[72:73], s[0:1], 64
    v_lshrrev_b32 v1, 6, v0
    s_nop 0
    v_readfirstlane_b32 s22, v1
    s_mov_b32 s6, 268435456
    s_mov_b32 s7, 0x00020000
    s_mov_b32 s62, 7340032
    s_mov_b32 s63, 0x00020000
    s_mov_b32 s66, 7340032
    s_mov_b32 s67, 0x00020000
    s_mov_b32 s74, 7340032
    s_mov_b32 s75, 0x00020000
    s_and_b32 s8, s2, 7
    s_lshr_b32 s9, s2, 3
    s_and_b32 s10, s8, 3
    s_lshl_b32 s10, s10, 3
    s_and_b32 s11, s9, 7
    s_add_u32 s10, s10, s11
    s_lshr_b32 s12, s8, 2
    s_lshl_b32 s12, s12, 2
    s_lshr_b32 s11, s9, 3
    s_add_u32 s12, s12, s11
    s_lshl_b32 s20, s12, 2
    s_lshl_b32 s21, s10, 1
    v_and_b32 v6, 63, v0
    v_lshlrev_b32 v6, 4, v6
    s_add_u32 s43, s22, 0
    s_mul_i32 s49, s43, 1024
    s_add_u32 s49, s49, 32768
    s_and_b32 s39, s43, 3
    s_mul_i32 s39, s39, 1024
    s_lshr_b32 s43, s43, 2
    s_add_u32 s44, s43, s20
    s_mul_i32 s44, s44, 65536
    s_add_u32 s44, s44, 2097152
    s_add_u32 s46, s43, s21
    s_mul_i32 s46, s46, 65536
    s_add_u32 s46, s46, 8126464
    s_cmp_lt_u32 s43, 4
    s_cselect_b32 s46, s44, s46
    s_add_u32 s46, s46, s39
    s_add_u32 m0, s49, 0
    s_waitcnt lgkmcnt(0)
    buffer_load_dwordx4 v6, s[4:7], s46 offen offset:0 lds
    s_add_u32 s43, s22, 8
    s_mul_i32 s50, s43, 1024
    s_add_u32 s50, s50, 32768
    s_and_b32 s39, s43, 3
    s_mul_i32 s39, s39, 1024
    s_lshr_b32 s43, s43, 2
    s_add_u32 s44, s43, s20
    s_mul_i32 s44, s44, 65536
    s_add_u32 s44, s44, 2097152
    s_add_u32 s47, s43, s21
    s_mul_i32 s47, s47, 65536
    s_add_u32 s47, s47, 8126464
    s_cmp_lt_u32 s43, 4
    s_cselect_b32 s47, s44, s47
    s_add_u32 s47, s47, s39
    s_add_u32 m0, s50, 0
    s_nop 0
    buffer_load_dwordx4 v6, s[4:7], s47 offen offset:0 lds
    s_add_u32 s43, s22, 16
    s_mul_i32 s51, s43, 1024
    s_add_u32 s51, s51, 32768
    s_and_b32 s39, s43, 3
    s_mul_i32 s39, s39, 1024
    s_lshr_b32 s43, s43, 2
    s_add_u32 s44, s43, s20
    s_mul_i32 s44, s44, 65536
    s_add_u32 s44, s44, 2097152
    s_add_u32 s48, s43, s21
    s_mul_i32 s48, s48, 65536
    s_add_u32 s48, s48, 8126464
    s_cmp_lt_u32 s43, 4
    s_cselect_b32 s48, s44, s48
    s_add_u32 s48, s48, s39
    s_add_u32 m0, s51, 0
    s_nop 0
    buffer_load_dwordx4 v6, s[4:7], s48 offen offset:0 lds
    v_add_u32 v6, 4096, v6
    s_add_u32 m0, s49, 24576
    s_nop 0
    buffer_load_dwordx4 v6, s[4:7], s46 offen offset:0 lds
    s_add_u32 m0, s50, 24576
    s_nop 0
    buffer_load_dwordx4 v6, s[4:7], s47 offen offset:0 lds
    s_add_u32 m0, s51, 24576
    s_nop 0
    buffer_load_dwordx4 v6, s[4:7], s48 offen offset:0 lds
    v_add_u32 v6, 4096, v6
    s_add_u32 m0, s49, 49152
    s_nop 0
    buffer_load_dwordx4 v6, s[4:7], s46 offen offset:0 lds
    s_add_u32 m0, s50, 49152
    s_nop 0
    buffer_load_dwordx4 v6, s[4:7], s47 offen offset:0 lds
    s_add_u32 m0, s51, 49152
    s_nop 0
    buffer_load_dwordx4 v6, s[4:7], s48 offen offset:0 lds
    v_add_u32 v6, 4096, v6
    v_and_b32 v4, 63, v0
    v_lshlrev_b32 v4, 4, v4
    s_and_b32 s43, s22, 3
    s_mul_i32 s43, s43, 4096
    s_add_u32 s43, s43, 32768
    v_add_u32 v2, s43, v4
    s_lshr_b32 s43, s22, 2
    s_mul_i32 s43, s43, 4096
    s_add_u32 s43, s43, 49152
    v_add_u32 v3, s43, v4
    v_and_b32 v8, 63, v0
    v_lshlrev_b32 v9, 4, v8
    v_lshlrev_b32 v10, 2, v8
    s_lshr_b32 s15, s22, 2
    s_and_b32 s16, s22, 3
    s_lshl_b32 s13, s15, 5
    s_add_u32 s13, s13, s16
    s_lshl_b32 s13, s13, 12
    s_add_u32 s13, s13, 1310720
    s_lshl_b32 s14, s22, 12
    s_mov_b32 s17, 163840
    v_mov_b32 v112, 0
    v_mov_b32 v113, 0
    v_mov_b32 v114, 0
    v_mov_b32 v115, 0
    v_mov_b32 v116, 0
    v_mov_b32 v117, 0
    v_mov_b32 v118, 0
    v_mov_b32 v119, 0
    v_mov_b32 v120, 0
    v_mov_b32 v121, 0
    v_mov_b32 v122, 0
    v_mov_b32 v123, 0
    v_mov_b32 v124, 0
    v_mov_b32 v125, 0
    v_mov_b32 v126, 0
    v_mov_b32 v127, 0
    v_mov_b32 v128, 0
    v_mov_b32 v129, 0
    v_mov_b32 v130, 0
    v_mov_b32 v131, 0
    v_mov_b32 v132, 0
    v_mov_b32 v133, 0
    v_mov_b32 v134, 0
    v_mov_b32 v135, 0
    v_mov_b32 v136, 0
    v_mov_b32 v137, 0
    v_mov_b32 v138, 0
    v_mov_b32 v139, 0
    v_mov_b32 v140, 0
    v_mov_b32 v141, 0
    v_mov_b32 v142, 0
    v_mov_b32 v143, 0
    v_mov_b32 v144, 0
    v_mov_b32 v145, 0
    v_mov_b32 v146, 0
    v_mov_b32 v147, 0
    v_mov_b32 v148, 0
    v_mov_b32 v149, 0
    v_mov_b32 v150, 0
    v_mov_b32 v151, 0
    v_mov_b32 v104, 0
    v_mov_b32 v105, 0
    v_mov_b32 v106, 0
    v_mov_b32 v107, 0
    v_mov_b32 v108, 0
    v_mov_b32 v109, 0
    v_mov_b32 v110, 0
    v_mov_b32 v111, 0
    v_mov_b32 v180, 0
    v_mov_b32 v181, 0
    v_mov_b32 v182, 0
    v_mov_b32 v183, 0
    v_mov_b32 v184, 0
    v_mov_b32 v185, 0
    v_mov_b32 v186, 0
    v_mov_b32 v187, 0
    v_mov_b32 v152, 0x3f803f80
    v_mov_b32 v153, 0x3f803f80
    s_mul_i32 s17, s22, 2304
    s_add_u32 s17, s17, 65536
    v_add_u32 v14, s17, v9
    v_add_u32 v15, s17, v10
    s_mov_b32 s17, 163840
    v_lshrrev_b32 v188, 4, v8
    v_lshlrev_b32 v193, 2, v188
    v_and_b32 v189, 15, v8
    v_xor_b32 v189, v193, v189
    v_lshlrev_b32 v189, 4, v189
    v_bfe_u32 v191, v8, 1, 1
    v_lshlrev_b32 v191, 3, v191
    v_and_b32 v193, 1, v8
    v_lshl_or_b32 v191, v193, 4, v191
    v_bfe_u32 v193, v8, 4, 1
    v_lshl_or_b32 v191, v193, 12, v191
    v_bfe_u32 v193, v8, 2, 2
    v_lshl_or_b32 v191, v193, 6, v191
    v_lshl_or_b32 v191, v193, 8, v191
    v_bfe_u32 v193, v8, 5, 1
    v_lshl_or_b32 v191, v193, 11, v191
    s_and_b32 s28, s2, 7
    s_lshr_b32 s29, s2, 3
    s_lshl_b32 s30, s28, 3
    s_add_u32 s30, s30, s22
    v_bfe_u32 v193, v8, 3, 1
    v_lshlrev_b32 v193, 14, v193
    v_bfe_u32 v194, v8, 2, 1
    v_lshlrev_b32 v194, 12, v194
    v_sub_u32 v193, v193, v194
    v_and_b32 v194, 3, v8
    v_lshl_add_u32 v193, v194, 4, v193
    v_add_u32 v193, 73728, v193
    s_lshl_b32 s31, s30, 6
    s_and_b32 s78, s2, 15
    s_lshl_b32 s78, s78, 8
    s_bitcmp1_b32 s2, 4
    s_cselect_b32 s79, 12288, 0
    s_add_u32 s78, s78, s79
    s_add_u32 s78, s78, 65536
    s_add_u32 s79, s78, 16384
    s_mov_b32 s71, 28672
    s_mov_b32 s33, 7168
    v_mul_lo_u32 v192, v188, s33
    v_add_u32 v192, v192, v189
    s_mul_i32 s34, s30, 114688
    s_mul_i32 s35, s29, 224
    s_add_u32 s34, s34, s35
    s_lshl_b32 s37, s22, 13
    s_add_u32 s37, s37, 98304
    s_mov_b32 s18, 0x3e8293ee
    s_mov_b32 s68, 0
    s_mov_b32 s69, s37
    s_mov_b32 s70, s34
    buffer_load_dwordx4 v[248:251], v9, s[4:7], s17 offen
    s_cmp_lg_u32 s22, 7
    s_cbranch_scc1 L_ct_k3_skip
    s_getpc_b64 s[24:25]
L_ct_k3:
    v_and_b32 v7, 63, v0
    v_lshlrev_b32 v7, 7, v7
    s_mov_b32 s26, L_k3_kernel_exit-L_ct_k3-4
    v_min_u32 v13, s26, v7
    global_load_dword v255, v13, s[24:25]
    v_add_u32 v7, 8192, v7
    v_min_u32 v13, s26, v7
    global_load_dword v255, v13, s[24:25]
L_ct_k3_skip:
    v_mov_b32 v80, 0
    v_mov_b32 v81, 0
    v_mov_b32 v82, 0
    v_mov_b32 v83, 0
    v_mov_b32 v84, 0
    v_mov_b32 v85, 0
    v_mov_b32 v86, 0
    v_mov_b32 v87, 0
    v_mov_b32 v88, 0
    v_mov_b32 v89, 0
    v_mov_b32 v90, 0
    v_mov_b32 v91, 0
    v_mov_b32 v92, 0
    v_mov_b32 v93, 0
    v_mov_b32 v94, 0
    v_mov_b32 v95, 0
    s_mov_b32 s40, 0
    v_mov_b32 v4, v2
    v_mov_b32 v5, v3
    s_waitcnt vmcnt(7)
    s_barrier
    ds_read_b128 v[16:19], v4 offset:0
    ds_read_b128 v[20:23], v5 offset:0
    ds_read_b128 v[24:27], v4 offset:1024
    ds_read_b128 v[28:31], v5 offset:1024
    ds_read_b128 v[32:35], v4 offset:2048
    ds_read_b128 v[36:39], v5 offset:2048
    ds_read_b128 v[40:43], v4 offset:3072
    ds_read_b128 v[44:47], v5 offset:3072
    s_mov_b32 s40, 24576
    s_mov_b32 s41, 0
    v_add_u32 v4, 24576, v2
    v_add_u32 v5, 24576, v3
    s_waitcnt vmcnt(4) lgkmcnt(0)
    s_barrier
    v_mfma_f32_32x32x16_bf16 v[80:95], v[16:19], v[20:23], v[80:95]
    ds_read_b128 v[48:51], v4 offset:0
    ds_read_b128 v[52:55], v5 offset:0
    ds_read_b128 v[56:59], v4 offset:1024
    s_add_u32 m0, s49, 73728
    s_nop 0
    buffer_load_dwordx4 v6, s[4:7], s46 offen offset:0 lds
    s_add_u32 m0, s50, 73728
    s_nop 0
    buffer_load_dwordx4 v6, s[4:7], s47 offen offset:0 lds
    s_add_u32 m0, s51, 73728
    v_mfma_f32_32x32x16_bf16 v[80:95], v[24:27], v[28:31], v[80:95]
    ds_read_b128 v[60:63], v5 offset:1024
    ds_read_b128 v[64:67], v4 offset:2048
    ds_read_b128 v[68:71], v5 offset:2048
    buffer_load_dwordx4 v6, s[4:7], s48 offen offset:0 lds
    v_add_u32 v6, 4096, v6
    s_add_u32 m0, s49, 98304
    v_mfma_f32_32x32x16_bf16 v[80:95], v[32:35], v[36:39], v[80:95]
    ds_read_b128 v[72:75], v4 offset:3072
    ds_read_b128 v[76:79], v5 offset:3072
    buffer_load_dwordx4 v6, s[4:7], s46 offen offset:0 lds
    s_add_u32 m0, s50, 98304
    v_mfma_f32_32x32x16_bf16 v[80:95], v[40:43], v[44:47], v[80:95]
    buffer_load_dwordx4 v6, s[4:7], s47 offen offset:0 lds
    s_add_u32 s41, s40, 24576
    s_cmp_eq_u32 s41, 122880
    s_cselect_b32 s41, 0, s41
    v_add_u32 v4, s41, v2
    v_add_u32 v5, s41, v3
    s_waitcnt vmcnt(6) lgkmcnt(0)
    s_barrier
    v_mfma_f32_32x32x16_bf16 v[80:95], v[48:51], v[52:55], v[80:95]
    ds_read_b128 v[16:19], v4 offset:0
    ds_read_b128 v[20:23], v5 offset:0
    ds_read_b128 v[24:27], v4 offset:1024
    s_add_u32 m0, s51, 98304
    s_nop 0
    buffer_load_dwordx4 v6, s[4:7], s48 offen offset:0 lds
    v_add_u32 v6, 4096, v6
    s_add_u32 m0, s49, 0
    s_nop 0
    buffer_load_dwordx4 v6, s[4:7], s46 offen offset:0 lds
    s_add_u32 m0, s50, 0
    v_mfma_f32_32x32x16_bf16 v[80:95], v[56:59], v[60:63], v[80:95]
    ds_read_b128 v[28:31], v5 offset:1024
    ds_read_b128 v[32:35], v4 offset:2048
    ds_read_b128 v[36:39], v5 offset:2048
    buffer_load_dwordx4 v6, s[4:7], s47 offen offset:0 lds
    s_add_u32 m0, s51, 0
    v_mfma_f32_32x32x16_bf16 v[80:95], v[64:67], v[68:71], v[80:95]
    ds_read_b128 v[40:43], v4 offset:3072
    ds_read_b128 v[44:47], v5 offset:3072
    buffer_load_dwordx4 v6, s[4:7], s48 offen offset:0 lds
    v_add_u32 v6, 4096, v6
    s_add_u32 m0, s49, 24576
    v_mfma_f32_32x32x16_bf16 v[80:95], v[72:75], v[76:79], v[80:95]
    buffer_load_dwordx4 v6, s[4:7], s46 offen offset:0 lds
    s_add_u32 s40, s41, 24576
    s_cmp_eq_u32 s40, 122880
    s_cselect_b32 s40, 0, s40
    v_add_u32 v4, s40, v2
    v_add_u32 v5, s40, v3
    s_waitcnt vmcnt(7) lgkmcnt(0)
    s_barrier
    v_mfma_f32_32x32x16_bf16 v[80:95], v[16:19], v[20:23], v[80:95]
    ds_read_b128 v[48:51], v4 offset:0
    ds_read_b128 v[52:55], v5 offset:0
    ds_read_b128 v[56:59], v4 offset:1024
    s_add_u32 m0, s50, 24576
    s_nop 0
    buffer_load_dwordx4 v6, s[4:7], s47 offen offset:0 lds
    s_add_u32 m0, s51, 24576
    s_nop 0
    buffer_load_dwordx4 v6, s[4:7], s48 offen offset:0 lds
    v_add_u32 v6, 4096, v6
    s_add_u32 m0, s49, 49152
    v_mfma_f32_32x32x16_bf16 v[80:95], v[24:27], v[28:31], v[80:95]
    ds_read_b128 v[60:63], v5 offset:1024
    ds_read_b128 v[64:67], v4 offset:2048
    ds_read_b128 v[68:71], v5 offset:2048
    buffer_load_dwordx4 v6, s[4:7], s46 offen offset:0 lds
    s_add_u32 m0, s50, 49152
    v_mfma_f32_32x32x16_bf16 v[80:95], v[32:35], v[36:39], v[80:95]
    ds_read_b128 v[72:75], v4 offset:3072
    ds_read_b128 v[76:79], v5 offset:3072
    buffer_load_dwordx4 v6, s[4:7], s47 offen offset:0 lds
    s_add_u32 m0, s51, 49152
    v_mfma_f32_32x32x16_bf16 v[80:95], v[40:43], v[44:47], v[80:95]
    buffer_load_dwordx4 v6, s[4:7], s48 offen offset:0 lds
    v_add_u32 v6, 4096, v6
    s_add_u32 s41, s40, 24576
    s_cmp_eq_u32 s41, 122880
    s_cselect_b32 s41, 0, s41
    v_add_u32 v4, s41, v2
    v_add_u32 v5, s41, v3
    s_mov_b32 s42, 4
.p2align 6
L_k3q_loop:
    s_waitcnt vmcnt(9) lgkmcnt(0)
    s_barrier
    v_mfma_f32_32x32x16_bf16 v[80:95], v[48:51], v[52:55], v[80:95]
    ds_read_b128 v[16:19], v4 offset:0
    ds_read_b128 v[20:23], v5 offset:0
    ds_read_b128 v[24:27], v4 offset:1024
    s_add_u32 m0, s40, s49
    s_nop 0
    buffer_load_dwordx4 v6, s[4:7], s46 offen offset:0 lds
    s_add_u32 m0, s40, s50
    v_mfma_f32_32x32x16_bf16 v[80:95], v[56:59], v[60:63], v[80:95]
    ds_read_b128 v[28:31], v5 offset:1024
    ds_read_b128 v[32:35], v4 offset:2048
    ds_read_b128 v[36:39], v5 offset:2048
    buffer_load_dwordx4 v6, s[4:7], s47 offen offset:0 lds
    s_add_u32 m0, s40, s51
    v_mfma_f32_32x32x16_bf16 v[80:95], v[64:67], v[68:71], v[80:95]
    ds_read_b128 v[40:43], v4 offset:3072
    ds_read_b128 v[44:47], v5 offset:3072
    buffer_load_dwordx4 v6, s[4:7], s48 offen offset:0 lds
    v_add_u32 v6, 4096, v6
    v_mfma_f32_32x32x16_bf16 v[80:95], v[72:75], v[76:79], v[80:95]
    s_add_u32 s40, s41, 24576
    s_cmp_eq_u32 s40, 122880
    s_cselect_b32 s40, 0, s40
    v_add_u32 v4, s40, v2
    v_add_u32 v5, s40, v3
    s_waitcnt vmcnt(9) lgkmcnt(0)
    s_barrier
    v_mfma_f32_32x32x16_bf16 v[80:95], v[16:19], v[20:23], v[80:95]
    ds_read_b128 v[48:51], v4 offset:0
    ds_read_b128 v[52:55], v5 offset:0
    ds_read_b128 v[56:59], v4 offset:1024
    s_add_u32 m0, s41, s49
    s_nop 0
    buffer_load_dwordx4 v6, s[4:7], s46 offen offset:0 lds
    s_add_u32 m0, s41, s50
    v_mfma_f32_32x32x16_bf16 v[80:95], v[24:27], v[28:31], v[80:95]
    ds_read_b128 v[60:63], v5 offset:1024
    ds_read_b128 v[64:67], v4 offset:2048
    ds_read_b128 v[68:71], v5 offset:2048
    buffer_load_dwordx4 v6, s[4:7], s47 offen offset:0 lds
    s_add_u32 m0, s41, s51
    v_mfma_f32_32x32x16_bf16 v[80:95], v[32:35], v[36:39], v[80:95]
    ds_read_b128 v[72:75], v4 offset:3072
    ds_read_b128 v[76:79], v5 offset:3072
    buffer_load_dwordx4 v6, s[4:7], s48 offen offset:0 lds
    v_add_u32 v6, 4096, v6
    v_mfma_f32_32x32x16_bf16 v[80:95], v[40:43], v[44:47], v[80:95]
    s_add_u32 s41, s40, 24576
    s_cmp_eq_u32 s41, 122880
    s_cselect_b32 s41, 0, s41
    v_add_u32 v4, s41, v2
    v_add_u32 v5, s41, v3
    s_sub_u32 s42, s42, 1
    s_cmp_lg_u32 s42, 0
    s_cbranch_scc1 L_k3q_loop
    s_waitcnt vmcnt(9) lgkmcnt(0)
    s_barrier
    v_mfma_f32_32x32x16_bf16 v[80:95], v[48:51], v[52:55], v[80:95]
    ds_read_b128 v[16:19], v4 offset:0
    ds_read_b128 v[20:23], v5 offset:0
    ds_read_b128 v[24:27], v4 offset:1024
    s_mov_b32 m0, s14
    s_nop 0
    buffer_load_dwordx4 v9, s[4:7], s13 offen offset:0 lds
    v_mfma_f32_32x32x16_bf16 v[80:95], v[56:59], v[60:63], v[80:95]
    ds_read_b128 v[28:31], v5 offset:1024
    ds_read_b128 v[32:35], v4 offset:2048
    ds_read_b128 v[36:39], v5 offset:2048
    buffer_load_dwordx4 v9, s[4:7], s13 offen offset:1024 lds
    v_mfma_f32_32x32x16_bf16 v[80:95], v[64:67], v[68:71], v[80:95]
    ds_read_b128 v[40:43], v4 offset:3072
    ds_read_b128 v[44:47], v5 offset:3072
    buffer_load_dwordx4 v9, s[4:7], s13 offen offset:2048 lds
    v_mfma_f32_32x32x16_bf16 v[80:95], v[72:75], v[76:79], v[80:95]
    s_add_u32 s40, s41, 24576
    s_cmp_eq_u32 s40, 122880
    s_cselect_b32 s40, 0, s40
    v_add_u32 v4, s40, v2
    v_add_u32 v5, s40, v3
    s_waitcnt vmcnt(9) lgkmcnt(0)
    s_barrier
    v_mfma_f32_32x32x16_bf16 v[80:95], v[16:19], v[20:23], v[80:95]
    ds_read_b128 v[48:51], v4 offset:0
    ds_read_b128 v[52:55], v5 offset:0
    ds_read_b128 v[56:59], v4 offset:1024
    v_mfma_f32_32x32x16_bf16 v[80:95], v[24:27], v[28:31], v[80:95]
    ds_read_b128 v[60:63], v5 offset:1024
    ds_read_b128 v[64:67], v4 offset:2048
    ds_read_b128 v[68:71], v5 offset:2048
    buffer_load_dwordx4 v9, s[4:7], s13 offen offset:3072 lds
    s_add_u32 s13, s13, 16384
    v_mfma_f32_32x32x16_bf16 v[80:95], v[32:35], v[36:39], v[80:95]
    ds_read_b128 v[72:75], v4 offset:3072
    ds_read_b128 v[76:79], v5 offset:3072
    v_mfma_f32_32x32x16_bf16 v[80:95], v[40:43], v[44:47], v[80:95]
    buffer_load_dwordx4 v[196:199], v193, s[4:7], s31 offen
    s_add_u32 s41, s40, 24576
    s_cmp_eq_u32 s41, 122880
    s_cselect_b32 s41, 0, s41
    v_add_u32 v4, s41, v2
    v_add_u32 v5, s41, v3
    s_waitcnt vmcnt(8) lgkmcnt(0)
    s_barrier
    v_mfma_f32_32x32x16_bf16 v[80:95], v[48:51], v[52:55], v[80:95]
    ds_read_b128 v[16:19], v4 offset:0
    ds_read_b128 v[20:23], v5 offset:0
    ds_read_b128 v[24:27], v4 offset:1024
    v_mfma_f32_32x32x16_bf16 v[80:95], v[56:59], v[60:63], v[80:95]
    ds_read_b128 v[28:31], v5 offset:1024
    ds_read_b128 v[32:35], v4 offset:2048
    ds_read_b128 v[36:39], v5 offset:2048
    v_mfma_f32_32x32x16_bf16 v[80:95], v[64:67], v[68:71], v[80:95]
    ds_read_b128 v[40:43], v4 offset:3072
    ds_read_b128 v[44:47], v5 offset:3072
    v_mfma_f32_32x32x16_bf16 v[80:95], v[72:75], v[76:79], v[80:95]
    s_add_u32 s40, s41, 24576
    s_cmp_eq_u32 s40, 122880
    s_cselect_b32 s40, 0, s40
    v_add_u32 v4, s40, v2
    v_add_u32 v5, s40, v3
    s_waitcnt vmcnt(5) lgkmcnt(0)
    s_barrier
    v_mfma_f32_32x32x16_bf16 v[80:95], v[16:19], v[20:23], v[80:95]
    ds_read_b128 v[48:51], v4 offset:0
    ds_read_b128 v[52:55], v5 offset:0
    ds_read_b128 v[56:59], v4 offset:1024
    v_mfma_f32_32x32x16_bf16 v[80:95], v[24:27], v[28:31], v[80:95]
    ds_read_b128 v[60:63], v5 offset:1024
    ds_read_b128 v[64:67], v4 offset:2048
    ds_read_b128 v[68:71], v5 offset:2048
    v_mfma_f32_32x32x16_bf16 v[80:95], v[32:35], v[36:39], v[80:95]
    ds_read_b128 v[72:75], v4 offset:3072
    ds_read_b128 v[76:79], v5 offset:3072
    v_mfma_f32_32x32x16_bf16 v[80:95], v[40:43], v[44:47], v[80:95]
    s_add_u32 s41, s40, 24576
    s_cmp_eq_u32 s41, 122880
    s_cselect_b32 s41, 0, s41
    v_add_u32 v4, s41, v2
    v_add_u32 v5, s41, v3
    s_waitcnt lgkmcnt(0)
    v_mfma_f32_32x32x16_bf16 v[80:95], v[48:51], v[52:55], v[80:95]
    v_mfma_f32_32x32x16_bf16 v[80:95], v[56:59], v[60:63], v[80:95]
    v_mfma_f32_32x32x16_bf16 v[80:95], v[64:67], v[68:71], v[80:95]
    v_mfma_f32_32x32x16_bf16 v[80:95], v[72:75], v[76:79], v[80:95]
    v_max3_f32 v11, v248, v249, v250
    v_max_f32 v11, v11, v251
    s_nop 1
    v_max_f32 v11, v11, v11 row_ror:8 row_mask:0xf bank_mask:0xf
    s_nop 1
    v_max_f32 v11, v11, v11 row_ror:4 row_mask:0xf bank_mask:0xf
    s_nop 1
    v_max_f32 v11, v11, v11 row_ror:2 row_mask:0xf bank_mask:0xf
    s_nop 1
    v_max_f32 v11, v11, v11 row_ror:1 row_mask:0xf bank_mask:0xf
    v_mov_b32 v12, v11
    s_nop 1
    v_permlane16_swap_b32 v11, v12
    v_max_f32 v11, v11, v12
    v_mov_b32 v12, v11
    s_nop 1
    v_permlane32_swap_b32 v11, v12
    v_max_f32 v11, v11, v12
    v_cvt_pk_bf16_f32 v13, v80, v81
    v_lshlrev_b32 v80, 16, v13
    v_and_b32 v81, 0xffff0000, v13
    v_pk_mul_f32 v[80:81], v[80:81], s[18:19] op_sel_hi:[1,0]
    v_cvt_pk_bf16_f32 v16, v80, v81
    v_cvt_pk_bf16_f32 v13, v82, v83
    v_lshlrev_b32 v82, 16, v13
    v_and_b32 v83, 0xffff0000, v13
    v_pk_mul_f32 v[82:83], v[82:83], s[18:19] op_sel_hi:[1,0]
    v_cvt_pk_bf16_f32 v17, v82, v83
    v_cvt_pk_bf16_f32 v13, v84, v85
    v_lshlrev_b32 v84, 16, v13
    v_and_b32 v85, 0xffff0000, v13
    v_pk_mul_f32 v[84:85], v[84:85], s[18:19] op_sel_hi:[1,0]
    v_cvt_pk_bf16_f32 v18, v84, v85
    v_cvt_pk_bf16_f32 v13, v86, v87
    v_lshlrev_b32 v86, 16, v13
    v_and_b32 v87, 0xffff0000, v13
    v_pk_mul_f32 v[86:87], v[86:87], s[18:19] op_sel_hi:[1,0]
    v_cvt_pk_bf16_f32 v19, v86, v87
    v_cvt_pk_bf16_f32 v13, v88, v89
    v_lshlrev_b32 v88, 16, v13
    v_and_b32 v89, 0xffff0000, v13
    v_pk_mul_f32 v[88:89], v[88:89], s[18:19] op_sel_hi:[1,0]
    v_cvt_pk_bf16_f32 v20, v88, v89
    v_cvt_pk_bf16_f32 v13, v90, v91
    v_lshlrev_b32 v90, 16, v13
    v_and_b32 v91, 0xffff0000, v13
    v_pk_mul_f32 v[90:91], v[90:91], s[18:19] op_sel_hi:[1,0]
    v_cvt_pk_bf16_f32 v21, v90, v91
    v_cvt_pk_bf16_f32 v13, v92, v93
    v_lshlrev_b32 v92, 16, v13
    v_and_b32 v93, 0xffff0000, v13
    v_pk_mul_f32 v[92:93], v[92:93], s[18:19] op_sel_hi:[1,0]
    v_cvt_pk_bf16_f32 v22, v92, v93
    v_cvt_pk_bf16_f32 v13, v94, v95
    v_lshlrev_b32 v94, 16, v13
    v_and_b32 v95, 0xffff0000, v13
    v_pk_mul_f32 v[94:95], v[94:95], s[18:19] op_sel_hi:[1,0]
    v_cvt_pk_bf16_f32 v23, v94, v95
    ds_write_b128 v14, v[16:19]
    ds_write_b128 v14, v[20:23] offset:1024
    v_mov_b32 v12, 0
    v_mov_b32 v13, 0
    v_lshlrev_b32 v6, 16, v16
    v_and_b32 v7, 0xffff0000, v16
    v_pk_fma_f32 v[12:13], v[6:7], v[6:7], v[12:13]
    v_lshlrev_b32 v6, 16, v17
    v_and_b32 v7, 0xffff0000, v17
    v_pk_fma_f32 v[12:13], v[6:7], v[6:7], v[12:13]
    v_lshlrev_b32 v6, 16, v18
    v_and_b32 v7, 0xffff0000, v18
    v_pk_fma_f32 v[12:13], v[6:7], v[6:7], v[12:13]
    v_lshlrev_b32 v6, 16, v19
    v_and_b32 v7, 0xffff0000, v19
    v_pk_fma_f32 v[12:13], v[6:7], v[6:7], v[12:13]
    v_lshlrev_b32 v6, 16, v20
    v_and_b32 v7, 0xffff0000, v20
    v_pk_fma_f32 v[12:13], v[6:7], v[6:7], v[12:13]
    v_lshlrev_b32 v6, 16, v21
    v_and_b32 v7, 0xffff0000, v21
    v_pk_fma_f32 v[12:13], v[6:7], v[6:7], v[12:13]
    v_lshlrev_b32 v6, 16, v22
    v_and_b32 v7, 0xffff0000, v22
    v_pk_fma_f32 v[12:13], v[6:7], v[6:7], v[12:13]
    v_lshlrev_b32 v6, 16, v23
    v_and_b32 v7, 0xffff0000, v23
    v_pk_fma_f32 v[12:13], v[6:7], v[6:7], v[12:13]
    v_add_f32 v13, v12, v13
    v_mov_b32 v6, v13
    s_nop 1
    v_permlane32_swap_b32 v13, v6
    v_add_f32 v13, v13, v6
    v_mul_f32 v13, v13, v11
    v_sqrt_f32 v13, v13
    s_mul_i32 s17, s16, 2304
    v_mul_f32 v13, 0xbf802000, v13
    ds_write_b32 v15, v13 offset:2048
    s_add_u32 s17, s17, 65536
    v_add_u32 v14, s17, v9
    v_add_u32 v15, s17, v10
    s_lshl_b32 s18, s15, 14
    v_add_u32 v2, s18, v9
    v_add_u32 v3, 32768, v2
    v_mov_b32 v4, v2
    s_waitcnt vmcnt(0) lgkmcnt(0)
    s_barrier
    ds_read_b32 v32, v15 offset:2048
    ds_read_b128 v[156:159], v2
    ds_read_b128 v[16:19], v14
    ds_read_b128 v[160:163], v2 offset:1024
    ds_read_b128 v[20:23], v14 offset:1024
    ds_read_b32 v48, v15 offset:11264
    ds_read_b128 v[24:27], v14 offset:9216
    ds_read_b128 v[28:31], v14 offset:10240
    s_add_u32 m0, s14, 32768
    s_nop 0
    buffer_load_dwordx4 v9, s[4:7], s13 offen offset:0 lds
    s_waitcnt lgkmcnt(7)
    v_mov_b32 v33, v32
    v_mov_b32 v34, v32
    v_mov_b32 v35, v32
    v_mov_b32 v36, v32
    v_mov_b32 v37, v32
    v_mov_b32 v38, v32
    v_mov_b32 v39, v32
    v_mov_b32 v40, v32
    v_mov_b32 v41, v32
    v_mov_b32 v42, v32
    v_mov_b32 v43, v32
    v_mov_b32 v44, v32
    v_mov_b32 v45, v32
    v_mov_b32 v46, v32
    v_mov_b32 v47, v32
    buffer_load_dwordx4 v9, s[4:7], s13 offen offset:1024 lds
    s_waitcnt lgkmcnt(2)
    v_mfma_f32_32x32x16_bf16 v[64:79], v[156:159], v[16:19], v[32:47]
    v_mfma_f32_32x32x16_bf16 v[64:79], v[160:163], v[20:23], v[64:79]
    v_mov_b32 v49, v48
    v_mov_b32 v50, v48
    v_mov_b32 v51, v48
    v_mov_b32 v52, v48
    v_mov_b32 v53, v48
    v_mov_b32 v54, v48
    v_mov_b32 v55, v48
    v_mov_b32 v56, v48
    v_mov_b32 v57, v48
    v_mov_b32 v58, v48
    v_mov_b32 v59, v48
    v_mov_b32 v60, v48
    v_mov_b32 v61, v48
    v_mov_b32 v62, v48
    v_mov_b32 v63, v48
    buffer_load_dwordx4 v9, s[4:7], s13 offen offset:2048 lds
    buffer_load_dwordx4 v9, s[4:7], s13 offen offset:3072 lds
    s_add_u32 s13, s13, 16384
    s_waitcnt lgkmcnt(0)
    s_mov_b32 s19, 0
    s_mov_b32 s23, 65536
.p2align 6
L_k3_loop:
    v_mfma_f32_32x32x16_bf16 v[80:95], v[156:159], v[24:27], v[48:63]
    ds_read_b128 v[164:167], v2 offset:4096
    ds_read_b128 v[168:171], v2 offset:5120
    v_exp_f32 v64, v64
    v_exp_f32 v65, v65
    v_exp_f32 v66, v66
    v_exp_f32 v67, v67
    v_mfma_f32_4x4x4_16b_bf16 v[148:151], v[152:153], v[104:105], v[148:151]
    v_cvt_pk_bf16_f32 v96, v64, v65
    v_exp_f32 v68, v68
    v_mfma_f32_32x32x16_bf16 v[80:95], v[160:163], v[28:31], v[80:95]
    ds_read_b128 v[172:175], v2 offset:2048
    ds_read_b128 v[176:179], v2 offset:3072
    v_exp_f32 v69, v69
    v_cvt_pk_bf16_f32 v97, v66, v67
    v_exp_f32 v70, v70
    v_exp_f32 v71, v71
    v_mfma_f32_4x4x4_16b_bf16 v[148:151], v[152:153], v[106:107], v[148:151]
    v_cvt_pk_bf16_f32 v98, v68, v69
    v_exp_f32 v72, v72
    v_mfma_f32_32x32x16_bf16 v[128:143], v[180:183], v[104:107], v[128:143]
    s_cmp_ge_u32 s68, 8
    s_cbranch_scc1 L_k3_nsa0
    s_mov_b32 m0, s69
    s_add_u32 s69, s69, 1024
    buffer_load_dwordx4 v192, s[60:63], s70 offen lds
    s_add_u32 s70, s70, s71
    s_add_u32 s68, s68, 1
    s_cmp_eq_u32 s68, 4
    s_cselect_b64 s[60:61], s[64:65], s[60:61]
    s_cselect_b32 s70, s34, s70
L_k3_nsa0:
    v_exp_f32 v73, v73
    v_cvt_pk_bf16_f32 v99, v70, v71
    v_exp_f32 v74, v74
    v_exp_f32 v75, v75
    v_mfma_f32_4x4x4_16b_bf16 v[148:151], v[152:153], v[108:109], v[148:151]
    v_cvt_pk_bf16_f32 v100, v72, v73
    v_exp_f32 v76, v76
    v_mfma_f32_32x32x16_bf16 v[128:143], v[184:187], v[108:111], v[128:143]
    v_exp_f32 v77, v77
    v_cvt_pk_bf16_f32 v101, v74, v75
    v_exp_f32 v78, v78
    v_exp_f32 v79, v79
    v_mfma_f32_4x4x4_16b_bf16 v[148:151], v[152:153], v[110:111], v[148:151]
    v_cvt_pk_bf16_f32 v102, v76, v77
    v_cvt_pk_bf16_f32 v103, v78, v79
    s_waitcnt lgkmcnt(0)
    v_mfma_f32_32x32x16_bf16 v[64:79], v[164:167], v[16:19], v[32:47]
    v_exp_f32 v80, v80
    v_exp_f32 v81, v81
    v_exp_f32 v82, v82
    v_exp_f32 v83, v83
    v_mfma_f32_4x4x4_16b_bf16 v[144:147], v[152:153], v[96:97], v[144:147]
    v_cvt_pk_bf16_f32 v104, v80, v81
    v_exp_f32 v84, v84
    v_mfma_f32_32x32x16_bf16 v[64:79], v[168:171], v[20:23], v[64:79]
    v_exp_f32 v85, v85
    v_cvt_pk_bf16_f32 v105, v82, v83
    v_exp_f32 v86, v86
    v_exp_f32 v87, v87
    v_mfma_f32_4x4x4_16b_bf16 v[144:147], v[152:153], v[98:99], v[144:147]
    v_cvt_pk_bf16_f32 v106, v84, v85
    v_exp_f32 v88, v88
    v_mfma_f32_32x32x16_bf16 v[112:127], v[172:175], v[96:99], v[112:127]
    v_exp_f32 v89, v89
    v_cvt_pk_bf16_f32 v107, v86, v87
    v_exp_f32 v90, v90
    v_exp_f32 v91, v91
    v_mfma_f32_4x4x4_16b_bf16 v[144:147], v[152:153], v[100:101], v[144:147]
    v_cvt_pk_bf16_f32 v108, v88, v89
    v_exp_f32 v92, v92
    v_mfma_f32_32x32x16_bf16 v[112:127], v[176:179], v[100:103], v[112:127]
    v_exp_f32 v93, v93
    v_cvt_pk_bf16_f32 v109, v90, v91
    v_exp_f32 v94, v94
    v_exp_f32 v95, v95
    v_mfma_f32_4x4x4_16b_bf16 v[144:147], v[152:153], v[102:103], v[144:147]
    v_cvt_pk_bf16_f32 v110, v92, v93
    v_cvt_pk_bf16_f32 v111, v94, v95
    v_mfma_f32_32x32x16_bf16 v[80:95], v[164:167], v[24:27], v[48:63]
    ds_read_b128 v[156:159], v2 offset:8192
    ds_read_b128 v[160:163], v2 offset:9216
    v_exp_f32 v64, v64
    v_exp_f32 v65, v65
    v_exp_f32 v66, v66
    v_exp_f32 v67, v67
    v_mfma_f32_4x4x4_16b_bf16 v[148:151], v[152:153], v[104:105], v[148:151]
    v_cvt_pk_bf16_f32 v96, v64, v65
    v_exp_f32 v68, v68
    v_mfma_f32_32x32x16_bf16 v[80:95], v[168:171], v[28:31], v[80:95]
    ds_read_b128 v[180:183], v2 offset:6144
    ds_read_b128 v[184:187], v2 offset:7168
    v_exp_f32 v69, v69
    v_cvt_pk_bf16_f32 v97, v66, v67
    v_exp_f32 v70, v70
    v_exp_f32 v71, v71
    v_mfma_f32_4x4x4_16b_bf16 v[148:151], v[152:153], v[106:107], v[148:151]
    v_cvt_pk_bf16_f32 v98, v68, v69
    v_exp_f32 v72, v72
    v_mfma_f32_32x32x16_bf16 v[128:143], v[172:175], v[104:107], v[128:143]
    s_cmp_ge_u32 s68, 8
    s_cbranch_scc1 L_k3_nsa1
    s_mov_b32 m0, s69
    s_add_u32 s69, s69, 1024
    buffer_load_dwordx4 v192, s[60:63], s70 offen lds
    s_add_u32 s70, s70, s71
    s_add_u32 s68, s68, 1
    s_cmp_eq_u32 s68, 4
    s_cselect_b64 s[60:61], s[64:65], s[60:61]
    s_cselect_b32 s70, s34, s70
L_k3_nsa1:
    v_exp_f32 v73, v73
    v_cvt_pk_bf16_f32 v99, v70, v71
    v_exp_f32 v74, v74
    v_exp_f32 v75, v75
    v_mfma_f32_4x4x4_16b_bf16 v[148:151], v[152:153], v[108:109], v[148:151]
    v_cvt_pk_bf16_f32 v100, v72, v73
    v_exp_f32 v76, v76
    v_mfma_f32_32x32x16_bf16 v[128:143], v[176:179], v[108:111], v[128:143]
    v_exp_f32 v77, v77
    v_cvt_pk_bf16_f32 v101, v74, v75
    v_exp_f32 v78, v78
    v_exp_f32 v79, v79
    v_mfma_f32_4x4x4_16b_bf16 v[148:151], v[152:153], v[110:111], v[148:151]
    v_cvt_pk_bf16_f32 v102, v76, v77
    v_cvt_pk_bf16_f32 v103, v78, v79
    s_waitcnt lgkmcnt(0)
    v_mfma_f32_32x32x16_bf16 v[64:79], v[156:159], v[16:19], v[32:47]
    v_exp_f32 v80, v80
    v_exp_f32 v81, v81
    v_exp_f32 v82, v82
    v_exp_f32 v83, v83
    v_mfma_f32_4x4x4_16b_bf16 v[144:147], v[152:153], v[96:97], v[144:147]
    v_cvt_pk_bf16_f32 v104, v80, v81
    v_exp_f32 v84, v84
    v_mfma_f32_32x32x16_bf16 v[64:79], v[160:163], v[20:23], v[64:79]
    v_exp_f32 v85, v85
    v_cvt_pk_bf16_f32 v105, v82, v83
    v_exp_f32 v86, v86
    v_exp_f32 v87, v87
    v_mfma_f32_4x4x4_16b_bf16 v[144:147], v[152:153], v[98:99], v[144:147]
    v_cvt_pk_bf16_f32 v106, v84, v85
    v_exp_f32 v88, v88
    v_mfma_f32_32x32x16_bf16 v[112:127], v[180:183], v[96:99], v[112:127]
    v_exp_f32 v89, v89
    v_cvt_pk_bf16_f32 v107, v86, v87
    v_exp_f32 v90, v90
    v_exp_f32 v91, v91
    v_mfma_f32_4x4x4_16b_bf16 v[144:147], v[152:153], v[100:101], v[144:147]
    v_cvt_pk_bf16_f32 v108, v88, v89
    v_exp_f32 v92, v92
    v_mfma_f32_32x32x16_bf16 v[112:127], v[184:187], v[100:103], v[112:127]
    v_exp_f32 v93, v93
    v_cvt_pk_bf16_f32 v109, v90, v91
    v_exp_f32 v94, v94
    v_exp_f32 v95, v95
    v_mfma_f32_4x4x4_16b_bf16 v[144:147], v[152:153], v[102:103], v[144:147]
    v_cvt_pk_bf16_f32 v110, v92, v93
    v_cvt_pk_bf16_f32 v111, v94, v95
    v_mfma_f32_32x32x16_bf16 v[80:95], v[156:159], v[24:27], v[48:63]
    ds_read_b128 v[164:167], v2 offset:12288
    ds_read_b128 v[168:171], v2 offset:13312
    v_exp_f32 v64, v64
    v_exp_f32 v65, v65
    v_exp_f32 v66, v66
    v_exp_f32 v67, v67
    v_mfma_f32_4x4x4_16b_bf16 v[148:151], v[152:153], v[104:105], v[148:151]
    v_cvt_pk_bf16_f32 v96, v64, v65
    v_exp_f32 v68, v68
    v_mfma_f32_32x32x16_bf16 v[80:95], v[160:163], v[28:31], v[80:95]
    ds_read_b128 v[172:175], v2 offset:10240
    ds_read_b128 v[176:179], v2 offset:11264
    v_exp_f32 v69, v69
    v_cvt_pk_bf16_f32 v97, v66, v67
    v_exp_f32 v70, v70
    v_exp_f32 v71, v71
    v_mfma_f32_4x4x4_16b_bf16 v[148:151], v[152:153], v[106:107], v[148:151]
    v_cvt_pk_bf16_f32 v98, v68, v69
    v_exp_f32 v72, v72
    v_mfma_f32_32x32x16_bf16 v[128:143], v[180:183], v[104:107], v[128:143]
    s_cmp_ge_u32 s68, 8
    s_cbranch_scc1 L_k3_nsa2
    s_mov_b32 m0, s69
    s_add_u32 s69, s69, 1024
    buffer_load_dwordx4 v192, s[60:63], s70 offen lds
    s_add_u32 s70, s70, s71
    s_add_u32 s68, s68, 1
    s_cmp_eq_u32 s68, 4
    s_cselect_b64 s[60:61], s[64:65], s[60:61]
    s_cselect_b32 s70, s34, s70
L_k3_nsa2:
    v_exp_f32 v73, v73
    v_cvt_pk_bf16_f32 v99, v70, v71
    v_exp_f32 v74, v74
    v_exp_f32 v75, v75
    v_mfma_f32_4x4x4_16b_bf16 v[148:151], v[152:153], v[108:109], v[148:151]
    v_cvt_pk_bf16_f32 v100, v72, v73
    v_exp_f32 v76, v76
    v_mfma_f32_32x32x16_bf16 v[128:143], v[184:187], v[108:111], v[128:143]
    v_exp_f32 v77, v77
    v_cvt_pk_bf16_f32 v101, v74, v75
    v_exp_f32 v78, v78
    v_exp_f32 v79, v79
    v_mfma_f32_4x4x4_16b_bf16 v[148:151], v[152:153], v[110:111], v[148:151]
    v_cvt_pk_bf16_f32 v102, v76, v77
    v_cvt_pk_bf16_f32 v103, v78, v79
    s_waitcnt lgkmcnt(0)
    v_mfma_f32_32x32x16_bf16 v[64:79], v[164:167], v[16:19], v[32:47]
    v_exp_f32 v80, v80
    v_exp_f32 v81, v81
    v_exp_f32 v82, v82
    v_exp_f32 v83, v83
    v_mfma_f32_4x4x4_16b_bf16 v[144:147], v[152:153], v[96:97], v[144:147]
    v_cvt_pk_bf16_f32 v104, v80, v81
    v_exp_f32 v84, v84
    v_mfma_f32_32x32x16_bf16 v[64:79], v[168:171], v[20:23], v[64:79]
    v_exp_f32 v85, v85
    v_cvt_pk_bf16_f32 v105, v82, v83
    v_exp_f32 v86, v86
    v_exp_f32 v87, v87
    v_mfma_f32_4x4x4_16b_bf16 v[144:147], v[152:153], v[98:99], v[144:147]
    v_cvt_pk_bf16_f32 v106, v84, v85
    v_exp_f32 v88, v88
    v_mfma_f32_32x32x16_bf16 v[112:127], v[172:175], v[96:99], v[112:127]
    v_exp_f32 v89, v89
    v_cvt_pk_bf16_f32 v107, v86, v87
    v_exp_f32 v90, v90
    v_exp_f32 v91, v91
    v_mfma_f32_4x4x4_16b_bf16 v[144:147], v[152:153], v[100:101], v[144:147]
    v_cvt_pk_bf16_f32 v108, v88, v89
    v_exp_f32 v92, v92
    v_mfma_f32_32x32x16_bf16 v[112:127], v[176:179], v[100:103], v[112:127]
    v_exp_f32 v93, v93
    v_cvt_pk_bf16_f32 v109, v90, v91
    v_exp_f32 v94, v94
    v_exp_f32 v95, v95
    v_mfma_f32_4x4x4_16b_bf16 v[144:147], v[152:153], v[102:103], v[144:147]
    v_cvt_pk_bf16_f32 v110, v92, v93
    v_cvt_pk_bf16_f32 v111, v94, v95
    s_sub_u32 s76, s19, s15
    s_cmp_eq_u32 s76, 4
    s_cbranch_scc1 L_k3_w7
    s_cmp_lt_u32 s19, 3
    s_cbranch_scc1 L_k3_w2
    s_waitcnt vmcnt(0)
L_k3_w2:
    s_waitcnt vmcnt(2)
L_k3_w7:
    s_waitcnt vmcnt(7) lgkmcnt(0)
    s_barrier
    v_mfma_f32_32x32x16_bf16 v[80:95], v[164:167], v[24:27], v[48:63]
    ds_read_b128 v[156:159], v3 offset:0
    ds_read_b128 v[160:163], v3 offset:1024
    v_exp_f32 v64, v64
    v_exp_f32 v65, v65
    v_exp_f32 v66, v66
    v_exp_f32 v67, v67
    v_mfma_f32_4x4x4_16b_bf16 v[148:151], v[152:153], v[104:105], v[148:151]
    v_cvt_pk_bf16_f32 v96, v64, v65
    v_exp_f32 v68, v68
    v_mfma_f32_32x32x16_bf16 v[80:95], v[168:171], v[28:31], v[80:95]
    ds_read_b128 v[180:183], v2 offset:14336
    ds_read_b128 v[184:187], v2 offset:15360
    v_exp_f32 v69, v69
    v_cvt_pk_bf16_f32 v97, v66, v67
    v_exp_f32 v70, v70
    v_exp_f32 v71, v71
    v_mfma_f32_4x4x4_16b_bf16 v[148:151], v[152:153], v[106:107], v[148:151]
    v_cvt_pk_bf16_f32 v98, v68, v69
    v_exp_f32 v72, v72
    v_mfma_f32_32x32x16_bf16 v[128:143], v[172:175], v[104:107], v[128:143]
    s_cmp_ge_u32 s19, 6
    s_cbranch_scc1 L_k3_nodma
    s_add_u32 m0, s14, s23
    s_nop 0
    buffer_load_dwordx4 v9, s[4:7], s13 offen offset:0 lds
    buffer_load_dwordx4 v9, s[4:7], s13 offen offset:1024 lds
    buffer_load_dwordx4 v9, s[4:7], s13 offen offset:2048 lds
    buffer_load_dwordx4 v9, s[4:7], s13 offen offset:3072 lds
    s_add_u32 s13, s13, 16384
L_k3_nodma:
    v_exp_f32 v73, v73
    v_cvt_pk_bf16_f32 v99, v70, v71
    v_exp_f32 v74, v74
    v_exp_f32 v75, v75
    v_mfma_f32_4x4x4_16b_bf16 v[148:151], v[152:153], v[108:109], v[148:151]
    v_cvt_pk_bf16_f32 v100, v72, v73
    v_exp_f32 v76, v76
    v_mfma_f32_32x32x16_bf16 v[128:143], v[176:179], v[108:111], v[128:143]
    v_exp_f32 v77, v77
    v_cvt_pk_bf16_f32 v101, v74, v75
    v_exp_f32 v78, v78
    v_exp_f32 v79, v79
    v_mfma_f32_4x4x4_16b_bf16 v[148:151], v[152:153], v[110:111], v[148:151]
    v_cvt_pk_bf16_f32 v102, v76, v77
    v_cvt_pk_bf16_f32 v103, v78, v79
    s_waitcnt lgkmcnt(0)
    v_mfma_f32_32x32x16_bf16 v[64:79], v[156:159], v[16:19], v[32:47]
    v_exp_f32 v80, v80
    v_exp_f32 v81, v81
    v_exp_f32 v82, v82
    v_exp_f32 v83, v83
    v_mfma_f32_4x4x4_16b_bf16 v[144:147], v[152:153], v[96:97], v[144:147]
    v_cvt_pk_bf16_f32 v104, v80, v81
    v_exp_f32 v84, v84
    v_mfma_f32_32x32x16_bf16 v[64:79], v[160:163], v[20:23], v[64:79]
    v_mov_b32 v2, v3
    v_add_u32 v3, s23, v4
    s_add_u32 s23, s23, 32768
    s_cmp_eq_u32 s23, 98304
    s_cselect_b32 s23, 0, s23
    v_exp_f32 v85, v85
    v_cvt_pk_bf16_f32 v105, v82, v83
    v_exp_f32 v86, v86
    v_exp_f32 v87, v87
    v_mfma_f32_4x4x4_16b_bf16 v[144:147], v[152:153], v[98:99], v[144:147]
    v_cvt_pk_bf16_f32 v106, v84, v85
    v_exp_f32 v88, v88
    v_mfma_f32_32x32x16_bf16 v[112:127], v[180:183], v[96:99], v[112:127]
    v_exp_f32 v89, v89
    v_cvt_pk_bf16_f32 v107, v86, v87
    v_exp_f32 v90, v90
    v_exp_f32 v91, v91
    v_mfma_f32_4x4x4_16b_bf16 v[144:147], v[152:153], v[100:101], v[144:147]
    v_cvt_pk_bf16_f32 v108, v88, v89
    v_exp_f32 v92, v92
    v_mfma_f32_32x32x16_bf16 v[112:127], v[184:187], v[100:103], v[112:127]
    v_exp_f32 v93, v93
    v_cvt_pk_bf16_f32 v109, v90, v91
    v_exp_f32 v94, v94
    v_exp_f32 v95, v95
    v_mfma_f32_4x4x4_16b_bf16 v[144:147], v[152:153], v[102:103], v[144:147]
    v_cvt_pk_bf16_f32 v110, v92, v93
    v_cvt_pk_bf16_f32 v111, v94, v95
    s_cmp_eq_u32 s19, 5
    s_cbranch_scc1 L_k3_p5
L_k3_p5ret:
    s_sub_u32 s76, s19, s15
    s_cmp_eq_u32 s76, 1
    s_cbranch_scc1 L_k3_p1
    s_cmp_eq_u32 s76, 3
    s_cbranch_scc1 L_k3_p2
    s_cmp_eq_u32 s76, 6
    s_cbranch_scc1 L_k3_p6
L_k3_pret:
    s_add_u32 s19, s19, 1
    s_cmp_lt_u32 s19, 8
    s_cbranch_scc1 L_k3_loop
    v_mfma_f32_32x32x16_bf16 v[128:143], v[180:183], v[104:107], v[128:143]
    v_mfma_f32_4x4x4_16b_bf16 v[148:151], v[152:153], v[104:105], v[148:151]
    s_nop 1
    v_mfma_f32_4x4x4_16b_bf16 v[148:151], v[152:153], v[106:107], v[148:151]
    v_mfma_f32_32x32x16_bf16 v[128:143], v[184:187], v[108:111], v[128:143]
    s_nop 0
    v_mfma_f32_4x4x4_16b_bf16 v[148:151], v[152:153], v[108:109], v[148:151]
    s_nop 1
    v_mfma_f32_4x4x4_16b_bf16 v[148:151], v[152:153], v[110:111], v[148:151]
    s_mul_i32 s17, s16, 5120
    s_lshl_b32 s18, s15, 16
    s_add_u32 s18, s18, s17
    v_add_u32 v14, s18, v9
    v_add_u32 v15, s18, v10
    s_xor_b32 s18, s18, 65536
    v_add_u32 v12, s18, v9
    v_add_u32 v13, s18, v10
    s_cmp_lg_u32 s15, 0
    s_cbranch_scc1 L_k3_c1
    ds_write_b128 v14, v[128:131] offset:0
    ds_write_b128 v14, v[132:135] offset:1024
    ds_write_b128 v14, v[136:139] offset:2048
    ds_write_b128 v14, v[140:143] offset:3072
    ds_write_b32 v15, v148 offset:4096
    v_mov_b32 v88, v16
    v_mov_b32 v89, v17
    v_mov_b32 v90, v18
    v_mov_b32 v91, v19
    v_mov_b32 v92, v20
    v_mov_b32 v93, v21
    v_mov_b32 v94, v22
    v_mov_b32 v95, v23
    s_waitcnt lgkmcnt(0)
    s_barrier
    ds_read_b128 v[64:67], v12 offset:0
    ds_read_b128 v[68:71], v12 offset:1024
    ds_read_b128 v[72:75], v12 offset:2048
    ds_read_b128 v[76:79], v12 offset:3072
    ds_read_b32 v80, v13 offset:4096
    s_waitcnt lgkmcnt(0)
    v_add_f32 v64, v64, v112
    v_add_f32 v65, v65, v113
    v_add_f32 v66, v66, v114
    v_add_f32 v67, v67, v115
    v_add_f32 v68, v68, v116
    v_add_f32 v69, v69, v117
    v_add_f32 v70, v70, v118
    v_add_f32 v71, v71, v119
    v_add_f32 v72, v72, v120
    v_add_f32 v73, v73, v121
    v_add_f32 v74, v74, v122
    v_add_f32 v75, v75, v123
    v_add_f32 v76, v76, v124
    v_add_f32 v77, v77, v125
    v_add_f32 v78, v78, v126
    v_add_f32 v79, v79, v127
    v_add_f32 v80, v80, v144
    s_branch L_k3_c2
L_k3_c1:
    ds_write_b128 v14, v[112:115] offset:0
    ds_write_b128 v14, v[116:119] offset:1024
    ds_write_b128 v14, v[120:123] offset:2048
    ds_write_b128 v14, v[124:127] offset:3072
    ds_write_b32 v15, v144 offset:4096
    v_mov_b32 v88, v24
    v_mov_b32 v89, v25
    v_mov_b32 v90, v26
    v_mov_b32 v91, v27
    v_mov_b32 v92, v28
    v_mov_b32 v93, v29
    v_mov_b32 v94, v30
    v_mov_b32 v95, v31
    s_waitcnt lgkmcnt(0)
    s_barrier
    ds_read_b128 v[64:67], v12 offset:0
    ds_read_b128 v[68:71], v12 offset:1024
    ds_read_b128 v[72:75], v12 offset:2048
    ds_read_b128 v[76:79], v12 offset:3072
    ds_read_b32 v80, v13 offset:4096
    s_waitcnt lgkmcnt(0)
    v_add_f32 v64, v64, v128
    v_add_f32 v65, v65, v129
    v_add_f32 v66, v66, v130
    v_add_f32 v67, v67, v131
    v_add_f32 v68, v68, v132
    v_add_f32 v69, v69, v133
    v_add_f32 v70, v70, v134
    v_add_f32 v71, v71, v135
    v_add_f32 v72, v72, v136
    v_add_f32 v73, v73, v137
    v_add_f32 v74, v74, v138
    v_add_f32 v75, v75, v139
    v_add_f32 v76, v76, v140
    v_add_f32 v77, v77, v141
    v_add_f32 v78, v78, v142
    v_add_f32 v79, v79, v143
    v_add_f32 v80, v80, v148
L_k3_c2:
    v_mov_b32 v5, v80
    s_nop 1
    v_permlane32_swap_b32 v80, v5
    v_add_f32 v80, v80, v5
    v_cmp_le_f32 vcc, 0x0d800000, v80
    v_mov_b32 v5, 0x7b800000
    v_cmp_gt_f32 s[24:25], v5, v80
    s_nop 0
    s_and_b64 vcc, vcc, s[24:25]
    s_cmp_eq_u64 vcc, -1
    s_cbranch_scc1 L_k3_fin
    v_mov_b32 v5, 0xff7fffff
    v_mov_b32 v6, 0
    v_mov_b32 v64, 0
    v_mov_b32 v65, 0
    v_mov_b32 v66, 0
    v_mov_b32 v67, 0
    v_mov_b32 v68, 0
    v_mov_b32 v69, 0
    v_mov_b32 v70, 0
    v_mov_b32 v71, 0
    v_mov_b32 v72, 0
    v_mov_b32 v73, 0
    v_mov_b32 v74, 0
    v_mov_b32 v75, 0
    v_mov_b32 v76, 0
    v_mov_b32 v77, 0
    v_mov_b32 v78, 0
    v_mov_b32 v79, 0
    s_mov_b32 s26, 1310720
    s_mov_b32 s27, 64
L_k3_fb:
    buffer_load_dwordx4 v[156:159], v9, s[4:7], s26 offen offset:0
    buffer_load_dwordx4 v[160:163], v9, s[4:7], s26 offen offset:1024
    buffer_load_dwordx4 v[164:167], v9, s[4:7], s26 offen offset:2048
    buffer_load_dwordx4 v[168:171], v9, s[4:7], s26 offen offset:3072
    s_waitcnt vmcnt(0)
    v_mfma_f32_32x32x16_bf16 v[112:127], v[156:159], v[88:91], 0
    v_mfma_f32_32x32x16_bf16 v[112:127], v[160:163], v[92:95], v[112:127]
    s_nop 11
    v_max3_f32 v7, v112, v113, v5
    v_max3_f32 v7, v114, v115, v7
    v_max3_f32 v7, v116, v117, v7
    v_max3_f32 v7, v118, v119, v7
    v_max3_f32 v7, v120, v121, v7
    v_max3_f32 v7, v122, v123, v7
    v_max3_f32 v7, v124, v125, v7
    v_max3_f32 v7, v126, v127, v7
    v_mov_b32 v11, v7
    s_nop 1
    v_permlane32_swap_b32 v7, v11
    v_max_f32 v7, v7, v11
    v_sub_f32 v11, v5, v7
    v_exp_f32 v11, v11
    v_mov_b32 v5, v7
    v_mul_f32 v6, v6, v11
    v_mul_f32 v64, v64, v11
    v_sub_f32 v112, v112, v5
    v_exp_f32 v112, v112
    v_mul_f32 v65, v65, v11
    v_sub_f32 v113, v113, v5
    v_exp_f32 v113, v113
    v_mul_f32 v66, v66, v11
    v_sub_f32 v114, v114, v5
    v_exp_f32 v114, v114
    v_mul_f32 v67, v67, v11
    v_sub_f32 v115, v115, v5
    v_exp_f32 v115, v115
    v_mul_f32 v68, v68, v11
    v_sub_f32 v116, v116, v5
    v_exp_f32 v116, v116
    v_mul_f32 v69, v69, v11
    v_sub_f32 v117, v117, v5
    v_exp_f32 v117, v117
    v_mul_f32 v70, v70, v11
    v_sub_f32 v118, v118, v5
    v_exp_f32 v118, v118
    v_mul_f32 v71, v71, v11
    v_sub_f32 v119, v119, v5
    v_exp_f32 v119, v119
    v_mul_f32 v72, v72, v11
    v_sub_f32 v120, v120, v5
    v_exp_f32 v120, v120
    v_mul_f32 v73, v73, v11
    v_sub_f32 v121, v121, v5
    v_exp_f32 v121, v121
    v_mul_f32 v74, v74, v11
    v_sub_f32 v122, v122, v5
    v_exp_f32 v122, v122
    v_mul_f32 v75, v75, v11
    v_sub_f32 v123, v123, v5
    v_exp_f32 v123, v123
    v_mul_f32 v76, v76, v11
    v_sub_f32 v124, v124, v5
    v_exp_f32 v124, v124
    v_mul_f32 v77, v77, v11
    v_sub_f32 v125, v125, v5
    v_exp_f32 v125, v125
    v_mul_f32 v78, v78, v11
    v_sub_f32 v126, v126, v5
    v_exp_f32 v126, v126
    v_mul_f32 v79, v79, v11
    v_sub_f32 v127, v127, v5
    v_exp_f32 v127, v127
    v_cvt_pk_bf16_f32 v96, v112, v113
    v_lshlrev_b32 v7, 16, v96
    v_and_b32 v11, 0xffff0000, v96
    v_add_f32 v6, v6, v7
    v_add_f32 v6, v6, v11
    v_cvt_pk_bf16_f32 v97, v114, v115
    v_lshlrev_b32 v7, 16, v97
    v_and_b32 v11, 0xffff0000, v97
    v_add_f32 v6, v6, v7
    v_add_f32 v6, v6, v11
    v_cvt_pk_bf16_f32 v98, v116, v117
    v_lshlrev_b32 v7, 16, v98
    v_and_b32 v11, 0xffff0000, v98
    v_add_f32 v6, v6, v7
    v_add_f32 v6, v6, v11
    v_cvt_pk_bf16_f32 v99, v118, v119
    v_lshlrev_b32 v7, 16, v99
    v_and_b32 v11, 0xffff0000, v99
    v_add_f32 v6, v6, v7
    v_add_f32 v6, v6, v11
    v_cvt_pk_bf16_f32 v100, v120, v121
    v_lshlrev_b32 v7, 16, v100
    v_and_b32 v11, 0xffff0000, v100
    v_add_f32 v6, v6, v7
    v_add_f32 v6, v6, v11
    v_cvt_pk_bf16_f32 v101, v122, v123
    v_lshlrev_b32 v7, 16, v101
    v_and_b32 v11, 0xffff0000, v101
    v_add_f32 v6, v6, v7
    v_add_f32 v6, v6, v11
    v_cvt_pk_bf16_f32 v102, v124, v125
    v_lshlrev_b32 v7, 16, v102
    v_and_b32 v11, 0xffff0000, v102
    v_add_f32 v6, v6, v7
    v_add_f32 v6, v6, v11
    v_cvt_pk_bf16_f32 v103, v126, v127
    v_lshlrev_b32 v7, 16, v103
    v_and_b32 v11, 0xffff0000, v103
    v_add_f32 v6, v6, v7
    v_add_f32 v6, v6, v11
    v_mfma_f32_32x32x16_bf16 v[64:79], v[164:167], v[96:99], v[64:79]
    v_mfma_f32_32x32x16_bf16 v[64:79], v[168:171], v[100:103], v[64:79]
    s_add_u32 s26, s26, 4096
    s_sub_u32 s27, s27, 1
    s_cmp_lg_u32 s27, 0
    s_cbranch_scc1 L_k3_fb
    v_mov_b32 v11, v6
    s_nop 1
    v_permlane32_swap_b32 v6, v11
    v_add_f32 v80, v6, v11
L_k3_fin:
    v_rcp_f32 v80, v80
    s_nop 1
    v_mul_f32 v64, v64, v80
    v_mul_f32 v65, v65, v80
    v_mul_f32 v66, v66, v80
    v_mul_f32 v67, v67, v80
    v_mul_f32 v68, v68, v80
    v_mul_f32 v69, v69, v80
    v_mul_f32 v70, v70, v80
    v_mul_f32 v71, v71, v80
    v_mul_f32 v72, v72, v80
    v_mul_f32 v73, v73, v80
    v_mul_f32 v74, v74, v80
    v_mul_f32 v75, v75, v80
    v_mul_f32 v76, v76, v80
    v_mul_f32 v77, v77, v80
    v_mul_f32 v78, v78, v80
    v_mul_f32 v79, v79, v80
    v_cvt_pk_bf16_f32 v96, v64, v65
    v_cvt_pk_bf16_f32 v97, v66, v67
    v_cvt_pk_bf16_f32 v98, v68, v69
    v_cvt_pk_bf16_f32 v99, v70, v71
    v_cvt_pk_bf16_f32 v100, v72, v73
    v_cvt_pk_bf16_f32 v101, v74, v75
    v_cvt_pk_bf16_f32 v102, v76, v77
    v_cvt_pk_bf16_f32 v103, v78, v79
    s_add_u32 s17, s21, s15
    s_lshl_b32 s17, s17, 16
    s_add_u32 s18, s20, s16
    s_lshl_b32 s18, s18, 11
    s_add_u32 s17, s17, s18
    s_add_u32 s17, s17, 12582912
    buffer_store_dwordx4 v[96:99], v9, s[4:7], s17 offen sc0 sc1
    buffer_store_dwordx4 v[100:103], v9, s[4:7], s17 offen offset:1024 sc0 sc1
    s_branch L_k3_kernel_end
L_k3_p1:
    v_add_f32 v196, v196, v196 row_ror:8 row_mask:0xf bank_mask:0xf
    v_add_f32 v197, v197, v197 row_ror:8 row_mask:0xf bank_mask:0xf
    v_add_f32 v198, v198, v198 row_ror:8 row_mask:0xf bank_mask:0xf
    v_add_f32 v199, v199, v199 row_ror:8 row_mask:0xf bank_mask:0xf
    v_cvt_pk_bf16_f32 v204, v196, v197
    v_cvt_pk_bf16_f32 v205, v198, v199
    v_lshlrev_b32 v196, 16, v204
    v_and_b32 v197, 0xffff0000, v204
    v_lshlrev_b32 v198, 16, v205
    v_and_b32 v199, 0xffff0000, v205
    v_add_f32 v196, 1.0, v196
    v_add_f32 v197, 1.0, v197
    v_add_f32 v198, 1.0, v198
    v_add_f32 v199, 1.0, v199
    v_cvt_pk_bf16_f32 v206, v196, v197
    v_cvt_pk_bf16_f32 v207, v198, v199
    v_lshrrev_b32 v193, 5, v8
    v_lshlrev_b32 v193, 3, v193
    v_add_u32 v194, 0, v193
    ds_bpermute_b32 v196, v194, v206
    ds_bpermute_b32 v252, v194, v204 offset:16
    v_add_u32 v195, 0, v193
    ds_bpermute_b32 v198, v195, v207
    ds_bpermute_b32 v253, v195, v205 offset:16
    v_add_u32 v194, 4, v193
    ds_bpermute_b32 v200, v194, v206
    ds_bpermute_b32 v254, v194, v204 offset:16
    v_add_u32 v195, 4, v193
    ds_bpermute_b32 v202, v195, v207
    ds_bpermute_b32 v255, v195, v205 offset:16
    s_cmp_ge_u32 s2, 32
    s_cbranch_scc1 L_k3_nomf1
    s_cmp_lg_u32 s22, 5
    s_cbranch_scc1 L_k3_nomf1
    buffer_load_dword v12, v10, s[4:7], s78 offen
    buffer_load_dword v13, v10, s[4:7], s79 offen
L_k3_nomf1:
    s_waitcnt lgkmcnt(0)
    v_and_b32 v193, 1, v8
    v_mov_b32 v194, 0xffff
    v_lshlrev_b32 v193, 4, v193
    v_lshlrev_b32 v194, v193, v194
    v_bfe_u32 v193, v8, 1, 1
    v_cmp_eq_u32 vcc, 0, v193
    s_nop 1
    v_cndmask_b32 v195, 0, v194, vcc
    v_sub_u32 v194, v194, v195
    v_and_b32 v248, v195, v196
    v_and_b32 v249, v194, v198
    v_and_b32 v250, v195, v200
    v_and_b32 v251, v194, v202
    v_add_u32 v191, s37, v191
    s_mul_i32 s35, s29, 7
    s_lshl_b32 s35, s35, 16
    s_lshl_b32 s36, s30, 10
    s_add_u32 s35, s35, s36
    s_add_u32 s35, s35, 33554432
    s_branch L_k3_pret
L_k3_p2:
    v_xor_b32 v194, 0, v191
    ds_read_b64_tr_b16 v[196:197], v194
    ds_read_b64_tr_b16 v[198:199], v194 offset:1024
    v_xor_b32 v195, 32, v191
    ds_read_b64_tr_b16 v[200:201], v195
    ds_read_b64_tr_b16 v[202:203], v195 offset:1024
    v_xor_b32 v194, 64, v191
    ds_read_b64_tr_b16 v[204:205], v194
    ds_read_b64_tr_b16 v[206:207], v194 offset:1024
    v_xor_b32 v195, 96, v191
    ds_read_b64_tr_b16 v[208:209], v195
    ds_read_b64_tr_b16 v[210:211], v195 offset:1024
    v_xor_b32 v194, 128, v191
    ds_read_b64_tr_b16 v[212:213], v194
    ds_read_b64_tr_b16 v[214:215], v194 offset:1024
    v_xor_b32 v195, 160, v191
    ds_read_b64_tr_b16 v[216:217], v195
    ds_read_b64_tr_b16 v[218:219], v195 offset:1024
    v_xor_b32 v194, 192, v191
    ds_read_b64_tr_b16 v[220:221], v194
    ds_read_b64_tr_b16 v[222:223], v194 offset:1024
    v_add_u32 v193, s37, v10
    s_waitcnt lgkmcnt(0)
    v_mfma_f32_4x4x4_16b_bf16 v[224:227], v[248:249], v[196:197], 0
    v_mfma_f32_4x4x4_16b_bf16 v[228:231], v[250:251], v[198:199], 0
    v_mfma_f32_4x4x4_16b_bf16 v[232:235], v[252:253], v[196:197], 0
    s_add_u32 s36, s35, 0
    s_nop 0
    v_mfma_f32_4x4x4_16b_bf16 v[232:235], v[254:255], v[198:199], v[232:235]
    v_cvt_pk_bf16_f32 v196, v224, v225
    v_cvt_pk_bf16_f32 v197, v226, v227
    v_cvt_pk_bf16_f32 v198, v228, v229
    v_cvt_pk_bf16_f32 v199, v230, v231
    buffer_store_dwordx4 v[196:199], v9, s[4:7], s36 offen sc0 sc1
    v_mfma_f32_4x4x4_16b_bf16 v[236:239], v[152:153], v[196:197], 0
    s_nop 0
    s_nop 0
    v_mfma_f32_4x4x4_16b_bf16 v[236:239], v[152:153], v[198:199], v[236:239]
    v_mfma_f32_4x4x4_16b_bf16 v[224:227], v[248:249], v[200:201], 0
    v_mfma_f32_4x4x4_16b_bf16 v[228:231], v[250:251], v[202:203], 0
    v_mfma_f32_4x4x4_16b_bf16 v[240:243], v[252:253], v[200:201], 0
    s_add_u32 s36, s35, 65536
    s_nop 0
    ds_write_b32 v193, v236 offset:0
    ds_write_b32 v193, v232 offset:256
    v_mfma_f32_4x4x4_16b_bf16 v[240:243], v[254:255], v[202:203], v[240:243]
    v_cvt_pk_bf16_f32 v200, v224, v225
    v_cvt_pk_bf16_f32 v201, v226, v227
    v_cvt_pk_bf16_f32 v202, v228, v229
    v_cvt_pk_bf16_f32 v203, v230, v231
    buffer_store_dwordx4 v[200:203], v9, s[4:7], s36 offen sc0 sc1
    v_mfma_f32_4x4x4_16b_bf16 v[244:247], v[152:153], v[200:201], 0
    s_nop 0
    s_nop 0
    v_mfma_f32_4x4x4_16b_bf16 v[244:247], v[152:153], v[202:203], v[244:247]
    v_mfma_f32_4x4x4_16b_bf16 v[224:227], v[248:249], v[204:205], 0
    v_mfma_f32_4x4x4_16b_bf16 v[228:231], v[250:251], v[206:207], 0
    v_mfma_f32_4x4x4_16b_bf16 v[232:235], v[252:253], v[204:205], 0
    s_add_u32 s36, s35, 131072
    s_nop 0
    ds_write_b32 v193, v244 offset:512
    ds_write_b32 v193, v240 offset:768
    v_mfma_f32_4x4x4_16b_bf16 v[232:235], v[254:255], v[206:207], v[232:235]
    v_cvt_pk_bf16_f32 v204, v224, v225
    v_cvt_pk_bf16_f32 v205, v226, v227
    v_cvt_pk_bf16_f32 v206, v228, v229
    v_cvt_pk_bf16_f32 v207, v230, v231
    buffer_store_dwordx4 v[204:207], v9, s[4:7], s36 offen sc0 sc1
    v_mfma_f32_4x4x4_16b_bf16 v[236:239], v[152:153], v[204:205], 0
    s_nop 0
    s_nop 0
    v_mfma_f32_4x4x4_16b_bf16 v[236:239], v[152:153], v[206:207], v[236:239]
    v_mfma_f32_4x4x4_16b_bf16 v[224:227], v[248:249], v[208:209], 0
    v_mfma_f32_4x4x4_16b_bf16 v[228:231], v[250:251], v[210:211], 0
    v_mfma_f32_4x4x4_16b_bf16 v[240:243], v[252:253], v[208:209], 0
    s_add_u32 s36, s35, 196608
    s_nop 0
    ds_write_b32 v193, v236 offset:1024
    ds_write_b32 v193, v232 offset:1280
    v_mfma_f32_4x4x4_16b_bf16 v[240:243], v[254:255], v[210:211], v[240:243]
    v_cvt_pk_bf16_f32 v208, v224, v225
    v_cvt_pk_bf16_f32 v209, v226, v227
    v_cvt_pk_bf16_f32 v210, v228, v229
    v_cvt_pk_bf16_f32 v211, v230, v231
    buffer_store_dwordx4 v[208:211], v9, s[4:7], s36 offen sc0 sc1
    v_mfma_f32_4x4x4_16b_bf16 v[244:247], v[152:153], v[208:209], 0
    s_nop 0
    s_nop 0
    v_mfma_f32_4x4x4_16b_bf16 v[244:247], v[152:153], v[210:211], v[244:247]
    v_mfma_f32_4x4x4_16b_bf16 v[224:227], v[248:249], v[212:213], 0
    v_mfma_f32_4x4x4_16b_bf16 v[228:231], v[250:251], v[214:215], 0
    v_mfma_f32_4x4x4_16b_bf16 v[232:235], v[252:253], v[212:213], 0
    s_add_u32 s36, s35, 262144
    s_nop 0
    ds_write_b32 v193, v244 offset:1536
    ds_write_b32 v193, v240 offset:1792
    v_mfma_f32_4x4x4_16b_bf16 v[232:235], v[254:255], v[214:215], v[232:235]
    v_cvt_pk_bf16_f32 v212, v224, v225
    v_cvt_pk_bf16_f32 v213, v226, v227
    v_cvt_pk_bf16_f32 v214, v228, v229
    v_cvt_pk_bf16_f32 v215, v230, v231
    buffer_store_dwordx4 v[212:215], v9, s[4:7], s36 offen sc0 sc1
    v_mfma_f32_4x4x4_16b_bf16 v[236:239], v[152:153], v[212:213], 0
    s_nop 0
    s_nop 0
    v_mfma_f32_4x4x4_16b_bf16 v[236:239], v[152:153], v[214:215], v[236:239]
    v_mfma_f32_4x4x4_16b_bf16 v[224:227], v[248:249], v[216:217], 0
    v_mfma_f32_4x4x4_16b_bf16 v[228:231], v[250:251], v[218:219], 0
    v_mfma_f32_4x4x4_16b_bf16 v[240:243], v[252:253], v[216:217], 0
    s_add_u32 s36, s35, 327680
    s_nop 0
    ds_write_b32 v193, v236 offset:2048
    ds_write_b32 v193, v232 offset:2304
    v_mfma_f32_4x4x4_16b_bf16 v[240:243], v[254:255], v[218:219], v[240:243]
    v_cvt_pk_bf16_f32 v216, v224, v225
    v_cvt_pk_bf16_f32 v217, v226, v227
    v_cvt_pk_bf16_f32 v218, v228, v229
    v_cvt_pk_bf16_f32 v219, v230, v231
    buffer_store_dwordx4 v[216:219], v9, s[4:7], s36 offen sc0 sc1
    v_mfma_f32_4x4x4_16b_bf16 v[244:247], v[152:153], v[216:217], 0
    s_nop 0
    s_nop 0
    v_mfma_f32_4x4x4_16b_bf16 v[244:247], v[152:153], v[218:219], v[244:247]
    v_mfma_f32_4x4x4_16b_bf16 v[224:227], v[248:249], v[220:221], 0
    v_mfma_f32_4x4x4_16b_bf16 v[228:231], v[250:251], v[222:223], 0
    v_mfma_f32_4x4x4_16b_bf16 v[232:235], v[252:253], v[220:221], 0
    s_add_u32 s36, s35, 393216
    s_nop 0
    ds_write_b32 v193, v244 offset:2560
    ds_write_b32 v193, v240 offset:2816
    v_mfma_f32_4x4x4_16b_bf16 v[232:235], v[254:255], v[222:223], v[232:235]
    v_cvt_pk_bf16_f32 v220, v224, v225
    v_cvt_pk_bf16_f32 v221, v226, v227
    v_cvt_pk_bf16_f32 v222, v228, v229
    v_cvt_pk_bf16_f32 v223, v230, v231
    buffer_store_dwordx4 v[220:223], v9, s[4:7], s36 offen sc0 sc1
    v_mfma_f32_4x4x4_16b_bf16 v[236:239], v[152:153], v[220:221], 0
    s_nop 0
    s_nop 0
    v_mfma_f32_4x4x4_16b_bf16 v[236:239], v[152:153], v[222:223], v[236:239]
    s_nop 4
    ds_write_b32 v193, v236 offset:3072
    ds_write_b32 v193, v232 offset:3328
    s_cmp_eq_u32 s22, 7
    s_cbranch_scc1 L_k3_pret
    v_lshl_add_u32 v192, v188, 11, v189
    s_mov_b64 s[60:61], s[72:73]
    s_mov_b32 s62, s74
    s_mul_i32 s52, s2, 7
    s_add_u32 s52, s52, s22
    s_lshr_b32 s53, s52, 3
    s_and_b32 s52, s52, 7
    s_lshl_b32 s70, s53, 15
    s_lshl_b32 s54, s52, 8
    s_add_u32 s70, s70, s54
    s_mul_i32 s52, s52, 917504
    s_lshl_b32 s53, s53, 10
    s_add_u32 s52, s52, s53
    s_add_u32 s52, s52, 20971520
    s_mov_b32 s71, 8192
    s_add_u32 s69, s37, 4096
    s_mov_b32 s68, 4
    s_branch L_k3_pret
L_k3_p6:
    s_cmp_eq_u32 s22, 7
    s_cbranch_scc1 L_k3_pret
    v_lshrrev_b32 v188, 4, v8
    v_lshlrev_b32 v193, 2, v188
    v_and_b32 v189, 15, v8
    v_xor_b32 v189, v193, v189
    v_lshlrev_b32 v189, 4, v189
    v_bfe_u32 v190, v8, 1, 1
    v_lshlrev_b32 v190, 3, v190
    v_and_b32 v193, 1, v8
    v_lshl_or_b32 v190, v193, 4, v190
    v_bfe_u32 v193, v8, 4, 1
    v_lshl_or_b32 v190, v193, 5, v190
    v_bfe_u32 v193, v8, 2, 2
    v_lshl_or_b32 v190, v193, 6, v190
    v_lshl_or_b32 v190, v193, 8, v190
    v_bfe_u32 v193, v8, 5, 1
    v_lshl_or_b32 v190, v193, 11, v190
    s_add_u32 s36, s37, 4096
    v_add_u32 v190, s36, v190
    v_xor_b32 v220, 0, v190
    v_xor_b32 v221, 64, v190
    v_xor_b32 v222, 128, v190
    v_xor_b32 v223, 192, v190
    ds_read_b64_tr_b16 v[196:197], v220
    ds_read_b64_tr_b16 v[198:199], v220 offset:1024
    ds_read_b64_tr_b16 v[200:201], v221
    ds_read_b64_tr_b16 v[202:203], v221 offset:1024
    ds_read_b64_tr_b16 v[204:205], v222
    ds_read_b64_tr_b16 v[206:207], v222 offset:1024
    ds_read_b64_tr_b16 v[208:209], v223
    ds_read_b64_tr_b16 v[210:211], v223 offset:1024
    s_add_u32 s36, s52, 0
    s_waitcnt lgkmcnt(6)
    buffer_store_dwordx4 v[196:199], v9, s[4:7], s36 offen sc0 sc1
    s_add_u32 s36, s52, 229376
    s_waitcnt lgkmcnt(4)
    buffer_store_dwordx4 v[200:203], v9, s[4:7], s36 offen sc0 sc1
    s_add_u32 s36, s52, 458752
    s_waitcnt lgkmcnt(2)
    buffer_store_dwordx4 v[204:207], v9, s[4:7], s36 offen sc0 sc1
    s_add_u32 s36, s52, 688128
    s_waitcnt lgkmcnt(0)
    buffer_store_dwordx4 v[208:211], v9, s[4:7], s36 offen sc0 sc1
    s_branch L_k3_pret
L_k3_p5:
    s_cmp_ge_u32 s2, 32
    s_cbranch_scc1 L_k3_nomf2
    s_cmp_lg_u32 s22, 5
    s_cbranch_scc1 L_k3_nomf2
    v_add_f32 v12, v12, v13
    v_cvt_pk_bf16_f32 v12, v12, v12
    v_lshlrev_b32 v12, 16, v12
    s_add_u32 s78, s78, 73728
    buffer_store_dword v12, v10, s[4:7], s78 offen
L_k3_nomf2:
    s_cmp_eq_u32 s22, 7
    s_cbranch_scc1 L_k3_p5ret
    v_lshrrev_b32 v193, 5, v0
    v_lshlrev_b32 v193, 8, v193
    v_and_b32 v220, 31, v0
    v_lshl_add_u32 v193, v220, 2, v193
    v_add_u32 v193, 98304, v193
    ds_read_b32 v196, v193 offset:0
    ds_read_b32 v197, v193 offset:128
    ds_read_b32 v198, v193 offset:8192
    ds_read_b32 v199, v193 offset:8320
    ds_read_b32 v200, v193 offset:16384
    ds_read_b32 v201, v193 offset:16512
    ds_read_b32 v202, v193 offset:24576
    ds_read_b32 v203, v193 offset:24704
    ds_read_b32 v204, v193 offset:32768
    ds_read_b32 v205, v193 offset:32896
    ds_read_b32 v206, v193 offset:40960
    ds_read_b32 v207, v193 offset:41088
    ds_read_b32 v208, v193 offset:49152
    ds_read_b32 v209, v193 offset:49280
    s_waitcnt lgkmcnt(0)
    ds_read_b32 v210, v193 offset:57344
    ds_read_b32 v211, v193 offset:57472
    s_waitcnt lgkmcnt(0)
    v_add_f32 v196, v196, v204
    v_add_f32 v197, v197, v205
    v_add_f32 v198, v198, v206
    v_add_f32 v199, v199, v207
    v_add_f32 v200, v200, v208
    v_add_f32 v201, v201, v209
    v_add_f32 v202, v202, v210
    v_add_f32 v203, v203, v211
    v_add_f32 v196, v196, v200
    v_add_f32 v197, v197, v201
    v_add_f32 v198, v198, v202
    v_add_f32 v199, v199, v203
    v_add_f32 v196, v196, v198
    v_add_f32 v197, v197, v199
    v_add_f32 v196, v196, v197
    s_mul_i32 s36, s28, 224
    s_mul_i32 s35, s29, 7
    s_add_u32 s36, s36, s35
    s_lshl_b32 s36, s36, 8
    s_add_u32 s36, s36, 458752
    v_lshlrev_b32 v220, 2, v0
    buffer_store_dword v196, v220, s[4:7], s36 offen
    s_branch L_k3_p5ret
L_k3_kernel_end:
L_k3_kernel_exit:
    s_endpgm

.globl k4_kernel
.p2align 8
.type k4_kernel,@function
k4_kernel:
    s_cmp_ge_u32 s2, 256
    s_cbranch_scc1 L_k4_kernel_exit
    s_load_dwordx2 s[4:5], s[0:1], 104
    s_load_dwordx2 s[24:25], s[0:1], 0
    v_lshrrev_b32 v1, 6, v0
    s_nop 0
    v_readfirstlane_b32 s22, v1
    s_mov_b32 s6, 268435456
    s_mov_b32 s7, 0x00020000
    s_mov_b32 s26, 4194304
    s_mov_b32 s27, 0x00020000
    s_and_b32 s8, s2, 7
    s_lshr_b32 s9, s2, 3
    s_and_b32 s10, s8, 3
    s_mul_i32 s10, s10, 4
    s_and_b32 s11, s9, 3
    s_add_u32 s10, s10, s11
    s_lshr_b32 s12, s8, 2
    s_mul_i32 s12, s12, 8
    s_lshr_b32 s11, s9, 2
    s_add_u32 s12, s12, s11
    s_mul_i32 s20, s12, 2
    s_mul_i32 s21, s10, 4
    v_and_b32 v6, 63, v0
    v_lshlrev_b32 v6, 4, v6
    s_add_u32 s43, s22, 0
    s_mul_i32 s49, s43, 2048
    s_and_b32 s39, s43, 1
    s_mul_i32 s39, s39, 2048
    s_lshr_b32 s43, s43, 1
    s_add_u32 s44, s43, s20
    s_mul_i32 s44, s44, 65536
    s_add_u32 s44, s44, 4194304
    s_add_u32 s46, s43, s21
    s_mul_i32 s46, s46, 65536
    s_add_u32 s46, s46, 12451840
    s_cmp_lt_u32 s43, 2
    s_cselect_b32 s46, s44, s46
    s_add_u32 s46, s46, s39
    s_add_u32 m0, s49, 0
    s_waitcnt lgkmcnt(0)
    buffer_load_dwordx4 v6, s[4:7], s46 offen offset:0 lds
    buffer_load_dwordx4 v6, s[4:7], s46 offen offset:1024 lds
    s_add_u32 s43, s22, 4
    s_mul_i32 s50, s43, 2048
    s_and_b32 s39, s43, 1
    s_mul_i32 s39, s39, 2048
    s_lshr_b32 s43, s43, 1
    s_add_u32 s44, s43, s20
    s_mul_i32 s44, s44, 65536
    s_add_u32 s44, s44, 4194304
    s_add_u32 s47, s43, s21
    s_mul_i32 s47, s47, 65536
    s_add_u32 s47, s47, 12451840
    s_cmp_lt_u32 s43, 2
    s_cselect_b32 s47, s44, s47
    s_add_u32 s47, s47, s39
    s_add_u32 m0, s50, 0
    s_nop 0
    buffer_load_dwordx4 v6, s[4:7], s47 offen offset:0 lds
    buffer_load_dwordx4 v6, s[4:7], s47 offen offset:1024 lds
    s_add_u32 s43, s22, 8
    s_mul_i32 s51, s43, 2048
    s_and_b32 s39, s43, 1
    s_mul_i32 s39, s39, 2048
    s_lshr_b32 s43, s43, 1
    s_add_u32 s44, s43, s20
    s_mul_i32 s44, s44, 65536
    s_add_u32 s44, s44, 4194304
    s_add_u32 s48, s43, s21
    s_mul_i32 s48, s48, 65536
    s_add_u32 s48, s48, 12451840
    s_cmp_lt_u32 s43, 2
    s_cselect_b32 s48, s44, s48
    s_add_u32 s48, s48, s39
    s_add_u32 m0, s51, 0
    s_nop 0
    buffer_load_dwordx4 v6, s[4:7], s48 offen offset:0 lds
    buffer_load_dwordx4 v6, s[4:7], s48 offen offset:1024 lds
    v_add_u32 v6, 4096, v6
    s_add_u32 m0, s49, 24576
    s_nop 0
    buffer_load_dwordx4 v6, s[4:7], s46 offen offset:0 lds
    buffer_load_dwordx4 v6, s[4:7], s46 offen offset:1024 lds
    s_add_u32 m0, s50, 24576
    s_nop 0
    buffer_load_dwordx4 v6, s[4:7], s47 offen offset:0 lds
    buffer_load_dwordx4 v6, s[4:7], s47 offen offset:1024 lds
    s_add_u32 m0, s51, 24576
    s_nop 0
    buffer_load_dwordx4 v6, s[4:7], s48 offen offset:0 lds
    buffer_load_dwordx4 v6, s[4:7], s48 offen offset:1024 lds
    v_add_u32 v6, 4096, v6
    s_add_u32 m0, s49, 49152
    s_nop 0
    buffer_load_dwordx4 v6, s[4:7], s46 offen offset:0 lds
    buffer_load_dwordx4 v6, s[4:7], s46 offen offset:1024 lds
    s_add_u32 m0, s50, 49152
    s_nop 0
    buffer_load_dwordx4 v6, s[4:7], s47 offen offset:0 lds
    buffer_load_dwordx4 v6, s[4:7], s47 offen offset:1024 lds
    s_add_u32 m0, s51, 49152
    s_nop 0
    buffer_load_dwordx4 v6, s[4:7], s48 offen offset:0 lds
    buffer_load_dwordx4 v6, s[4:7], s48 offen offset:1024 lds
    v_add_u32 v6, 4096, v6
    s_add_u32 m0, s49, 73728
    s_nop 0
    buffer_load_dwordx4 v6, s[4:7], s46 offen offset:0 lds
    buffer_load_dwordx4 v6, s[4:7], s46 offen offset:1024 lds
    s_add_u32 m0, s50, 73728
    s_nop 0
    buffer_load_dwordx4 v6, s[4:7], s47 offen offset:0 lds
    buffer_load_dwordx4 v6, s[4:7], s47 offen offset:1024 lds
    s_add_u32 m0, s51, 73728
    s_nop 0
    buffer_load_dwordx4 v6, s[4:7], s48 offen offset:0 lds
    buffer_load_dwordx4 v6, s[4:7], s48 offen offset:1024 lds
    v_add_u32 v6, 4096, v6
    v_and_b32 v4, 63, v0
    v_lshlrev_b32 v4, 4, v4
    s_and_b32 s43, s22, 0
    s_mul_i32 s43, s43, 8192
    v_add_u32 v2, s43, v4
    s_lshr_b32 s43, s22, 0
    s_mul_i32 s43, s43, 4096
    s_add_u32 s43, s43, 8192
    v_add_u32 v3, s43, v4
    v_and_b32 v8, 63, v0
    v_lshlrev_b32 v9, 4, v8
    v_and_b32 v10, 31, v8
    v_lshrrev_b32 v11, 5, v8
    v_lshlrev_b32 v12, 11, v10
    v_lshl_add_u32 v12, v11, 4, v12
    v_lshlrev_b32 v13, 5, v11
    s_add_u32 s13, s21, s22
    s_lshl_b32 s14, s13, 16
    s_lshl_b32 s15, s20, 6
    s_add_u32 s14, s14, s15
    s_lshl_b32 s15, s20, 11
    s_lshl_b32 s16, s13, 16
    s_add_u32 s16, s16, s15
    s_add_u32 s16, s16, 16777216
    s_lshl_b32 s15, s20, 7
    s_add_u32 s15, s15, 139264
    s_mul_i32 s18, s2, 224
    v_lshlrev_b32 v15, 2, v8
    s_cmp_lg_u32 s22, 3
    s_cbranch_scc1 L_ct_k4_skip
    s_getpc_b64 s[28:29]
L_ct_k4:
    v_and_b32 v7, 63, v0
    v_lshlrev_b32 v7, 7, v7
    s_mov_b32 s30, L_k4_kernel_exit-L_ct_k4-4
    v_min_u32 v14, s30, v7
    global_load_dword v200, v14, s[28:29]
L_ct_k4_skip:
    v_mov_b32 v16, 0
    v_mov_b32 v17, 0
    v_mov_b32 v18, 0
    v_mov_b32 v19, 0
    v_mov_b32 v20, 0
    v_mov_b32 v21, 0
    v_mov_b32 v22, 0
    v_mov_b32 v23, 0
    v_mov_b32 v24, 0
    v_mov_b32 v25, 0
    v_mov_b32 v26, 0
    v_mov_b32 v27, 0
    v_mov_b32 v28, 0
    v_mov_b32 v29, 0
    v_mov_b32 v30, 0
    v_mov_b32 v31, 0
    v_mov_b32 v32, 0
    v_mov_b32 v33, 0
    v_mov_b32 v34, 0
    v_mov_b32 v35, 0
    v_mov_b32 v36, 0
    v_mov_b32 v37, 0
    v_mov_b32 v38, 0
    v_mov_b32 v39, 0
    v_mov_b32 v40, 0
    v_mov_b32 v41, 0
    v_mov_b32 v42, 0
    v_mov_b32 v43, 0
    v_mov_b32 v44, 0
    v_mov_b32 v45, 0
    v_mov_b32 v46, 0
    v_mov_b32 v47, 0
    s_mov_b32 s40, 0
    v_mov_b32 v4, v2
    v_mov_b32 v5, v3
    s_waitcnt vmcnt(18)
    s_barrier
    ds_read_b128 v[96:99], v4 offset:0
    ds_read_b128 v[104:107], v5 offset:0
    ds_read_b128 v[100:103], v4 offset:4096
    ds_read_b128 v[108:111], v4 offset:1024
    ds_read_b128 v[116:119], v5 offset:1024
    ds_read_b128 v[112:115], v4 offset:5120
    ds_read_b128 v[120:123], v4 offset:2048
    ds_read_b128 v[128:131], v5 offset:2048
    ds_read_b128 v[124:127], v4 offset:6144
    ds_read_b128 v[132:135], v4 offset:3072
    ds_read_b128 v[140:143], v5 offset:3072
    ds_read_b128 v[136:139], v4 offset:7168
    s_mov_b32 s40, 24576
    s_mov_b32 s41, 0
    v_add_u32 v4, 24576, v2
    v_add_u32 v5, 24576, v3
    s_waitcnt vmcnt(12) lgkmcnt(0)
    s_barrier
    v_mfma_f32_32x32x16_bf16 v[16:31], v[96:99], v[104:107], v[16:31]
    ds_read_b128 v[144:147], v4 offset:0
    ds_read_b128 v[152:155], v5 offset:0
    s_add_u32 m0, s49, 98304
    s_nop 0
    buffer_load_dwordx4 v6, s[4:7], s46 offen offset:0 lds
    buffer_load_dwordx4 v6, s[4:7], s46 offen offset:1024 lds
    s_add_u32 m0, s50, 98304
    v_mfma_f32_32x32x16_bf16 v[32:47], v[100:103], v[104:107], v[32:47]
    ds_read_b128 v[148:151], v4 offset:4096
    ds_read_b128 v[156:159], v4 offset:1024
    buffer_load_dwordx4 v6, s[4:7], s47 offen offset:0 lds
    v_mfma_f32_32x32x16_bf16 v[16:31], v[108:111], v[116:119], v[16:31]
    ds_read_b128 v[164:167], v5 offset:1024
    ds_read_b128 v[160:163], v4 offset:5120
    buffer_load_dwordx4 v6, s[4:7], s47 offen offset:1024 lds
    s_add_u32 m0, s51, 98304
    s_nop 0
    buffer_load_dwordx4 v6, s[4:7], s48 offen offset:0 lds
    v_mfma_f32_32x32x16_bf16 v[32:47], v[112:115], v[116:119], v[32:47]
    ds_read_b128 v[168:171], v4 offset:2048
    ds_read_b128 v[176:179], v5 offset:2048
    buffer_load_dwordx4 v6, s[4:7], s48 offen offset:1024 lds
    v_add_u32 v6, 4096, v6
    s_add_u32 m0, s49, 122880
    v_mfma_f32_32x32x16_bf16 v[16:31], v[120:123], v[128:131], v[16:31]
    ds_read_b128 v[172:175], v4 offset:6144
    ds_read_b128 v[180:183], v4 offset:3072
    buffer_load_dwordx4 v6, s[4:7], s46 offen offset:0 lds
    buffer_load_dwordx4 v6, s[4:7], s46 offen offset:1024 lds
    s_add_u32 m0, s50, 122880
    v_mfma_f32_32x32x16_bf16 v[32:47], v[124:127], v[128:131], v[32:47]
    ds_read_b128 v[188:191], v5 offset:3072
    ds_read_b128 v[184:187], v4 offset:7168
    buffer_load_dwordx4 v6, s[4:7], s47 offen offset:0 lds
    v_mfma_f32_32x32x16_bf16 v[16:31], v[132:135], v[140:143], v[16:31]
    buffer_load_dwordx4 v6, s[4:7], s47 offen offset:1024 lds
    s_add_u32 m0, s51, 122880
    s_nop 0
    buffer_load_dwordx4 v6, s[4:7], s48 offen offset:0 lds
    v_mfma_f32_32x32x16_bf16 v[32:47], v[136:139], v[140:143], v[32:47]
    buffer_load_dwordx4 v6, s[4:7], s48 offen offset:1024 lds
    v_add_u32 v6, 4096, v6
    s_add_u32 s41, s40, 24576
    s_cmp_eq_u32 s41, 147456
    s_cselect_b32 s41, 0, s41
    v_add_u32 v4, s41, v2
    v_add_u32 v5, s41, v3
    s_waitcnt vmcnt(18) lgkmcnt(0)
    s_barrier
    v_mfma_f32_32x32x16_bf16 v[16:31], v[144:147], v[152:155], v[16:31]
    ds_read_b128 v[96:99], v4 offset:0
    ds_read_b128 v[104:107], v5 offset:0
    s_add_u32 m0, s49, 0
    s_nop 0
    buffer_load_dwordx4 v6, s[4:7], s46 offen offset:0 lds
    buffer_load_dwordx4 v6, s[4:7], s46 offen offset:1024 lds
    s_add_u32 m0, s50, 0
    v_mfma_f32_32x32x16_bf16 v[32:47], v[148:151], v[152:155], v[32:47]
    ds_read_b128 v[100:103], v4 offset:4096
    ds_read_b128 v[108:111], v4 offset:1024
    buffer_load_dwordx4 v6, s[4:7], s47 offen offset:0 lds
    v_mfma_f32_32x32x16_bf16 v[16:31], v[156:159], v[164:167], v[16:31]
    ds_read_b128 v[116:119], v5 offset:1024
    ds_read_b128 v[112:115], v4 offset:5120
    buffer_load_dwordx4 v6, s[4:7], s47 offen offset:1024 lds
    s_add_u32 m0, s51, 0
    s_nop 0
    buffer_load_dwordx4 v6, s[4:7], s48 offen offset:0 lds
    v_mfma_f32_32x32x16_bf16 v[32:47], v[160:163], v[164:167], v[32:47]
    ds_read_b128 v[120:123], v4 offset:2048
    ds_read_b128 v[128:131], v5 offset:2048
    buffer_load_dwordx4 v6, s[4:7], s48 offen offset:1024 lds
    v_add_u32 v6, 4096, v6
    s_add_u32 m0, s49, 24576
    v_mfma_f32_32x32x16_bf16 v[16:31], v[168:171], v[176:179], v[16:31]
    ds_read_b128 v[124:127], v4 offset:6144
    ds_read_b128 v[132:135], v4 offset:3072
    buffer_load_dwordx4 v6, s[4:7], s46 offen offset:0 lds
    buffer_load_dwordx4 v6, s[4:7], s46 offen offset:1024 lds
    s_add_u32 m0, s50, 24576
    v_mfma_f32_32x32x16_bf16 v[32:47], v[172:175], v[176:179], v[32:47]
    ds_read_b128 v[140:143], v5 offset:3072
    ds_read_b128 v[136:139], v4 offset:7168
    buffer_load_dwordx4 v6, s[4:7], s47 offen offset:0 lds
    v_mfma_f32_32x32x16_bf16 v[16:31], v[180:183], v[188:191], v[16:31]
    buffer_load_dwordx4 v6, s[4:7], s47 offen offset:1024 lds
    s_add_u32 m0, s51, 24576
    s_nop 0
    buffer_load_dwordx4 v6, s[4:7], s48 offen offset:0 lds
    v_mfma_f32_32x32x16_bf16 v[32:47], v[184:187], v[188:191], v[32:47]
    buffer_load_dwordx4 v6, s[4:7], s48 offen offset:1024 lds
    v_add_u32 v6, 4096, v6
    s_add_u32 s40, s41, 24576
    s_cmp_eq_u32 s40, 147456
    s_cselect_b32 s40, 0, s40
    v_add_u32 v4, s40, v2
    v_add_u32 v5, s40, v3
    s_mov_b32 s42, 4
.p2align 6
L_k4_loop:
    s_waitcnt vmcnt(24) lgkmcnt(0)
    s_barrier
    v_mfma_f32_32x32x16_bf16 v[16:31], v[96:99], v[104:107], v[16:31]
    ds_read_b128 v[144:147], v4 offset:0
    ds_read_b128 v[152:155], v5 offset:0
    s_add_u32 m0, s41, s49
    s_nop 0
    buffer_load_dwordx4 v6, s[4:7], s46 offen offset:0 lds
    v_mfma_f32_32x32x16_bf16 v[32:47], v[100:103], v[104:107], v[32:47]
    ds_read_b128 v[148:151], v4 offset:4096
    ds_read_b128 v[156:159], v4 offset:1024
    buffer_load_dwordx4 v6, s[4:7], s46 offen offset:1024 lds
    s_add_u32 m0, s41, s50
    v_mfma_f32_32x32x16_bf16 v[16:31], v[108:111], v[116:119], v[16:31]
    ds_read_b128 v[164:167], v5 offset:1024
    ds_read_b128 v[160:163], v4 offset:5120
    buffer_load_dwordx4 v6, s[4:7], s47 offen offset:0 lds
    v_mfma_f32_32x32x16_bf16 v[32:47], v[112:115], v[116:119], v[32:47]
    ds_read_b128 v[168:171], v4 offset:2048
    ds_read_b128 v[176:179], v5 offset:2048
    v_mfma_f32_32x32x16_bf16 v[16:31], v[120:123], v[128:131], v[16:31]
    ds_read_b128 v[172:175], v4 offset:6144
    ds_read_b128 v[180:183], v4 offset:3072
    buffer_load_dwordx4 v6, s[4:7], s47 offen offset:1024 lds
    s_add_u32 m0, s41, s51
    v_mfma_f32_32x32x16_bf16 v[32:47], v[124:127], v[128:131], v[32:47]
    ds_read_b128 v[188:191], v5 offset:3072
    ds_read_b128 v[184:187], v4 offset:7168
    buffer_load_dwordx4 v6, s[4:7], s48 offen offset:0 lds
    v_mfma_f32_32x32x16_bf16 v[16:31], v[132:135], v[140:143], v[16:31]
    buffer_load_dwordx4 v6, s[4:7], s48 offen offset:1024 lds
    v_add_u32 v6, 4096, v6
    s_add_u32 s41, s40, 24576
    s_cmp_eq_u32 s41, 147456
    s_cselect_b32 s41, 0, s41
    v_add_u32 v4, s41, v2
    v_mfma_f32_32x32x16_bf16 v[32:47], v[136:139], v[140:143], v[32:47]
    v_add_u32 v5, s41, v3
    s_waitcnt vmcnt(24) lgkmcnt(0)
    s_barrier
    v_mfma_f32_32x32x16_bf16 v[16:31], v[144:147], v[152:155], v[16:31]
    ds_read_b128 v[96:99], v4 offset:0
    ds_read_b128 v[104:107], v5 offset:0
    s_add_u32 m0, s40, s49
    s_nop 0
    buffer_load_dwordx4 v6, s[4:7], s46 offen offset:0 lds
    v_mfma_f32_32x32x16_bf16 v[32:47], v[148:151], v[152:155], v[32:47]
    ds_read_b128 v[100:103], v4 offset:4096
    ds_read_b128 v[108:111], v4 offset:1024
    buffer_load_dwordx4 v6, s[4:7], s46 offen offset:1024 lds
    s_add_u32 m0, s40, s50
    v_mfma_f32_32x32x16_bf16 v[16:31], v[156:159], v[164:167], v[16:31]
    ds_read_b128 v[116:119], v5 offset:1024
    ds_read_b128 v[112:115], v4 offset:5120
    buffer_load_dwordx4 v6, s[4:7], s47 offen offset:0 lds
    v_mfma_f32_32x32x16_bf16 v[32:47], v[160:163], v[164:167], v[32:47]
    ds_read_b128 v[120:123], v4 offset:2048
    ds_read_b128 v[128:131], v5 offset:2048
    v_mfma_f32_32x32x16_bf16 v[16:31], v[168:171], v[176:179], v[16:31]
    ds_read_b128 v[124:127], v4 offset:6144
    ds_read_b128 v[132:135], v4 offset:3072
    buffer_load_dwordx4 v6, s[4:7], s47 offen offset:1024 lds
    s_add_u32 m0, s40, s51
    v_mfma_f32_32x32x16_bf16 v[32:47], v[172:175], v[176:179], v[32:47]
    ds_read_b128 v[140:143], v5 offset:3072
    ds_read_b128 v[136:139], v4 offset:7168
    buffer_load_dwordx4 v6, s[4:7], s48 offen offset:0 lds
    v_mfma_f32_32x32x16_bf16 v[16:31], v[180:183], v[188:191], v[16:31]
    buffer_load_dwordx4 v6, s[4:7], s48 offen offset:1024 lds
    v_add_u32 v6, 4096, v6
    s_add_u32 s40, s41, 24576
    s_cmp_eq_u32 s40, 147456
    s_cselect_b32 s40, 0, s40
    v_add_u32 v4, s40, v2
    v_mfma_f32_32x32x16_bf16 v[32:47], v[184:187], v[188:191], v[32:47]
    v_add_u32 v5, s40, v3
    s_sub_u32 s42, s42, 1
    s_cmp_lg_u32 s42, 0
    s_cbranch_scc1 L_k4_loop
    s_waitcnt vmcnt(24) lgkmcnt(0)
    s_barrier
    v_mfma_f32_32x32x16_bf16 v[16:31], v[96:99], v[104:107], v[16:31]
    ds_read_b128 v[144:147], v4 offset:0
    ds_read_b128 v[152:155], v5 offset:0
    buffer_load_dwordx4 v[48:51], v12, s[24:27], s14 offen offset:0
    v_mfma_f32_32x32x16_bf16 v[32:47], v[100:103], v[104:107], v[32:47]
    ds_read_b128 v[148:151], v4 offset:4096
    ds_read_b128 v[156:159], v4 offset:1024
    buffer_load_dwordx4 v[52:55], v12, s[24:27], s14 offen offset:32
    v_mfma_f32_32x32x16_bf16 v[16:31], v[108:111], v[116:119], v[16:31]
    ds_read_b128 v[164:167], v5 offset:1024
    ds_read_b128 v[160:163], v4 offset:5120
    buffer_load_dwordx4 v[56:59], v12, s[24:27], s14 offen offset:64
    v_mfma_f32_32x32x16_bf16 v[32:47], v[112:115], v[116:119], v[32:47]
    ds_read_b128 v[168:171], v4 offset:2048
    ds_read_b128 v[176:179], v5 offset:2048
    buffer_load_dwordx4 v[60:63], v12, s[24:27], s14 offen offset:96
    v_mfma_f32_32x32x16_bf16 v[16:31], v[120:123], v[128:131], v[16:31]
    ds_read_b128 v[172:175], v4 offset:6144
    ds_read_b128 v[180:183], v4 offset:3072
    buffer_load_dwordx4 v[64:67], v13, s[4:7], s15 offen offset:0
    v_mfma_f32_32x32x16_bf16 v[32:47], v[124:127], v[128:131], v[32:47]
    ds_read_b128 v[188:191], v5 offset:3072
    ds_read_b128 v[184:187], v4 offset:7168
    buffer_load_dwordx4 v[68:71], v13, s[4:7], s15 offen offset:16
    v_mfma_f32_32x32x16_bf16 v[16:31], v[132:135], v[140:143], v[16:31]
    buffer_load_dwordx4 v[72:75], v13, s[4:7], s15 offen offset:64
    s_add_u32 s41, s40, 24576
    s_cmp_eq_u32 s41, 147456
    s_cselect_b32 s41, 0, s41
    v_add_u32 v4, s41, v2
    v_mfma_f32_32x32x16_bf16 v[32:47], v[136:139], v[140:143], v[32:47]
    v_add_u32 v5, s41, v3
    s_waitcnt vmcnt(25) lgkmcnt(0)
    s_barrier
    v_mfma_f32_32x32x16_bf16 v[16:31], v[144:147], v[152:155], v[16:31]
    ds_read_b128 v[96:99], v4 offset:0
    ds_read_b128 v[104:107], v5 offset:0
    buffer_load_dwordx4 v[76:79], v13, s[4:7], s15 offen offset:80
    v_mfma_f32_32x32x16_bf16 v[32:47], v[148:151], v[152:155], v[32:47]
    ds_read_b128 v[100:103], v4 offset:4096
    ds_read_b128 v[108:111], v4 offset:1024
    buffer_load_dwordx4 v[80:83], v13, s[4:7], s15 offen offset:128
    v_mfma_f32_32x32x16_bf16 v[16:31], v[156:159], v[164:167], v[16:31]
    ds_read_b128 v[116:119], v5 offset:1024
    ds_read_b128 v[112:115], v4 offset:5120
    buffer_load_dwordx4 v[84:87], v13, s[4:7], s15 offen offset:144
    v_mfma_f32_32x32x16_bf16 v[32:47], v[160:163], v[164:167], v[32:47]
    ds_read_b128 v[120:123], v4 offset:2048
    ds_read_b128 v[128:131], v5 offset:2048
    buffer_load_dwordx4 v[88:91], v13, s[4:7], s15 offen offset:192
    v_mfma_f32_32x32x16_bf16 v[16:31], v[168:171], v[176:179], v[16:31]
    ds_read_b128 v[124:127], v4 offset:6144
    ds_read_b128 v[132:135], v4 offset:3072
    buffer_load_dwordx4 v[92:95], v13, s[4:7], s15 offen offset:208
    v_mfma_f32_32x32x16_bf16 v[32:47], v[172:175], v[176:179], v[32:47]
    ds_read_b128 v[140:143], v5 offset:3072
    ds_read_b128 v[136:139], v4 offset:7168
    s_add_u32 s17, s18, 458752
    buffer_load_dword v192, v15, s[4:7], s17 offen
    v_mfma_f32_32x32x16_bf16 v[16:31], v[180:183], v[188:191], v[16:31]
    s_add_u32 s17, s18, 516096
    buffer_load_dword v193, v15, s[4:7], s17 offen
    s_add_u32 s40, s41, 24576
    s_cmp_eq_u32 s40, 147456
    s_cselect_b32 s40, 0, s40
    v_add_u32 v4, s40, v2
    v_mfma_f32_32x32x16_bf16 v[32:47], v[184:187], v[188:191], v[32:47]
    v_add_u32 v5, s40, v3
    s_waitcnt vmcnt(26) lgkmcnt(0)
    s_barrier
    v_mfma_f32_32x32x16_bf16 v[16:31], v[96:99], v[104:107], v[16:31]
    ds_read_b128 v[144:147], v4 offset:0
    ds_read_b128 v[152:155], v5 offset:0
    s_add_u32 s17, s18, 573440
    buffer_load_dword v194, v15, s[4:7], s17 offen
    v_mfma_f32_32x32x16_bf16 v[32:47], v[100:103], v[104:107], v[32:47]
    ds_read_b128 v[148:151], v4 offset:4096
    ds_read_b128 v[156:159], v4 offset:1024
    s_add_u32 s17, s18, 630784
    buffer_load_dword v195, v15, s[4:7], s17 offen
    v_mfma_f32_32x32x16_bf16 v[16:31], v[108:111], v[116:119], v[16:31]
    ds_read_b128 v[164:167], v5 offset:1024
    ds_read_b128 v[160:163], v4 offset:5120
    s_add_u32 s17, s18, 688128
    buffer_load_dword v196, v15, s[4:7], s17 offen
    v_mfma_f32_32x32x16_bf16 v[32:47], v[112:115], v[116:119], v[32:47]
    ds_read_b128 v[168:171], v4 offset:2048
    ds_read_b128 v[176:179], v5 offset:2048
    v_mfma_f32_32x32x16_bf16 v[16:31], v[120:123], v[128:131], v[16:31]
    ds_read_b128 v[172:175], v4 offset:6144
    ds_read_b128 v[180:183], v4 offset:3072
    s_add_u32 s17, s18, 745472
    buffer_load_dword v197, v15, s[4:7], s17 offen
    v_mfma_f32_32x32x16_bf16 v[32:47], v[124:127], v[128:131], v[32:47]
    ds_read_b128 v[188:191], v5 offset:3072
    ds_read_b128 v[184:187], v4 offset:7168
    s_add_u32 s17, s18, 802816
    buffer_load_dword v198, v15, s[4:7], s17 offen
    v_mfma_f32_32x32x16_bf16 v[16:31], v[132:135], v[140:143], v[16:31]
    s_add_u32 s17, s18, 860160
    buffer_load_dword v199, v15, s[4:7], s17 offen
    s_add_u32 s41, s40, 24576
    s_cmp_eq_u32 s41, 147456
    s_cselect_b32 s41, 0, s41
    v_add_u32 v4, s41, v2
    v_mfma_f32_32x32x16_bf16 v[32:47], v[136:139], v[140:143], v[32:47]
    v_add_u32 v5, s41, v3
    s_waitcnt vmcnt(26) lgkmcnt(0)
    s_barrier
    v_mfma_f32_32x32x16_bf16 v[16:31], v[144:147], v[152:155], v[16:31]
    ds_read_b128 v[96:99], v4 offset:0
    ds_read_b128 v[104:107], v5 offset:0
    v_mfma_f32_32x32x16_bf16 v[32:47], v[148:151], v[152:155], v[32:47]
    ds_read_b128 v[100:103], v4 offset:4096
    ds_read_b128 v[108:111], v4 offset:1024
    v_mfma_f32_32x32x16_bf16 v[16:31], v[156:159], v[164:167], v[16:31]
    ds_read_b128 v[116:119], v5 offset:1024
    ds_read_b128 v[112:115], v4 offset:5120
    v_mfma_f32_32x32x16_bf16 v[32:47], v[160:163], v[164:167], v[32:47]
    ds_read_b128 v[120:123], v4 offset:2048
    ds_read_b128 v[128:131], v5 offset:2048
    v_mfma_f32_32x32x16_bf16 v[16:31], v[168:171], v[176:179], v[16:31]
    ds_read_b128 v[124:127], v4 offset:6144
    ds_read_b128 v[132:135], v4 offset:3072
    v_mfma_f32_32x32x16_bf16 v[32:47], v[172:175], v[176:179], v[32:47]
    ds_read_b128 v[140:143], v5 offset:3072
    ds_read_b128 v[136:139], v4 offset:7168
    v_mfma_f32_32x32x16_bf16 v[16:31], v[180:183], v[188:191], v[16:31]
    s_add_u32 s40, s41, 24576
    s_cmp_eq_u32 s40, 147456
    s_cselect_b32 s40, 0, s40
    v_add_u32 v4, s40, v2
    v_mfma_f32_32x32x16_bf16 v[32:47], v[184:187], v[188:191], v[32:47]
    v_add_u32 v5, s40, v3
    s_waitcnt vmcnt(20) lgkmcnt(0)
    s_barrier
    v_mfma_f32_32x32x16_bf16 v[16:31], v[96:99], v[104:107], v[16:31]
    ds_read_b128 v[144:147], v4 offset:0
    ds_read_b128 v[152:155], v5 offset:0
    v_mfma_f32_32x32x16_bf16 v[32:47], v[100:103], v[104:107], v[32:47]
    ds_read_b128 v[148:151], v4 offset:4096
    ds_read_b128 v[156:159], v4 offset:1024
    v_mfma_f32_32x32x16_bf16 v[16:31], v[108:111], v[116:119], v[16:31]
    ds_read_b128 v[164:167], v5 offset:1024
    ds_read_b128 v[160:163], v4 offset:5120
    v_mfma_f32_32x32x16_bf16 v[32:47], v[112:115], v[116:119], v[32:47]
    ds_read_b128 v[168:171], v4 offset:2048
    ds_read_b128 v[176:179], v5 offset:2048
    v_mfma_f32_32x32x16_bf16 v[16:31], v[120:123], v[128:131], v[16:31]
    ds_read_b128 v[172:175], v4 offset:6144
    ds_read_b128 v[180:183], v4 offset:3072
    v_mfma_f32_32x32x16_bf16 v[32:47], v[124:127], v[128:131], v[32:47]
    ds_read_b128 v[188:191], v5 offset:3072
    ds_read_b128 v[184:187], v4 offset:7168
    v_mfma_f32_32x32x16_bf16 v[16:31], v[132:135], v[140:143], v[16:31]
    s_add_u32 s41, s40, 24576
    s_cmp_eq_u32 s41, 147456
    s_cselect_b32 s41, 0, s41
    v_add_u32 v4, s41, v2
    v_mfma_f32_32x32x16_bf16 v[32:47], v[136:139], v[140:143], v[32:47]
    v_add_u32 v5, s41, v3
    s_waitcnt lgkmcnt(0)
    v_mfma_f32_32x32x16_bf16 v[16:31], v[144:147], v[152:155], v[16:31]
    v_mfma_f32_32x32x16_bf16 v[32:47], v[148:151], v[152:155], v[32:47]
    v_mfma_f32_32x32x16_bf16 v[16:31], v[156:159], v[164:167], v[16:31]
    v_mfma_f32_32x32x16_bf16 v[32:47], v[160:163], v[164:167], v[32:47]
    v_mfma_f32_32x32x16_bf16 v[16:31], v[168:171], v[176:179], v[16:31]
    v_mfma_f32_32x32x16_bf16 v[32:47], v[172:175], v[176:179], v[32:47]
    v_mfma_f32_32x32x16_bf16 v[16:31], v[180:183], v[188:191], v[16:31]
    v_mfma_f32_32x32x16_bf16 v[32:47], v[184:187], v[188:191], v[32:47]
    s_waitcnt vmcnt(0) lgkmcnt(0)
    v_mov_b32 v104, 0
    v_mov_b32 v105, 0
    v_mov_b32 v106, 0
    v_mov_b32 v107, 0
    v_lshlrev_b32 v96, 16, v48
    v_and_b32 v97, 0xffff0000, v48
    s_nop 3
    v_pk_fma_f32 v[16:17], v[16:17], v[64:65], v[96:97]
    v_cvt_pk_bf16_f32 v48, v16, v17
    v_lshlrev_b32 v100, 16, v48
    v_and_b32 v101, 0xffff0000, v48
    v_pk_add_f32 v[104:105], v[104:105], v[100:101]
    v_pk_fma_f32 v[106:107], v[100:101], v[100:101], v[106:107]
    v_lshlrev_b32 v98, 16, v49
    v_and_b32 v99, 0xffff0000, v49
    v_pk_fma_f32 v[18:19], v[18:19], v[66:67], v[98:99]
    v_cvt_pk_bf16_f32 v49, v18, v19
    v_lshlrev_b32 v102, 16, v49
    v_and_b32 v103, 0xffff0000, v49
    v_pk_add_f32 v[104:105], v[104:105], v[102:103]
    v_pk_fma_f32 v[106:107], v[102:103], v[102:103], v[106:107]
    v_lshlrev_b32 v96, 16, v50
    v_and_b32 v97, 0xffff0000, v50
    v_pk_fma_f32 v[20:21], v[20:21], v[68:69], v[96:97]
    v_cvt_pk_bf16_f32 v50, v20, v21
    v_lshlrev_b32 v100, 16, v50
    v_and_b32 v101, 0xffff0000, v50
    v_pk_add_f32 v[104:105], v[104:105], v[100:101]
    v_pk_fma_f32 v[106:107], v[100:101], v[100:101], v[106:107]
    v_lshlrev_b32 v98, 16, v51
    v_and_b32 v99, 0xffff0000, v51
    v_pk_fma_f32 v[22:23], v[22:23], v[70:71], v[98:99]
    v_cvt_pk_bf16_f32 v51, v22, v23
    v_lshlrev_b32 v102, 16, v51
    v_and_b32 v103, 0xffff0000, v51
    v_pk_add_f32 v[104:105], v[104:105], v[102:103]
    v_pk_fma_f32 v[106:107], v[102:103], v[102:103], v[106:107]
    buffer_store_dwordx4 v[48:51], v9, s[4:7], s16 offen offset:0 sc0 sc1
    v_lshlrev_b32 v96, 16, v52
    v_and_b32 v97, 0xffff0000, v52
    v_pk_fma_f32 v[24:25], v[24:25], v[72:73], v[96:97]
    v_cvt_pk_bf16_f32 v52, v24, v25
    v_lshlrev_b32 v100, 16, v52
    v_and_b32 v101, 0xffff0000, v52
    v_pk_add_f32 v[104:105], v[104:105], v[100:101]
    v_pk_fma_f32 v[106:107], v[100:101], v[100:101], v[106:107]
    v_lshlrev_b32 v98, 16, v53
    v_and_b32 v99, 0xffff0000, v53
    v_pk_fma_f32 v[26:27], v[26:27], v[74:75], v[98:99]
    v_cvt_pk_bf16_f32 v53, v26, v27
    v_lshlrev_b32 v102, 16, v53
    v_and_b32 v103, 0xffff0000, v53
    v_pk_add_f32 v[104:105], v[104:105], v[102:103]
    v_pk_fma_f32 v[106:107], v[102:103], v[102:103], v[106:107]
    v_lshlrev_b32 v96, 16, v54
    v_and_b32 v97, 0xffff0000, v54
    v_pk_fma_f32 v[28:29], v[28:29], v[76:77], v[96:97]
    v_cvt_pk_bf16_f32 v54, v28, v29
    v_lshlrev_b32 v100, 16, v54
    v_and_b32 v101, 0xffff0000, v54
    v_pk_add_f32 v[104:105], v[104:105], v[100:101]
    v_pk_fma_f32 v[106:107], v[100:101], v[100:101], v[106:107]
    v_lshlrev_b32 v98, 16, v55
    v_and_b32 v99, 0xffff0000, v55
    v_pk_fma_f32 v[30:31], v[30:31], v[78:79], v[98:99]
    v_cvt_pk_bf16_f32 v55, v30, v31
    v_lshlrev_b32 v102, 16, v55
    v_and_b32 v103, 0xffff0000, v55
    v_pk_add_f32 v[104:105], v[104:105], v[102:103]
    v_pk_fma_f32 v[106:107], v[102:103], v[102:103], v[106:107]
    buffer_store_dwordx4 v[52:55], v9, s[4:7], s16 offen offset:1024 sc0 sc1
    v_lshlrev_b32 v96, 16, v56
    v_and_b32 v97, 0xffff0000, v56
    v_pk_fma_f32 v[32:33], v[32:33], v[80:81], v[96:97]
    v_cvt_pk_bf16_f32 v56, v32, v33
    v_lshlrev_b32 v100, 16, v56
    v_and_b32 v101, 0xffff0000, v56
    v_pk_add_f32 v[104:105], v[104:105], v[100:101]
    v_pk_fma_f32 v[106:107], v[100:101], v[100:101], v[106:107]
    v_lshlrev_b32 v98, 16, v57
    v_and_b32 v99, 0xffff0000, v57
    v_pk_fma_f32 v[34:35], v[34:35], v[82:83], v[98:99]
    v_cvt_pk_bf16_f32 v57, v34, v35
    v_lshlrev_b32 v102, 16, v57
    v_and_b32 v103, 0xffff0000, v57
    v_pk_add_f32 v[104:105], v[104:105], v[102:103]
    v_pk_fma_f32 v[106:107], v[102:103], v[102:103], v[106:107]
    v_lshlrev_b32 v96, 16, v58
    v_and_b32 v97, 0xffff0000, v58
    v_pk_fma_f32 v[36:37], v[36:37], v[84:85], v[96:97]
    v_cvt_pk_bf16_f32 v58, v36, v37
    v_lshlrev_b32 v100, 16, v58
    v_and_b32 v101, 0xffff0000, v58
    v_pk_add_f32 v[104:105], v[104:105], v[100:101]
    v_pk_fma_f32 v[106:107], v[100:101], v[100:101], v[106:107]
    v_lshlrev_b32 v98, 16, v59
    v_and_b32 v99, 0xffff0000, v59
    v_pk_fma_f32 v[38:39], v[38:39], v[86:87], v[98:99]
    v_cvt_pk_bf16_f32 v59, v38, v39
    v_lshlrev_b32 v102, 16, v59
    v_and_b32 v103, 0xffff0000, v59
    v_pk_add_f32 v[104:105], v[104:105], v[102:103]
    v_pk_fma_f32 v[106:107], v[102:103], v[102:103], v[106:107]
    buffer_store_dwordx4 v[56:59], v9, s[4:7], s16 offen offset:2048 sc0 sc1
    v_lshlrev_b32 v96, 16, v60
    v_and_b32 v97, 0xffff0000, v60
    v_pk_fma_f32 v[40:41], v[40:41], v[88:89], v[96:97]
    v_cvt_pk_bf16_f32 v60, v40, v41
    v_lshlrev_b32 v100, 16, v60
    v_and_b32 v101, 0xffff0000, v60
    v_pk_add_f32 v[104:105], v[104:105], v[100:101]
    v_pk_fma_f32 v[106:107], v[100:101], v[100:101], v[106:107]
    v_lshlrev_b32 v98, 16, v61
    v_and_b32 v99, 0xffff0000, v61
    v_pk_fma_f32 v[42:43], v[42:43], v[90:91], v[98:99]
    v_cvt_pk_bf16_f32 v61, v42, v43
    v_lshlrev_b32 v102, 16, v61
    v_and_b32 v103, 0xffff0000, v61
    v_pk_add_f32 v[104:105], v[104:105], v[102:103]
    v_pk_fma_f32 v[106:107], v[102:103], v[102:103], v[106:107]
    v_lshlrev_b32 v96, 16, v62
    v_and_b32 v97, 0xffff0000, v62
    v_pk_fma_f32 v[44:45], v[44:45], v[92:93], v[96:97]
    v_cvt_pk_bf16_f32 v62, v44, v45
    v_lshlrev_b32 v100, 16, v62
    v_and_b32 v101, 0xffff0000, v62
    v_pk_add_f32 v[104:105], v[104:105], v[100:101]
    v_pk_fma_f32 v[106:107], v[100:101], v[100:101], v[106:107]
    v_lshlrev_b32 v98, 16, v63
    v_and_b32 v99, 0xffff0000, v63
    v_pk_fma_f32 v[46:47], v[46:47], v[94:95], v[98:99]
    v_cvt_pk_bf16_f32 v63, v46, v47
    v_lshlrev_b32 v102, 16, v63
    v_and_b32 v103, 0xffff0000, v63
    v_pk_add_f32 v[104:105], v[104:105], v[102:103]
    v_pk_fma_f32 v[106:107], v[102:103], v[102:103], v[106:107]
    buffer_store_dwordx4 v[60:63], v9, s[4:7], s16 offen offset:3072 sc0 sc1
    v_add_f32 v104, v104, v105
    v_add_f32 v105, v106, v107
    v_mov_b32 v106, v104
    v_mov_b32 v107, v105
    s_nop 0
    v_permlane32_swap_b32 v104, v106
    v_permlane32_swap_b32 v105, v107
    v_pk_add_f32 v[104:105], v[104:105], v[106:107]
    v_lshlrev_b32 v14, 7, v10
    s_lshl_b32 s15, s13, 12
    s_lshl_b32 s17, s12, 3
    s_add_u32 s15, s15, s17
    s_add_u32 s15, s15, 196608
    v_cmp_eq_u32 vcc, 0, v11
    s_nop 0
    s_and_saveexec_b64 s[18:19], vcc
    buffer_store_dwordx2 v[104:105], v14, s[4:7], s15 offen
    s_mov_b64 exec, s[18:19]
    s_cmp_lg_u32 s22, 3
    s_cbranch_scc1 L_k4_kernel_end
    v_add_f32 v192, v192, v196
    v_add_f32 v193, v193, v197
    v_add_f32 v194, v194, v198
    v_add_f32 v195, v195, v199
    v_add_f32 v192, v192, v194
    v_add_f32 v193, v193, v195
    v_add_f32 v192, v192, v193
    s_mul_i32 s18, s2, 224
    s_add_u32 s17, s18, 950272
    v_cmp_gt_u32 vcc, 56, v8
    s_nop 0
    s_and_saveexec_b64 s[18:19], vcc
    buffer_store_dword v192, v15, s[4:7], s17 offen
L_k4_kernel_end:
L_k4_kernel_exit:
    s_endpgm

.globl k5_kernel
.p2align 8
.type k5_kernel,@function
k5_kernel:
    s_cmp_ge_u32 s2, 256
    s_cbranch_scc1 L_k5_kernel_exit
    s_load_dwordx2 s[4:5], s[0:1], 104
    v_lshrrev_b32 v1, 6, v0
    s_nop 0
    v_readfirstlane_b32 s22, v1
    s_mov_b32 s6, 268435456
    s_mov_b32 s7, 0x00020000
    s_and_b32 s8, s2, 7
    s_lshr_b32 s9, s2, 3
    s_and_b32 s10, s8, 1
    s_mul_i32 s10, s10, 4
    s_and_b32 s11, s9, 3
    s_add_u32 s10, s10, s11
    s_lshr_b32 s12, s8, 1
    s_mul_i32 s12, s12, 8
    s_lshr_b32 s11, s9, 2
    s_add_u32 s12, s12, s11
    s_mul_i32 s20, s12, 7
    s_mul_i32 s21, s10, 8
    v_and_b32 v6, 63, v0
    v_lshlrev_b32 v6, 4, v6
    s_cmp_lt_u32 s22, 3
    s_cselect_b64 vcc, -1, 0
    s_add_u32 s43, s22, 0
    s_mul_i32 s50, s43, 2048
    s_add_u32 s44, s43, s20
    s_mul_i32 s44, s44, 65536
    s_add_u32 s44, s44, 33554432
    s_add_u32 s46, s43, s21
    s_mul_i32 s46, s46, 65536
    s_add_u32 s46, s46, 16318464
    s_cmp_lt_u32 s43, 7
    s_cselect_b32 s46, s44, s46
    s_add_u32 m0, s50, 0
    s_waitcnt lgkmcnt(0)
    buffer_load_dwordx4 v6, s[4:7], s46 offen offset:0 lds
    buffer_load_dwordx4 v6, s[4:7], s46 offen offset:1024 lds
    s_add_u32 s43, s22, 4
    s_mul_i32 s51, s43, 2048
    s_add_u32 s44, s43, s20
    s_mul_i32 s44, s44, 65536
    s_add_u32 s44, s44, 33554432
    s_add_u32 s47, s43, s21
    s_mul_i32 s47, s47, 65536
    s_add_u32 s47, s47, 16318464
    s_cmp_lt_u32 s43, 7
    s_cselect_b32 s47, s44, s47
    s_add_u32 m0, s51, 0
    s_nop 0
    buffer_load_dwordx4 v6, s[4:7], s47 offen offset:0 lds
    buffer_load_dwordx4 v6, s[4:7], s47 offen offset:1024 lds
    s_add_u32 s43, s22, 8
    s_mul_i32 s52, s43, 2048
    s_add_u32 s44, s43, s20
    s_mul_i32 s44, s44, 65536
    s_add_u32 s44, s44, 33554432
    s_add_u32 s48, s43, s21
    s_mul_i32 s48, s48, 65536
    s_add_u32 s48, s48, 16318464
    s_cmp_lt_u32 s43, 7
    s_cselect_b32 s48, s44, s48
    s_add_u32 m0, s52, 0
    s_nop 0
    buffer_load_dwordx4 v6, s[4:7], s48 offen offset:0 lds
    buffer_load_dwordx4 v6, s[4:7], s48 offen offset:1024 lds
    s_add_u32 s43, s22, 12
    s_mul_i32 s53, s43, 2048
    s_add_u32 s44, s43, s20
    s_mul_i32 s44, s44, 65536
    s_add_u32 s44, s44, 33554432
    s_add_u32 s49, s43, s21
    s_mul_i32 s49, s49, 65536
    s_add_u32 s49, s49, 16318464
    s_cmp_lt_u32 s43, 7
    s_cselect_b32 s49, s44, s49
    s_add_u32 m0, s53, 0
    s_cbranch_vccz L_k5_skip1
    buffer_load_dwordx4 v6, s[4:7], s49 offen offset:0 lds
L_k5_skip1:
    s_cbranch_vccz L_k5_skip2
    buffer_load_dwordx4 v6, s[4:7], s49 offen offset:1024 lds
L_k5_skip2:
    v_add_u32 v6, 2048, v6
    s_add_u32 m0, s50, 30720
    s_nop 0
    buffer_load_dwordx4 v6, s[4:7], s46 offen offset:0 lds
    buffer_load_dwordx4 v6, s[4:7], s46 offen offset:1024 lds
    s_add_u32 m0, s51, 30720
    s_nop 0
    buffer_load_dwordx4 v6, s[4:7], s47 offen offset:0 lds
    buffer_load_dwordx4 v6, s[4:7], s47 offen offset:1024 lds
    s_add_u32 m0, s52, 30720
    s_nop 0
    buffer_load_dwordx4 v6, s[4:7], s48 offen offset:0 lds
    buffer_load_dwordx4 v6, s[4:7], s48 offen offset:1024 lds
    s_add_u32 m0, s53, 30720
    s_cbranch_vccz L_k5_skip3
    buffer_load_dwordx4 v6, s[4:7], s49 offen offset:0 lds
L_k5_skip3:
    s_cbranch_vccz L_k5_skip4
    buffer_load_dwordx4 v6, s[4:7], s49 offen offset:1024 lds
L_k5_skip4:
    v_add_u32 v6, 2048, v6
    v_and_b32 v4, 15, v0
    v_lshlrev_b32 v4, 4, v4
    v_bfe_u32 v5, v0, 4, 2
    v_lshl_add_u32 v4, v5, 9, v4
    s_and_b32 s43, s22, 0
    s_mul_i32 s43, s43, 14336
    v_add_u32 v2, s43, v4
    s_lshr_b32 s43, s22, 0
    s_mul_i32 s43, s43, 4096
    s_add_u32 s43, s43, 14336
    v_add_u32 v3, s43, v4
    v_and_b32 v8, 63, v0
    v_lshlrev_b32 v9, 4, v8
    v_and_b32 v10, 15, v8
    v_lshrrev_b32 v11, 4, v8
    v_lshlrev_b32 v12, 7, v10
    v_lshl_add_u32 v12, v11, 5, v12
    s_lshl_b32 s13, s22, 1
    s_add_u32 s13, s13, s21
    s_lshl_b32 s14, s13, 12
    s_add_u32 s14, s14, 196608
    s_add_u32 s15, s14, 4096
    s_mul_i32 s16, s12, 1792
    s_lshl_b32 s17, s22, 10
    s_add_u32 s16, s16, s17
    s_add_u32 s16, s16, 950272
    s_add_u32 s17, s17, 153600
    s_cmp_lg_u32 s22, 3
    s_cbranch_scc1 L_ct_k5_skip
    s_getpc_b64 s[28:29]
L_ct_k5:
    v_and_b32 v7, 63, v0
    v_lshlrev_b32 v7, 7, v7
    s_mov_b32 s30, L_k5_kernel_exit-L_ct_k5-4
    v_min_u32 v14, s30, v7
    global_load_dword v13, v14, s[28:29]
    v_add_u32 v7, 8192, v7
    v_min_u32 v14, s30, v7
    global_load_dword v13, v14, s[28:29]
L_ct_k5_skip:
    v_mov_b32 v16, 0
    v_mov_b32 v17, 0
    v_mov_b32 v18, 0
    v_mov_b32 v19, 0
    v_mov_b32 v20, 0
    v_mov_b32 v21, 0
    v_mov_b32 v22, 0
    v_mov_b32 v23, 0
    v_mov_b32 v24, 0
    v_mov_b32 v25, 0
    v_mov_b32 v26, 0
    v_mov_b32 v27, 0
    v_mov_b32 v28, 0
    v_mov_b32 v29, 0
    v_mov_b32 v30, 0
    v_mov_b32 v31, 0
    v_mov_b32 v32, 0
    v_mov_b32 v33, 0
    v_mov_b32 v34, 0
    v_mov_b32 v35, 0
    v_mov_b32 v36, 0
    v_mov_b32 v37, 0
    v_mov_b32 v38, 0
    v_mov_b32 v39, 0
    v_mov_b32 v40, 0
    v_mov_b32 v41, 0
    v_mov_b32 v42, 0
    v_mov_b32 v43, 0
    v_mov_b32 v44, 0
    v_mov_b32 v45, 0
    v_mov_b32 v46, 0
    v_mov_b32 v47, 0
    v_mov_b32 v48, 0
    v_mov_b32 v49, 0
    v_mov_b32 v50, 0
    v_mov_b32 v51, 0
    v_mov_b32 v52, 0
    v_mov_b32 v53, 0
    v_mov_b32 v54, 0
    v_mov_b32 v55, 0
    v_mov_b32 v56, 0
    v_mov_b32 v57, 0
    v_mov_b32 v58, 0
    v_mov_b32 v59, 0
    v_mov_b32 v60, 0
    v_mov_b32 v61, 0
    v_mov_b32 v62, 0
    v_mov_b32 v63, 0
    v_mov_b32 v64, 0
    v_mov_b32 v65, 0
    v_mov_b32 v66, 0
    v_mov_b32 v67, 0
    v_mov_b32 v68, 0
    v_mov_b32 v69, 0
    v_mov_b32 v70, 0
    v_mov_b32 v71, 0
    v_mov_b32 v72, 0
    v_mov_b32 v73, 0
    v_mov_b32 v74, 0
    v_mov_b32 v75, 0
    v_mov_b32 v76, 0
    v_mov_b32 v77, 0
    v_mov_b32 v78, 0
    v_mov_b32 v79, 0
    v_mov_b32 v80, 0
    v_mov_b32 v81, 0
    v_mov_b32 v82, 0
    v_mov_b32 v83, 0
    v_mov_b32 v84, 0
    v_mov_b32 v85, 0
    v_mov_b32 v86, 0
    v_mov_b32 v87, 0
    v_mov_b32 v88, 0
    v_mov_b32 v89, 0
    v_mov_b32 v90, 0
    v_mov_b32 v91, 0
    v_mov_b32 v92, 0
    v_mov_b32 v93, 0
    v_mov_b32 v94, 0
    v_mov_b32 v95, 0
    v_mov_b32 v96, 0
    v_mov_b32 v97, 0
    v_mov_b32 v98, 0
    v_mov_b32 v99, 0
    v_mov_b32 v100, 0
    v_mov_b32 v101, 0
    v_mov_b32 v102, 0
    v_mov_b32 v103, 0
    v_mov_b32 v104, 0
    v_mov_b32 v105, 0
    v_mov_b32 v106, 0
    v_mov_b32 v107, 0
    v_mov_b32 v108, 0
    v_mov_b32 v109, 0
    v_mov_b32 v110, 0
    v_mov_b32 v111, 0
    v_mov_b32 v112, 0
    v_mov_b32 v113, 0
    v_mov_b32 v114, 0
    v_mov_b32 v115, 0
    v_mov_b32 v116, 0
    v_mov_b32 v117, 0
    v_mov_b32 v118, 0
    v_mov_b32 v119, 0
    v_mov_b32 v120, 0
    v_mov_b32 v121, 0
    v_mov_b32 v122, 0
    v_mov_b32 v123, 0
    v_mov_b32 v124, 0
    v_mov_b32 v125, 0
    v_mov_b32 v126, 0
    v_mov_b32 v127, 0
    v_mov_b32 v128, 0
    v_mov_b32 v129, 0
    v_mov_b32 v130, 0
    v_mov_b32 v131, 0
    v_mov_b32 v132, 0
    v_mov_b32 v133, 0
    v_mov_b32 v134, 0
    v_mov_b32 v135, 0
    v_mov_b32 v136, 0
    v_mov_b32 v137, 0
    v_mov_b32 v138, 0
    v_mov_b32 v139, 0
    v_mov_b32 v140, 0
    v_mov_b32 v141, 0
    v_mov_b32 v142, 0
    v_mov_b32 v143, 0
    v_mov_b32 v144, 0
    v_mov_b32 v145, 0
    v_mov_b32 v146, 0
    v_mov_b32 v147, 0
    v_mov_b32 v148, 0
    v_mov_b32 v149, 0
    v_mov_b32 v150, 0
    v_mov_b32 v151, 0
    v_mov_b32 v152, 0
    v_mov_b32 v153, 0
    v_mov_b32 v154, 0
    v_mov_b32 v155, 0
    v_mov_b32 v156, 0
    v_mov_b32 v157, 0
    v_mov_b32 v158, 0
    v_mov_b32 v159, 0
    v_mov_b32 v160, 0
    v_mov_b32 v161, 0
    v_mov_b32 v162, 0
    v_mov_b32 v163, 0
    v_mov_b32 v164, 0
    v_mov_b32 v165, 0
    v_mov_b32 v166, 0
    v_mov_b32 v167, 0
    v_mov_b32 v168, 0
    v_mov_b32 v169, 0
    v_mov_b32 v170, 0
    v_mov_b32 v171, 0
    v_mov_b32 v172, 0
    v_mov_b32 v173, 0
    v_mov_b32 v174, 0
    v_mov_b32 v175, 0
    v_mov_b32 v176, 0
    v_mov_b32 v177, 0
    v_mov_b32 v178, 0
    v_mov_b32 v179, 0
    v_mov_b32 v180, 0
    v_mov_b32 v181, 0
    v_mov_b32 v182, 0
    v_mov_b32 v183, 0
    v_mov_b32 v184, 0
    v_mov_b32 v185, 0
    v_mov_b32 v186, 0
    v_mov_b32 v187, 0
    v_mov_b32 v188, 0
    v_mov_b32 v189, 0
    v_mov_b32 v190, 0
    v_mov_b32 v191, 0
    v_mov_b32 v192, 0
    v_mov_b32 v193, 0
    v_mov_b32 v194, 0
    v_mov_b32 v195, 0
    v_mov_b32 v196, 0
    v_mov_b32 v197, 0
    v_mov_b32 v198, 0
    v_mov_b32 v199, 0
    v_mov_b32 v200, 0
    v_mov_b32 v201, 0
    v_mov_b32 v202, 0
    v_mov_b32 v203, 0
    v_mov_b32 v204, 0
    v_mov_b32 v205, 0
    v_mov_b32 v206, 0
    v_mov_b32 v207, 0
    v_mov_b32 v208, 0
    v_mov_b32 v209, 0
    v_mov_b32 v210, 0
    v_mov_b32 v211, 0
    v_mov_b32 v212, 0
    v_mov_b32 v213, 0
    v_mov_b32 v214, 0
    v_mov_b32 v215, 0
    v_mov_b32 v216, 0
    v_mov_b32 v217, 0
    v_mov_b32 v218, 0
    v_mov_b32 v219, 0
    v_mov_b32 v220, 0
    v_mov_b32 v221, 0
    v_mov_b32 v222, 0
    v_mov_b32 v223, 0
    v_mov_b32 v224, 0
    v_mov_b32 v225, 0
    v_mov_b32 v226, 0
    v_mov_b32 v227, 0
    v_mov_b32 v228, 0
    v_mov_b32 v229, 0
    v_mov_b32 v230, 0
    v_mov_b32 v231, 0
    v_mov_b32 v232, 0
    v_mov_b32 v233, 0
    v_mov_b32 v234, 0
    v_mov_b32 v235, 0
    v_mov_b32 v236, 0
    v_mov_b32 v237, 0
    v_mov_b32 v238, 0
    v_mov_b32 v239, 0
    s_mov_b32 s40, 0
    v_mov_b32 v4, v2
    v_mov_b32 v5, v3
    s_waitcnt vmcnt(6)
    s_barrier
    ds_read_b128 a[0:3], v4 offset:0
    ds_read_b128 a[28:31], v5 offset:0
    ds_read_b128 a[64:67], v5 offset:256
    ds_read_b128 a[32:35], v5 offset:2048
    ds_read_b128 a[68:71], v5 offset:2304
    ds_read_b128 a[36:39], v4 offset:256
    ds_read_b128 a[4:7], v4 offset:2048
    ds_read_b128 a[40:43], v4 offset:2304
    ds_read_b128 a[8:11], v4 offset:4096
    ds_read_b128 a[44:47], v4 offset:4352
    ds_read_b128 a[12:15], v4 offset:6144
    ds_read_b128 a[48:51], v4 offset:6400
    ds_read_b128 a[16:19], v4 offset:8192
    ds_read_b128 a[52:55], v4 offset:8448
    ds_read_b128 a[20:23], v4 offset:10240
    ds_read_b128 a[56:59], v4 offset:10496
    ds_read_b128 a[24:27], v4 offset:12288
    ds_read_b128 a[60:63], v4 offset:12544
    s_mov_b32 s40, 30720
    s_mov_b32 s41, 0
    v_add_u32 v4, 30720, v2
    v_add_u32 v5, 30720, v3
    s_waitcnt vmcnt(0) lgkmcnt(0)
    s_barrier
    v_mfma_f32_16x16x32_bf16 v[16:19], a[0:3], a[28:31], v[16:19]
    ds_read_b128 a[72:75], v4 offset:0
    s_add_u32 m0, s50, 61440
    v_mfma_f32_16x16x32_bf16 v[24:27], a[36:39], a[28:31], v[24:27]
    buffer_load_dwordx4 v6, s[4:7], s46 offen offset:0 lds
    v_mfma_f32_16x16x32_bf16 v[48:51], a[4:7], a[28:31], v[48:51]
    ds_read_b128 a[100:103], v5 offset:0
    v_mfma_f32_16x16x32_bf16 v[56:59], a[40:43], a[28:31], v[56:59]
    v_mfma_f32_16x16x32_bf16 v[80:83], a[8:11], a[28:31], v[80:83]
    ds_read_b128 a[136:139], v5 offset:256
    buffer_load_dwordx4 v6, s[4:7], s46 offen offset:1024 lds
    v_mfma_f32_16x16x32_bf16 v[88:91], a[44:47], a[28:31], v[88:91]
    v_mfma_f32_16x16x32_bf16 v[112:115], a[12:15], a[28:31], v[112:115]
    v_mfma_f32_16x16x32_bf16 v[120:123], a[48:51], a[28:31], v[120:123]
    ds_read_b128 a[104:107], v5 offset:2048
    s_add_u32 m0, s51, 61440
    v_mfma_f32_16x16x32_bf16 v[144:147], a[16:19], a[28:31], v[144:147]
    buffer_load_dwordx4 v6, s[4:7], s47 offen offset:0 lds
    v_mfma_f32_16x16x32_bf16 v[152:155], a[52:55], a[28:31], v[152:155]
    ds_read_b128 a[140:143], v5 offset:2304
    v_mfma_f32_16x16x32_bf16 v[176:179], a[20:23], a[28:31], v[176:179]
    v_mfma_f32_16x16x32_bf16 v[184:187], a[56:59], a[28:31], v[184:187]
    buffer_load_dwordx4 v6, s[4:7], s47 offen offset:1024 lds
    v_mfma_f32_16x16x32_bf16 v[208:211], a[24:27], a[28:31], v[208:211]
    ds_read_b128 a[108:111], v4 offset:256
    v_mfma_f32_16x16x32_bf16 v[216:219], a[60:63], a[28:31], v[216:219]
    v_mfma_f32_16x16x32_bf16 v[220:223], a[60:63], a[64:67], v[220:223]
    ds_read_b128 a[76:79], v4 offset:2048
    s_add_u32 m0, s52, 61440
    v_mfma_f32_16x16x32_bf16 v[212:215], a[24:27], a[64:67], v[212:215]
    buffer_load_dwordx4 v6, s[4:7], s48 offen offset:0 lds
    v_mfma_f32_16x16x32_bf16 v[188:191], a[56:59], a[64:67], v[188:191]
    v_mfma_f32_16x16x32_bf16 v[180:183], a[20:23], a[64:67], v[180:183]
    ds_read_b128 a[112:115], v4 offset:2304
    v_mfma_f32_16x16x32_bf16 v[156:159], a[52:55], a[64:67], v[156:159]
    buffer_load_dwordx4 v6, s[4:7], s48 offen offset:1024 lds
    v_mfma_f32_16x16x32_bf16 v[148:151], a[16:19], a[64:67], v[148:151]
    ds_read_b128 a[80:83], v4 offset:4096
    v_mfma_f32_16x16x32_bf16 v[124:127], a[48:51], a[64:67], v[124:127]
    v_mfma_f32_16x16x32_bf16 v[116:119], a[12:15], a[64:67], v[116:119]
    s_add_u32 m0, s53, 61440
    v_mfma_f32_16x16x32_bf16 v[92:95], a[44:47], a[64:67], v[92:95]
    ds_read_b128 a[116:119], v4 offset:4352
    s_cbranch_vccz L_k5_skip5
    buffer_load_dwordx4 v6, s[4:7], s49 offen offset:0 lds
L_k5_skip5:
    v_mfma_f32_16x16x32_bf16 v[84:87], a[8:11], a[64:67], v[84:87]
    v_mfma_f32_16x16x32_bf16 v[60:63], a[40:43], a[64:67], v[60:63]
    ds_read_b128 a[84:87], v4 offset:6144
    v_mfma_f32_16x16x32_bf16 v[52:55], a[4:7], a[64:67], v[52:55]
    s_cbranch_vccz L_k5_skip6
    buffer_load_dwordx4 v6, s[4:7], s49 offen offset:1024 lds
L_k5_skip6:
    v_add_u32 v6, 2048, v6
    v_mfma_f32_16x16x32_bf16 v[28:31], a[36:39], a[64:67], v[28:31]
    v_mfma_f32_16x16x32_bf16 v[20:23], a[0:3], a[64:67], v[20:23]
    ds_read_b128 a[120:123], v4 offset:6400
    v_mfma_f32_16x16x32_bf16 v[32:35], a[0:3], a[32:35], v[32:35]
    s_add_u32 m0, s50, 92160
    v_mfma_f32_16x16x32_bf16 v[40:43], a[36:39], a[32:35], v[40:43]
    ds_read_b128 a[88:91], v4 offset:8192
    buffer_load_dwordx4 v6, s[4:7], s46 offen offset:0 lds
    v_mfma_f32_16x16x32_bf16 v[64:67], a[4:7], a[32:35], v[64:67]
    v_mfma_f32_16x16x32_bf16 v[72:75], a[40:43], a[32:35], v[72:75]
    v_mfma_f32_16x16x32_bf16 v[96:99], a[8:11], a[32:35], v[96:99]
    ds_read_b128 a[124:127], v4 offset:8448
    buffer_load_dwordx4 v6, s[4:7], s46 offen offset:1024 lds
    v_mfma_f32_16x16x32_bf16 v[104:107], a[44:47], a[32:35], v[104:107]
    v_mfma_f32_16x16x32_bf16 v[128:131], a[12:15], a[32:35], v[128:131]
    ds_read_b128 a[92:95], v4 offset:10240
    v_mfma_f32_16x16x32_bf16 v[136:139], a[48:51], a[32:35], v[136:139]
    s_add_u32 m0, s51, 92160
    v_mfma_f32_16x16x32_bf16 v[160:163], a[16:19], a[32:35], v[160:163]
    buffer_load_dwordx4 v6, s[4:7], s47 offen offset:0 lds
    v_mfma_f32_16x16x32_bf16 v[168:171], a[52:55], a[32:35], v[168:171]
    ds_read_b128 a[128:131], v4 offset:10496
    v_mfma_f32_16x16x32_bf16 v[192:195], a[20:23], a[32:35], v[192:195]
    v_mfma_f32_16x16x32_bf16 v[200:203], a[56:59], a[32:35], v[200:203]
    ds_read_b128 a[96:99], v4 offset:12288
    buffer_load_dwordx4 v6, s[4:7], s47 offen offset:1024 lds
    v_mfma_f32_16x16x32_bf16 v[224:227], a[24:27], a[32:35], v[224:227]
    v_mfma_f32_16x16x32_bf16 v[232:235], a[60:63], a[32:35], v[232:235]
    v_mfma_f32_16x16x32_bf16 v[236:239], a[60:63], a[68:71], v[236:239]
    ds_read_b128 a[132:135], v4 offset:12544
    s_add_u32 m0, s52, 92160
    v_mfma_f32_16x16x32_bf16 v[228:231], a[24:27], a[68:71], v[228:231]
    buffer_load_dwordx4 v6, s[4:7], s48 offen offset:0 lds
    v_mfma_f32_16x16x32_bf16 v[204:207], a[56:59], a[68:71], v[204:207]
    v_mfma_f32_16x16x32_bf16 v[196:199], a[20:23], a[68:71], v[196:199]
    v_mfma_f32_16x16x32_bf16 v[172:175], a[52:55], a[68:71], v[172:175]
    buffer_load_dwordx4 v6, s[4:7], s48 offen offset:1024 lds
    v_mfma_f32_16x16x32_bf16 v[164:167], a[16:19], a[68:71], v[164:167]
    v_mfma_f32_16x16x32_bf16 v[140:143], a[48:51], a[68:71], v[140:143]
    v_mfma_f32_16x16x32_bf16 v[132:135], a[12:15], a[68:71], v[132:135]
    s_add_u32 m0, s53, 92160
    v_mfma_f32_16x16x32_bf16 v[108:111], a[44:47], a[68:71], v[108:111]
    s_cbranch_vccz L_k5_skip7
    buffer_load_dwordx4 v6, s[4:7], s49 offen offset:0 lds
L_k5_skip7:
    s_add_u32 s41, s40, 30720
    s_cmp_eq_u32 s41, 153600
    s_cselect_b32 s41, 0, s41
    v_mfma_f32_16x16x32_bf16 v[100:103], a[8:11], a[68:71], v[100:103]
    v_mfma_f32_16x16x32_bf16 v[76:79], a[40:43], a[68:71], v[76:79]
    v_add_u32 v4, s41, v2
    v_mfma_f32_16x16x32_bf16 v[68:71], a[4:7], a[68:71], v[68:71]
    s_cbranch_vccz L_k5_skip8
    buffer_load_dwordx4 v6, s[4:7], s49 offen offset:1024 lds
L_k5_skip8:
    v_add_u32 v6, 2048, v6
    v_mfma_f32_16x16x32_bf16 v[44:47], a[36:39], a[68:71], v[44:47]
    v_add_u32 v5, s41, v3
    v_mfma_f32_16x16x32_bf16 v[36:39], a[0:3], a[68:71], v[36:39]
    s_waitcnt vmcnt(6) lgkmcnt(0)
    s_barrier
    v_mfma_f32_16x16x32_bf16 v[16:19], a[72:75], a[100:103], v[16:19]
    ds_read_b128 a[0:3], v4 offset:0
    s_add_u32 m0, s50, 122880
    v_mfma_f32_16x16x32_bf16 v[24:27], a[108:111], a[100:103], v[24:27]
    buffer_load_dwordx4 v6, s[4:7], s46 offen offset:0 lds
    v_mfma_f32_16x16x32_bf16 v[48:51], a[76:79], a[100:103], v[48:51]
    ds_read_b128 a[28:31], v5 offset:0
    v_mfma_f32_16x16x32_bf16 v[56:59], a[112:115], a[100:103], v[56:59]
    v_mfma_f32_16x16x32_bf16 v[80:83], a[80:83], a[100:103], v[80:83]
    ds_read_b128 a[64:67], v5 offset:256
    buffer_load_dwordx4 v6, s[4:7], s46 offen offset:1024 lds
    v_mfma_f32_16x16x32_bf16 v[88:91], a[116:119], a[100:103], v[88:91]
    v_mfma_f32_16x16x32_bf16 v[112:115], a[84:87], a[100:103], v[112:115]
    v_mfma_f32_16x16x32_bf16 v[120:123], a[120:123], a[100:103], v[120:123]
    ds_read_b128 a[32:35], v5 offset:2048
    s_add_u32 m0, s51, 122880
    v_mfma_f32_16x16x32_bf16 v[144:147], a[88:91], a[100:103], v[144:147]
    buffer_load_dwordx4 v6, s[4:7], s47 offen offset:0 lds
    v_mfma_f32_16x16x32_bf16 v[152:155], a[124:127], a[100:103], v[152:155]
    ds_read_b128 a[68:71], v5 offset:2304
    v_mfma_f32_16x16x32_bf16 v[176:179], a[92:95], a[100:103], v[176:179]
    v_mfma_f32_16x16x32_bf16 v[184:187], a[128:131], a[100:103], v[184:187]
    buffer_load_dwordx4 v6, s[4:7], s47 offen offset:1024 lds
    v_mfma_f32_16x16x32_bf16 v[208:211], a[96:99], a[100:103], v[208:211]
    ds_read_b128 a[36:39], v4 offset:256
    v_mfma_f32_16x16x32_bf16 v[216:219], a[132:135], a[100:103], v[216:219]
    v_mfma_f32_16x16x32_bf16 v[220:223], a[132:135], a[136:139], v[220:223]
    ds_read_b128 a[4:7], v4 offset:2048
    s_add_u32 m0, s52, 122880
    v_mfma_f32_16x16x32_bf16 v[212:215], a[96:99], a[136:139], v[212:215]
    buffer_load_dwordx4 v6, s[4:7], s48 offen offset:0 lds
    v_mfma_f32_16x16x32_bf16 v[188:191], a[128:131], a[136:139], v[188:191]
    v_mfma_f32_16x16x32_bf16 v[180:183], a[92:95], a[136:139], v[180:183]
    ds_read_b128 a[40:43], v4 offset:2304
    v_mfma_f32_16x16x32_bf16 v[156:159], a[124:127], a[136:139], v[156:159]
    buffer_load_dwordx4 v6, s[4:7], s48 offen offset:1024 lds
    v_mfma_f32_16x16x32_bf16 v[148:151], a[88:91], a[136:139], v[148:151]
    ds_read_b128 a[8:11], v4 offset:4096
    v_mfma_f32_16x16x32_bf16 v[124:127], a[120:123], a[136:139], v[124:127]
    v_mfma_f32_16x16x32_bf16 v[116:119], a[84:87], a[136:139], v[116:119]
    s_add_u32 m0, s53, 122880
    v_mfma_f32_16x16x32_bf16 v[92:95], a[116:119], a[136:139], v[92:95]
    ds_read_b128 a[44:47], v4 offset:4352
    s_cbranch_vccz L_k5_skip9
    buffer_load_dwordx4 v6, s[4:7], s49 offen offset:0 lds
L_k5_skip9:
    v_mfma_f32_16x16x32_bf16 v[84:87], a[80:83], a[136:139], v[84:87]
    v_mfma_f32_16x16x32_bf16 v[60:63], a[112:115], a[136:139], v[60:63]
    ds_read_b128 a[12:15], v4 offset:6144
    v_mfma_f32_16x16x32_bf16 v[52:55], a[76:79], a[136:139], v[52:55]
    s_cbranch_vccz L_k5_skip10
    buffer_load_dwordx4 v6, s[4:7], s49 offen offset:1024 lds
L_k5_skip10:
    v_add_u32 v6, 2048, v6
    v_mfma_f32_16x16x32_bf16 v[28:31], a[108:111], a[136:139], v[28:31]
    v_mfma_f32_16x16x32_bf16 v[20:23], a[72:75], a[136:139], v[20:23]
    ds_read_b128 a[48:51], v4 offset:6400
    v_mfma_f32_16x16x32_bf16 v[32:35], a[72:75], a[104:107], v[32:35]
    s_add_u32 m0, s50, 0
    v_mfma_f32_16x16x32_bf16 v[40:43], a[108:111], a[104:107], v[40:43]
    ds_read_b128 a[16:19], v4 offset:8192
    buffer_load_dwordx4 v6, s[4:7], s46 offen offset:0 lds
    v_mfma_f32_16x16x32_bf16 v[64:67], a[76:79], a[104:107], v[64:67]
    v_mfma_f32_16x16x32_bf16 v[72:75], a[112:115], a[104:107], v[72:75]
    v_mfma_f32_16x16x32_bf16 v[96:99], a[80:83], a[104:107], v[96:99]
    ds_read_b128 a[52:55], v4 offset:8448
    buffer_load_dwordx4 v6, s[4:7], s46 offen offset:1024 lds
    v_mfma_f32_16x16x32_bf16 v[104:107], a[116:119], a[104:107], v[104:107]
    v_mfma_f32_16x16x32_bf16 v[128:131], a[84:87], a[104:107], v[128:131]
    ds_read_b128 a[20:23], v4 offset:10240
    v_mfma_f32_16x16x32_bf16 v[136:139], a[120:123], a[104:107], v[136:139]
    s_add_u32 m0, s51, 0
    v_mfma_f32_16x16x32_bf16 v[160:163], a[88:91], a[104:107], v[160:163]
    buffer_load_dwordx4 v6, s[4:7], s47 offen offset:0 lds
    v_mfma_f32_16x16x32_bf16 v[168:171], a[124:127], a[104:107], v[168:171]
    ds_read_b128 a[56:59], v4 offset:10496
    v_mfma_f32_16x16x32_bf16 v[192:195], a[92:95], a[104:107], v[192:195]
    v_mfma_f32_16x16x32_bf16 v[200:203], a[128:131], a[104:107], v[200:203]
    ds_read_b128 a[24:27], v4 offset:12288
    buffer_load_dwordx4 v6, s[4:7], s47 offen offset:1024 lds
    v_mfma_f32_16x16x32_bf16 v[224:227], a[96:99], a[104:107], v[224:227]
    v_mfma_f32_16x16x32_bf16 v[232:235], a[132:135], a[104:107], v[232:235]
    v_mfma_f32_16x16x32_bf16 v[236:239], a[132:135], a[140:143], v[236:239]
    ds_read_b128 a[60:63], v4 offset:12544
    s_add_u32 m0, s52, 0
    v_mfma_f32_16x16x32_bf16 v[228:231], a[96:99], a[140:143], v[228:231]
    buffer_load_dwordx4 v6, s[4:7], s48 offen offset:0 lds
    v_mfma_f32_16x16x32_bf16 v[204:207], a[128:131], a[140:143], v[204:207]
    v_mfma_f32_16x16x32_bf16 v[196:199], a[92:95], a[140:143], v[196:199]
    v_mfma_f32_16x16x32_bf16 v[172:175], a[124:127], a[140:143], v[172:175]
    buffer_load_dwordx4 v6, s[4:7], s48 offen offset:1024 lds
    v_mfma_f32_16x16x32_bf16 v[164:167], a[88:91], a[140:143], v[164:167]
    v_mfma_f32_16x16x32_bf16 v[140:143], a[120:123], a[140:143], v[140:143]
    v_mfma_f32_16x16x32_bf16 v[132:135], a[84:87], a[140:143], v[132:135]
    s_add_u32 m0, s53, 0
    v_mfma_f32_16x16x32_bf16 v[108:111], a[116:119], a[140:143], v[108:111]
    s_cbranch_vccz L_k5_skip11
    buffer_load_dwordx4 v6, s[4:7], s49 offen offset:0 lds
L_k5_skip11:
    s_add_u32 s40, s41, 30720
    s_cmp_eq_u32 s40, 153600
    s_cselect_b32 s40, 0, s40
    v_mfma_f32_16x16x32_bf16 v[100:103], a[80:83], a[140:143], v[100:103]
    v_mfma_f32_16x16x32_bf16 v[76:79], a[112:115], a[140:143], v[76:79]
    v_add_u32 v4, s40, v2
    v_mfma_f32_16x16x32_bf16 v[68:71], a[76:79], a[140:143], v[68:71]
    s_cbranch_vccz L_k5_skip12
    buffer_load_dwordx4 v6, s[4:7], s49 offen offset:1024 lds
L_k5_skip12:
    v_add_u32 v6, 2048, v6
    v_mfma_f32_16x16x32_bf16 v[44:47], a[108:111], a[140:143], v[44:47]
    v_add_u32 v5, s40, v3
    v_mfma_f32_16x16x32_bf16 v[36:39], a[72:75], a[140:143], v[36:39]
    s_waitcnt vmcnt(12) lgkmcnt(0)
    s_barrier
    v_mfma_f32_16x16x32_bf16 v[16:19], a[0:3], a[28:31], v[16:19]
    ds_read_b128 a[72:75], v4 offset:0
    s_add_u32 m0, s50, 30720
    v_mfma_f32_16x16x32_bf16 v[24:27], a[36:39], a[28:31], v[24:27]
    buffer_load_dwordx4 v6, s[4:7], s46 offen offset:0 lds
    v_mfma_f32_16x16x32_bf16 v[48:51], a[4:7], a[28:31], v[48:51]
    ds_read_b128 a[100:103], v5 offset:0
    v_mfma_f32_16x16x32_bf16 v[56:59], a[40:43], a[28:31], v[56:59]
    v_mfma_f32_16x16x32_bf16 v[80:83], a[8:11], a[28:31], v[80:83]
    ds_read_b128 a[136:139], v5 offset:256
    buffer_load_dwordx4 v6, s[4:7], s46 offen offset:1024 lds
    v_mfma_f32_16x16x32_bf16 v[88:91], a[44:47], a[28:31], v[88:91]
    v_mfma_f32_16x16x32_bf16 v[112:115], a[12:15], a[28:31], v[112:115]
    v_mfma_f32_16x16x32_bf16 v[120:123], a[48:51], a[28:31], v[120:123]
    ds_read_b128 a[104:107], v5 offset:2048
    s_add_u32 m0, s51, 30720
    v_mfma_f32_16x16x32_bf16 v[144:147], a[16:19], a[28:31], v[144:147]
    buffer_load_dwordx4 v6, s[4:7], s47 offen offset:0 lds
    v_mfma_f32_16x16x32_bf16 v[152:155], a[52:55], a[28:31], v[152:155]
    ds_read_b128 a[140:143], v5 offset:2304
    v_mfma_f32_16x16x32_bf16 v[176:179], a[20:23], a[28:31], v[176:179]
    v_mfma_f32_16x16x32_bf16 v[184:187], a[56:59], a[28:31], v[184:187]
    buffer_load_dwordx4 v6, s[4:7], s47 offen offset:1024 lds
    v_mfma_f32_16x16x32_bf16 v[208:211], a[24:27], a[28:31], v[208:211]
    ds_read_b128 a[108:111], v4 offset:256
    v_mfma_f32_16x16x32_bf16 v[216:219], a[60:63], a[28:31], v[216:219]
    v_mfma_f32_16x16x32_bf16 v[220:223], a[60:63], a[64:67], v[220:223]
    ds_read_b128 a[76:79], v4 offset:2048
    s_add_u32 m0, s52, 30720
    v_mfma_f32_16x16x32_bf16 v[212:215], a[24:27], a[64:67], v[212:215]
    buffer_load_dwordx4 v6, s[4:7], s48 offen offset:0 lds
    v_mfma_f32_16x16x32_bf16 v[188:191], a[56:59], a[64:67], v[188:191]
    v_mfma_f32_16x16x32_bf16 v[180:183], a[20:23], a[64:67], v[180:183]
    ds_read_b128 a[112:115], v4 offset:2304
    v_mfma_f32_16x16x32_bf16 v[156:159], a[52:55], a[64:67], v[156:159]
    buffer_load_dwordx4 v6, s[4:7], s48 offen offset:1024 lds
    v_mfma_f32_16x16x32_bf16 v[148:151], a[16:19], a[64:67], v[148:151]
    ds_read_b128 a[80:83], v4 offset:4096
    v_mfma_f32_16x16x32_bf16 v[124:127], a[48:51], a[64:67], v[124:127]
    v_mfma_f32_16x16x32_bf16 v[116:119], a[12:15], a[64:67], v[116:119]
    s_add_u32 m0, s53, 30720
    v_mfma_f32_16x16x32_bf16 v[92:95], a[44:47], a[64:67], v[92:95]
    ds_read_b128 a[116:119], v4 offset:4352
    s_cbranch_vccz L_k5_skip13
    buffer_load_dwordx4 v6, s[4:7], s49 offen offset:0 lds
L_k5_skip13:
    v_mfma_f32_16x16x32_bf16 v[84:87], a[8:11], a[64:67], v[84:87]
    v_mfma_f32_16x16x32_bf16 v[60:63], a[40:43], a[64:67], v[60:63]
    ds_read_b128 a[84:87], v4 offset:6144
    v_mfma_f32_16x16x32_bf16 v[52:55], a[4:7], a[64:67], v[52:55]
    s_cbranch_vccz L_k5_skip14
    buffer_load_dwordx4 v6, s[4:7], s49 offen offset:1024 lds
L_k5_skip14:
    v_add_u32 v6, 2048, v6
    v_mfma_f32_16x16x32_bf16 v[28:31], a[36:39], a[64:67], v[28:31]
    v_mfma_f32_16x16x32_bf16 v[20:23], a[0:3], a[64:67], v[20:23]
    ds_read_b128 a[120:123], v4 offset:6400
    v_mfma_f32_16x16x32_bf16 v[32:35], a[0:3], a[32:35], v[32:35]
    s_add_u32 m0, s50, 61440
    v_mfma_f32_16x16x32_bf16 v[40:43], a[36:39], a[32:35], v[40:43]
    ds_read_b128 a[88:91], v4 offset:8192
    buffer_load_dwordx4 v6, s[4:7], s46 offen offset:0 lds
    v_mfma_f32_16x16x32_bf16 v[64:67], a[4:7], a[32:35], v[64:67]
    v_mfma_f32_16x16x32_bf16 v[72:75], a[40:43], a[32:35], v[72:75]
    v_mfma_f32_16x16x32_bf16 v[96:99], a[8:11], a[32:35], v[96:99]
    ds_read_b128 a[124:127], v4 offset:8448
    buffer_load_dwordx4 v6, s[4:7], s46 offen offset:1024 lds
    v_mfma_f32_16x16x32_bf16 v[104:107], a[44:47], a[32:35], v[104:107]
    v_mfma_f32_16x16x32_bf16 v[128:131], a[12:15], a[32:35], v[128:131]
    ds_read_b128 a[92:95], v4 offset:10240
    v_mfma_f32_16x16x32_bf16 v[136:139], a[48:51], a[32:35], v[136:139]
    s_add_u32 m0, s51, 61440
    v_mfma_f32_16x16x32_bf16 v[160:163], a[16:19], a[32:35], v[160:163]
    buffer_load_dwordx4 v6, s[4:7], s47 offen offset:0 lds
    v_mfma_f32_16x16x32_bf16 v[168:171], a[52:55], a[32:35], v[168:171]
    ds_read_b128 a[128:131], v4 offset:10496
    v_mfma_f32_16x16x32_bf16 v[192:195], a[20:23], a[32:35], v[192:195]
    v_mfma_f32_16x16x32_bf16 v[200:203], a[56:59], a[32:35], v[200:203]
    ds_read_b128 a[96:99], v4 offset:12288
    buffer_load_dwordx4 v6, s[4:7], s47 offen offset:1024 lds
    v_mfma_f32_16x16x32_bf16 v[224:227], a[24:27], a[32:35], v[224:227]
    v_mfma_f32_16x16x32_bf16 v[232:235], a[60:63], a[32:35], v[232:235]
    v_mfma_f32_16x16x32_bf16 v[236:239], a[60:63], a[68:71], v[236:239]
    ds_read_b128 a[132:135], v4 offset:12544
    s_add_u32 m0, s52, 61440
    v_mfma_f32_16x16x32_bf16 v[228:231], a[24:27], a[68:71], v[228:231]
    buffer_load_dwordx4 v6, s[4:7], s48 offen offset:0 lds
    v_mfma_f32_16x16x32_bf16 v[204:207], a[56:59], a[68:71], v[204:207]
    v_mfma_f32_16x16x32_bf16 v[196:199], a[20:23], a[68:71], v[196:199]
    v_mfma_f32_16x16x32_bf16 v[172:175], a[52:55], a[68:71], v[172:175]
    buffer_load_dwordx4 v6, s[4:7], s48 offen offset:1024 lds
    v_mfma_f32_16x16x32_bf16 v[164:167], a[16:19], a[68:71], v[164:167]
    v_mfma_f32_16x16x32_bf16 v[140:143], a[48:51], a[68:71], v[140:143]
    v_mfma_f32_16x16x32_bf16 v[132:135], a[12:15], a[68:71], v[132:135]
    s_add_u32 m0, s53, 61440
    v_mfma_f32_16x16x32_bf16 v[108:111], a[44:47], a[68:71], v[108:111]
    s_cbranch_vccz L_k5_skip15
    buffer_load_dwordx4 v6, s[4:7], s49 offen offset:0 lds
L_k5_skip15:
    s_add_u32 s41, s40, 30720
    s_cmp_eq_u32 s41, 153600
    s_cselect_b32 s41, 0, s41
    v_mfma_f32_16x16x32_bf16 v[100:103], a[8:11], a[68:71], v[100:103]
    v_mfma_f32_16x16x32_bf16 v[76:79], a[40:43], a[68:71], v[76:79]
    v_add_u32 v4, s41, v2
    v_mfma_f32_16x16x32_bf16 v[68:71], a[4:7], a[68:71], v[68:71]
    s_cbranch_vccz L_k5_skip16
    buffer_load_dwordx4 v6, s[4:7], s49 offen offset:1024 lds
L_k5_skip16:
    v_add_u32 v6, 2048, v6
    v_mfma_f32_16x16x32_bf16 v[44:47], a[36:39], a[68:71], v[44:47]
    v_add_u32 v5, s41, v3
    v_mfma_f32_16x16x32_bf16 v[36:39], a[0:3], a[68:71], v[36:39]
    s_mov_b32 s42, 12
.p2align 6
L_k5_loop:
    s_waitcnt vmcnt(18) lgkmcnt(0)
    s_barrier
    v_mfma_f32_16x16x32_bf16 v[16:19], a[72:75], a[100:103], v[16:19]
    ds_read_b128 a[0:3], v4 offset:0
    v_mfma_f32_16x16x32_bf16 v[24:27], a[108:111], a[100:103], v[24:27]
    v_mfma_f32_16x16x32_bf16 v[48:51], a[76:79], a[100:103], v[48:51]
    ds_read_b128 a[28:31], v5 offset:0
    s_add_u32 m0, s40, s50
    v_mfma_f32_16x16x32_bf16 v[56:59], a[112:115], a[100:103], v[56:59]
    buffer_load_dwordx4 v6, s[4:7], s46 offen offset:0 lds
    v_mfma_f32_16x16x32_bf16 v[80:83], a[80:83], a[100:103], v[80:83]
    ds_read_b128 a[64:67], v5 offset:256
    v_mfma_f32_16x16x32_bf16 v[88:91], a[116:119], a[100:103], v[88:91]
    v_mfma_f32_16x16x32_bf16 v[112:115], a[84:87], a[100:103], v[112:115]
    v_mfma_f32_16x16x32_bf16 v[120:123], a[120:123], a[100:103], v[120:123]
    ds_read_b128 a[32:35], v5 offset:2048
    v_mfma_f32_16x16x32_bf16 v[144:147], a[88:91], a[100:103], v[144:147]
    v_mfma_f32_16x16x32_bf16 v[152:155], a[124:127], a[100:103], v[152:155]
    ds_read_b128 a[68:71], v5 offset:2304
    v_mfma_f32_16x16x32_bf16 v[176:179], a[92:95], a[100:103], v[176:179]
    buffer_load_dwordx4 v6, s[4:7], s46 offen offset:1024 lds
    v_mfma_f32_16x16x32_bf16 v[184:187], a[128:131], a[100:103], v[184:187]
    v_mfma_f32_16x16x32_bf16 v[208:211], a[96:99], a[100:103], v[208:211]
    ds_read_b128 a[36:39], v4 offset:256
    v_mfma_f32_16x16x32_bf16 v[216:219], a[132:135], a[100:103], v[216:219]
    v_mfma_f32_16x16x32_bf16 v[220:223], a[132:135], a[136:139], v[220:223]
    ds_read_b128 a[4:7], v4 offset:2048
    v_mfma_f32_16x16x32_bf16 v[212:215], a[96:99], a[136:139], v[212:215]
    v_mfma_f32_16x16x32_bf16 v[188:191], a[128:131], a[136:139], v[188:191]
    s_add_u32 m0, s40, s51
    v_mfma_f32_16x16x32_bf16 v[180:183], a[92:95], a[136:139], v[180:183]
    ds_read_b128 a[40:43], v4 offset:2304
    buffer_load_dwordx4 v6, s[4:7], s47 offen offset:0 lds
    v_mfma_f32_16x16x32_bf16 v[156:159], a[124:127], a[136:139], v[156:159]
    v_mfma_f32_16x16x32_bf16 v[148:151], a[88:91], a[136:139], v[148:151]
    ds_read_b128 a[8:11], v4 offset:4096
    v_mfma_f32_16x16x32_bf16 v[124:127], a[120:123], a[136:139], v[124:127]
    v_mfma_f32_16x16x32_bf16 v[116:119], a[84:87], a[136:139], v[116:119]
    v_mfma_f32_16x16x32_bf16 v[92:95], a[116:119], a[136:139], v[92:95]
    ds_read_b128 a[44:47], v4 offset:4352
    v_mfma_f32_16x16x32_bf16 v[84:87], a[80:83], a[136:139], v[84:87]
    v_mfma_f32_16x16x32_bf16 v[60:63], a[112:115], a[136:139], v[60:63]
    ds_read_b128 a[12:15], v4 offset:6144
    buffer_load_dwordx4 v6, s[4:7], s47 offen offset:1024 lds
    v_mfma_f32_16x16x32_bf16 v[52:55], a[76:79], a[136:139], v[52:55]
    v_mfma_f32_16x16x32_bf16 v[28:31], a[108:111], a[136:139], v[28:31]
    v_mfma_f32_16x16x32_bf16 v[20:23], a[72:75], a[136:139], v[20:23]
    ds_read_b128 a[48:51], v4 offset:6400
    v_mfma_f32_16x16x32_bf16 v[32:35], a[72:75], a[104:107], v[32:35]
    v_mfma_f32_16x16x32_bf16 v[40:43], a[108:111], a[104:107], v[40:43]
    ds_read_b128 a[16:19], v4 offset:8192
    v_mfma_f32_16x16x32_bf16 v[64:67], a[76:79], a[104:107], v[64:67]
    s_add_u32 m0, s40, s52
    v_mfma_f32_16x16x32_bf16 v[72:75], a[112:115], a[104:107], v[72:75]
    buffer_load_dwordx4 v6, s[4:7], s48 offen offset:0 lds
    v_mfma_f32_16x16x32_bf16 v[96:99], a[80:83], a[104:107], v[96:99]
    ds_read_b128 a[52:55], v4 offset:8448
    v_mfma_f32_16x16x32_bf16 v[104:107], a[116:119], a[104:107], v[104:107]
    v_mfma_f32_16x16x32_bf16 v[128:131], a[84:87], a[104:107], v[128:131]
    ds_read_b128 a[20:23], v4 offset:10240
    v_mfma_f32_16x16x32_bf16 v[136:139], a[120:123], a[104:107], v[136:139]
    v_mfma_f32_16x16x32_bf16 v[160:163], a[88:91], a[104:107], v[160:163]
    v_mfma_f32_16x16x32_bf16 v[168:171], a[124:127], a[104:107], v[168:171]
    ds_read_b128 a[56:59], v4 offset:10496
    v_mfma_f32_16x16x32_bf16 v[192:195], a[92:95], a[104:107], v[192:195]
    buffer_load_dwordx4 v6, s[4:7], s48 offen offset:1024 lds
    v_mfma_f32_16x16x32_bf16 v[200:203], a[128:131], a[104:107], v[200:203]
    ds_read_b128 a[24:27], v4 offset:12288
    v_mfma_f32_16x16x32_bf16 v[224:227], a[96:99], a[104:107], v[224:227]
    v_mfma_f32_16x16x32_bf16 v[232:235], a[132:135], a[104:107], v[232:235]
    v_mfma_f32_16x16x32_bf16 v[236:239], a[132:135], a[140:143], v[236:239]
    ds_read_b128 a[60:63], v4 offset:12544
    v_mfma_f32_16x16x32_bf16 v[228:231], a[96:99], a[140:143], v[228:231]
    v_mfma_f32_16x16x32_bf16 v[204:207], a[128:131], a[140:143], v[204:207]
    s_add_u32 m0, s40, s53
    v_mfma_f32_16x16x32_bf16 v[196:199], a[92:95], a[140:143], v[196:199]
    s_cbranch_vccz L_k5_skip19
    buffer_load_dwordx4 v6, s[4:7], s49 offen offset:0 lds
L_k5_skip19:
    s_add_u32 s40, s41, 30720
    s_cmp_eq_u32 s40, 153600
    s_cselect_b32 s40, 0, s40
    v_mfma_f32_16x16x32_bf16 v[172:175], a[124:127], a[140:143], v[172:175]
    v_mfma_f32_16x16x32_bf16 v[164:167], a[88:91], a[140:143], v[164:167]
    v_mfma_f32_16x16x32_bf16 v[140:143], a[120:123], a[140:143], v[140:143]
    v_add_u32 v4, s40, v2
    v_mfma_f32_16x16x32_bf16 v[132:135], a[84:87], a[140:143], v[132:135]
    v_mfma_f32_16x16x32_bf16 v[108:111], a[116:119], a[140:143], v[108:111]
    v_mfma_f32_16x16x32_bf16 v[100:103], a[80:83], a[140:143], v[100:103]
    v_mfma_f32_16x16x32_bf16 v[76:79], a[112:115], a[140:143], v[76:79]
    s_cbranch_vccz L_k5_skip20
    buffer_load_dwordx4 v6, s[4:7], s49 offen offset:1024 lds
L_k5_skip20:
    v_add_u32 v6, 2048, v6
    v_add_u32 v5, s40, v3
    v_mfma_f32_16x16x32_bf16 v[68:71], a[76:79], a[140:143], v[68:71]
    v_mfma_f32_16x16x32_bf16 v[44:47], a[108:111], a[140:143], v[44:47]
    v_mfma_f32_16x16x32_bf16 v[36:39], a[72:75], a[140:143], v[36:39]
    s_waitcnt vmcnt(18) lgkmcnt(0)
    s_barrier
    v_mfma_f32_16x16x32_bf16 v[16:19], a[0:3], a[28:31], v[16:19]
    ds_read_b128 a[72:75], v4 offset:0
    v_mfma_f32_16x16x32_bf16 v[24:27], a[36:39], a[28:31], v[24:27]
    v_mfma_f32_16x16x32_bf16 v[48:51], a[4:7], a[28:31], v[48:51]
    ds_read_b128 a[100:103], v5 offset:0
    s_add_u32 m0, s41, s50
    v_mfma_f32_16x16x32_bf16 v[56:59], a[40:43], a[28:31], v[56:59]
    buffer_load_dwordx4 v6, s[4:7], s46 offen offset:0 lds
    v_mfma_f32_16x16x32_bf16 v[80:83], a[8:11], a[28:31], v[80:83]
    ds_read_b128 a[136:139], v5 offset:256
    v_mfma_f32_16x16x32_bf16 v[88:91], a[44:47], a[28:31], v[88:91]
    v_mfma_f32_16x16x32_bf16 v[112:115], a[12:15], a[28:31], v[112:115]
    v_mfma_f32_16x16x32_bf16 v[120:123], a[48:51], a[28:31], v[120:123]
    ds_read_b128 a[104:107], v5 offset:2048
    v_mfma_f32_16x16x32_bf16 v[144:147], a[16:19], a[28:31], v[144:147]
    v_mfma_f32_16x16x32_bf16 v[152:155], a[52:55], a[28:31], v[152:155]
    ds_read_b128 a[140:143], v5 offset:2304
    v_mfma_f32_16x16x32_bf16 v[176:179], a[20:23], a[28:31], v[176:179]
    buffer_load_dwordx4 v6, s[4:7], s46 offen offset:1024 lds
    v_mfma_f32_16x16x32_bf16 v[184:187], a[56:59], a[28:31], v[184:187]
    v_mfma_f32_16x16x32_bf16 v[208:211], a[24:27], a[28:31], v[208:211]
    ds_read_b128 a[108:111], v4 offset:256
    v_mfma_f32_16x16x32_bf16 v[216:219], a[60:63], a[28:31], v[216:219]
    v_mfma_f32_16x16x32_bf16 v[220:223], a[60:63], a[64:67], v[220:223]
    ds_read_b128 a[76:79], v4 offset:2048
    v_mfma_f32_16x16x32_bf16 v[212:215], a[24:27], a[64:67], v[212:215]
    v_mfma_f32_16x16x32_bf16 v[188:191], a[56:59], a[64:67], v[188:191]
    s_add_u32 m0, s41, s51
    v_mfma_f32_16x16x32_bf16 v[180:183], a[20:23], a[64:67], v[180:183]
    ds_read_b128 a[112:115], v4 offset:2304
    buffer_load_dwordx4 v6, s[4:7], s47 offen offset:0 lds
    v_mfma_f32_16x16x32_bf16 v[156:159], a[52:55], a[64:67], v[156:159]
    v_mfma_f32_16x16x32_bf16 v[148:151], a[16:19], a[64:67], v[148:151]
    ds_read_b128 a[80:83], v4 offset:4096
    v_mfma_f32_16x16x32_bf16 v[124:127], a[48:51], a[64:67], v[124:127]
    v_mfma_f32_16x16x32_bf16 v[116:119], a[12:15], a[64:67], v[116:119]
    v_mfma_f32_16x16x32_bf16 v[92:95], a[44:47], a[64:67], v[92:95]
    ds_read_b128 a[116:119], v4 offset:4352
    v_mfma_f32_16x16x32_bf16 v[84:87], a[8:11], a[64:67], v[84:87]
    v_mfma_f32_16x16x32_bf16 v[60:63], a[40:43], a[64:67], v[60:63]
    ds_read_b128 a[84:87], v4 offset:6144
    buffer_load_dwordx4 v6, s[4:7], s47 offen offset:1024 lds
    v_mfma_f32_16x16x32_bf16 v[52:55], a[4:7], a[64:67], v[52:55]
    v_mfma_f32_16x16x32_bf16 v[28:31], a[36:39], a[64:67], v[28:31]
    v_mfma_f32_16x16x32_bf16 v[20:23], a[0:3], a[64:67], v[20:23]
    ds_read_b128 a[120:123], v4 offset:6400
    v_mfma_f32_16x16x32_bf16 v[32:35], a[0:3], a[32:35], v[32:35]
    v_mfma_f32_16x16x32_bf16 v[40:43], a[36:39], a[32:35], v[40:43]
    ds_read_b128 a[88:91], v4 offset:8192
    v_mfma_f32_16x16x32_bf16 v[64:67], a[4:7], a[32:35], v[64:67]
    s_add_u32 m0, s41, s52
    v_mfma_f32_16x16x32_bf16 v[72:75], a[40:43], a[32:35], v[72:75]
    buffer_load_dwordx4 v6, s[4:7], s48 offen offset:0 lds
    v_mfma_f32_16x16x32_bf16 v[96:99], a[8:11], a[32:35], v[96:99]
    ds_read_b128 a[124:127], v4 offset:8448
    v_mfma_f32_16x16x32_bf16 v[104:107], a[44:47], a[32:35], v[104:107]
    v_mfma_f32_16x16x32_bf16 v[128:131], a[12:15], a[32:35], v[128:131]
    ds_read_b128 a[92:95], v4 offset:10240
    v_mfma_f32_16x16x32_bf16 v[136:139], a[48:51], a[32:35], v[136:139]
    v_mfma_f32_16x16x32_bf16 v[160:163], a[16:19], a[32:35], v[160:163]
    v_mfma_f32_16x16x32_bf16 v[168:171], a[52:55], a[32:35], v[168:171]
    ds_read_b128 a[128:131], v4 offset:10496
    v_mfma_f32_16x16x32_bf16 v[192:195], a[20:23], a[32:35], v[192:195]
    buffer_load_dwordx4 v6, s[4:7], s48 offen offset:1024 lds
    v_mfma_f32_16x16x32_bf16 v[200:203], a[56:59], a[32:35], v[200:203]
    ds_read_b128 a[96:99], v4 offset:12288
    v_mfma_f32_16x16x32_bf16 v[224:227], a[24:27], a[32:35], v[224:227]
    v_mfma_f32_16x16x32_bf16 v[232:235], a[60:63], a[32:35], v[232:235]
    v_mfma_f32_16x16x32_bf16 v[236:239], a[60:63], a[68:71], v[236:239]
    ds_read_b128 a[132:135], v4 offset:12544
    v_mfma_f32_16x16x32_bf16 v[228:231], a[24:27], a[68:71], v[228:231]
    v_mfma_f32_16x16x32_bf16 v[204:207], a[56:59], a[68:71], v[204:207]
    s_add_u32 m0, s41, s53
    v_mfma_f32_16x16x32_bf16 v[196:199], a[20:23], a[68:71], v[196:199]
    s_cbranch_vccz L_k5_skip23
    buffer_load_dwordx4 v6, s[4:7], s49 offen offset:0 lds
L_k5_skip23:
    s_add_u32 s41, s40, 30720
    s_cmp_eq_u32 s41, 153600
    s_cselect_b32 s41, 0, s41
    v_mfma_f32_16x16x32_bf16 v[172:175], a[52:55], a[68:71], v[172:175]
    v_mfma_f32_16x16x32_bf16 v[164:167], a[16:19], a[68:71], v[164:167]
    v_mfma_f32_16x16x32_bf16 v[140:143], a[48:51], a[68:71], v[140:143]
    v_add_u32 v4, s41, v2
    v_mfma_f32_16x16x32_bf16 v[132:135], a[12:15], a[68:71], v[132:135]
    v_mfma_f32_16x16x32_bf16 v[108:111], a[44:47], a[68:71], v[108:111]
    v_mfma_f32_16x16x32_bf16 v[100:103], a[8:11], a[68:71], v[100:103]
    v_mfma_f32_16x16x32_bf16 v[76:79], a[40:43], a[68:71], v[76:79]
    s_cbranch_vccz L_k5_skip24
    buffer_load_dwordx4 v6, s[4:7], s49 offen offset:1024 lds
L_k5_skip24:
    v_add_u32 v6, 2048, v6
    v_add_u32 v5, s41, v3
    v_mfma_f32_16x16x32_bf16 v[68:71], a[4:7], a[68:71], v[68:71]
    v_mfma_f32_16x16x32_bf16 v[44:47], a[36:39], a[68:71], v[44:47]
    v_mfma_f32_16x16x32_bf16 v[36:39], a[0:3], a[68:71], v[36:39]
    s_sub_u32 s42, s42, 1
    s_cmp_lg_u32 s42, 0
    s_cbranch_scc1 L_k5_loop
    s_waitcnt vmcnt(18) lgkmcnt(0)
    s_barrier
    v_mfma_f32_16x16x32_bf16 v[16:19], a[72:75], a[100:103], v[16:19]
    ds_read_b128 a[0:3], v4 offset:0
    v_mfma_f32_16x16x32_bf16 v[24:27], a[108:111], a[100:103], v[24:27]
    v_mfma_f32_16x16x32_bf16 v[48:51], a[76:79], a[100:103], v[48:51]
    ds_read_b128 a[28:31], v5 offset:0
    v_mfma_f32_16x16x32_bf16 v[56:59], a[112:115], a[100:103], v[56:59]
    v_mfma_f32_16x16x32_bf16 v[80:83], a[80:83], a[100:103], v[80:83]
    ds_read_b128 a[64:67], v5 offset:256
    v_mfma_f32_16x16x32_bf16 v[88:91], a[116:119], a[100:103], v[88:91]
    s_cmp_ge_u32 s22, 2
    s_cbranch_scc1 L_k5_nocs
    s_mov_b32 m0, s17
    s_nop 0
    buffer_load_dwordx4 v9, s[4:7], s16 offen lds
L_k5_nocs:
    v_mfma_f32_16x16x32_bf16 v[112:115], a[84:87], a[100:103], v[112:115]
    v_mfma_f32_16x16x32_bf16 v[120:123], a[120:123], a[100:103], v[120:123]
    ds_read_b128 a[32:35], v5 offset:2048
    v_mfma_f32_16x16x32_bf16 v[144:147], a[88:91], a[100:103], v[144:147]
    v_mfma_f32_16x16x32_bf16 v[152:155], a[124:127], a[100:103], v[152:155]
    ds_read_b128 a[68:71], v5 offset:2304
    v_mfma_f32_16x16x32_bf16 v[176:179], a[92:95], a[100:103], v[176:179]
    v_mfma_f32_16x16x32_bf16 v[184:187], a[128:131], a[100:103], v[184:187]
    v_mfma_f32_16x16x32_bf16 v[208:211], a[96:99], a[100:103], v[208:211]
    ds_read_b128 a[36:39], v4 offset:256
    v_mfma_f32_16x16x32_bf16 v[216:219], a[132:135], a[100:103], v[216:219]
    v_mfma_f32_16x16x32_bf16 v[220:223], a[132:135], a[136:139], v[220:223]
    ds_read_b128 a[4:7], v4 offset:2048
    v_mfma_f32_16x16x32_bf16 v[212:215], a[96:99], a[136:139], v[212:215]
    v_mfma_f32_16x16x32_bf16 v[188:191], a[128:131], a[136:139], v[188:191]
    buffer_load_dwordx4 a[144:147], v12, s[4:7], s14 offen offset:0
    v_mfma_f32_16x16x32_bf16 v[180:183], a[92:95], a[136:139], v[180:183]
    ds_read_b128 a[40:43], v4 offset:2304
    v_mfma_f32_16x16x32_bf16 v[156:159], a[124:127], a[136:139], v[156:159]
    v_mfma_f32_16x16x32_bf16 v[148:151], a[88:91], a[136:139], v[148:151]
    ds_read_b128 a[8:11], v4 offset:4096
    v_mfma_f32_16x16x32_bf16 v[124:127], a[120:123], a[136:139], v[124:127]
    v_mfma_f32_16x16x32_bf16 v[116:119], a[84:87], a[136:139], v[116:119]
    v_mfma_f32_16x16x32_bf16 v[92:95], a[116:119], a[136:139], v[92:95]
    ds_read_b128 a[44:47], v4 offset:4352
    v_mfma_f32_16x16x32_bf16 v[84:87], a[80:83], a[136:139], v[84:87]
    v_mfma_f32_16x16x32_bf16 v[60:63], a[112:115], a[136:139], v[60:63]
    ds_read_b128 a[12:15], v4 offset:6144
    v_mfma_f32_16x16x32_bf16 v[52:55], a[76:79], a[136:139], v[52:55]
    v_mfma_f32_16x16x32_bf16 v[28:31], a[108:111], a[136:139], v[28:31]
    v_mfma_f32_16x16x32_bf16 v[20:23], a[72:75], a[136:139], v[20:23]
    ds_read_b128 a[48:51], v4 offset:6400
    buffer_load_dwordx4 a[148:151], v12, s[4:7], s14 offen offset:16
    v_mfma_f32_16x16x32_bf16 v[32:35], a[72:75], a[104:107], v[32:35]
    v_mfma_f32_16x16x32_bf16 v[40:43], a[108:111], a[104:107], v[40:43]
    ds_read_b128 a[16:19], v4 offset:8192
    v_mfma_f32_16x16x32_bf16 v[64:67], a[76:79], a[104:107], v[64:67]
    v_mfma_f32_16x16x32_bf16 v[72:75], a[112:115], a[104:107], v[72:75]
    v_mfma_f32_16x16x32_bf16 v[96:99], a[80:83], a[104:107], v[96:99]
    ds_read_b128 a[52:55], v4 offset:8448
    v_mfma_f32_16x16x32_bf16 v[104:107], a[116:119], a[104:107], v[104:107]
    v_mfma_f32_16x16x32_bf16 v[128:131], a[84:87], a[104:107], v[128:131]
    ds_read_b128 a[20:23], v4 offset:10240
    v_mfma_f32_16x16x32_bf16 v[136:139], a[120:123], a[104:107], v[136:139]
    v_mfma_f32_16x16x32_bf16 v[160:163], a[88:91], a[104:107], v[160:163]
    v_mfma_f32_16x16x32_bf16 v[168:171], a[124:127], a[104:107], v[168:171]
    ds_read_b128 a[56:59], v4 offset:10496
    v_mfma_f32_16x16x32_bf16 v[192:195], a[92:95], a[104:107], v[192:195]
    buffer_load_dwordx4 a[152:155], v12, s[4:7], s14 offen offset:2048
    v_mfma_f32_16x16x32_bf16 v[200:203], a[128:131], a[104:107], v[200:203]
    ds_read_b128 a[24:27], v4 offset:12288
    v_mfma_f32_16x16x32_bf16 v[224:227], a[96:99], a[104:107], v[224:227]
    v_mfma_f32_16x16x32_bf16 v[232:235], a[132:135], a[104:107], v[232:235]
    v_mfma_f32_16x16x32_bf16 v[236:239], a[132:135], a[140:143], v[236:239]
    ds_read_b128 a[60:63], v4 offset:12544
    v_mfma_f32_16x16x32_bf16 v[228:231], a[96:99], a[140:143], v[228:231]
    s_add_u32 s40, s41, 30720
    s_cmp_eq_u32 s40, 153600
    s_cselect_b32 s40, 0, s40
    v_mfma_f32_16x16x32_bf16 v[204:207], a[128:131], a[140:143], v[204:207]
    v_mfma_f32_16x16x32_bf16 v[196:199], a[92:95], a[140:143], v[196:199]
    v_mfma_f32_16x16x32_bf16 v[172:175], a[124:127], a[140:143], v[172:175]
    v_mfma_f32_16x16x32_bf16 v[164:167], a[88:91], a[140:143], v[164:167]
    v_add_u32 v4, s40, v2
    v_mfma_f32_16x16x32_bf16 v[140:143], a[120:123], a[140:143], v[140:143]
    v_mfma_f32_16x16x32_bf16 v[132:135], a[84:87], a[140:143], v[132:135]
    buffer_load_dwordx4 a[156:159], v12, s[4:7], s14 offen offset:2064
    v_mfma_f32_16x16x32_bf16 v[108:111], a[116:119], a[140:143], v[108:111]
    v_mfma_f32_16x16x32_bf16 v[100:103], a[80:83], a[140:143], v[100:103]
    v_add_u32 v5, s40, v3
    v_mfma_f32_16x16x32_bf16 v[76:79], a[112:115], a[140:143], v[76:79]
    v_mfma_f32_16x16x32_bf16 v[68:71], a[76:79], a[140:143], v[68:71]
    v_mfma_f32_16x16x32_bf16 v[44:47], a[108:111], a[140:143], v[44:47]
    v_mfma_f32_16x16x32_bf16 v[36:39], a[72:75], a[140:143], v[36:39]
    s_waitcnt vmcnt(16) lgkmcnt(0)
    s_barrier
    v_mfma_f32_16x16x32_bf16 v[16:19], a[0:3], a[28:31], v[16:19]
    ds_read_b128 a[72:75], v4 offset:0
    v_mfma_f32_16x16x32_bf16 v[24:27], a[36:39], a[28:31], v[24:27]
    v_mfma_f32_16x16x32_bf16 v[48:51], a[4:7], a[28:31], v[48:51]
    ds_read_b128 a[100:103], v5 offset:0
    v_mfma_f32_16x16x32_bf16 v[56:59], a[40:43], a[28:31], v[56:59]
    v_mfma_f32_16x16x32_bf16 v[80:83], a[8:11], a[28:31], v[80:83]
    ds_read_b128 a[136:139], v5 offset:256
    v_mfma_f32_16x16x32_bf16 v[88:91], a[44:47], a[28:31], v[88:91]
    v_mfma_f32_16x16x32_bf16 v[112:115], a[12:15], a[28:31], v[112:115]
    v_mfma_f32_16x16x32_bf16 v[120:123], a[48:51], a[28:31], v[120:123]
    ds_read_b128 a[104:107], v5 offset:2048
    buffer_load_dwordx4 a[160:163], v12, s[4:7], s15 offen offset:0
    v_mfma_f32_16x16x32_bf16 v[144:147], a[16:19], a[28:31], v[144:147]
    v_mfma_f32_16x16x32_bf16 v[152:155], a[52:55], a[28:31], v[152:155]
    ds_read_b128 a[140:143], v5 offset:2304
    v_mfma_f32_16x16x32_bf16 v[176:179], a[20:23], a[28:31], v[176:179]
    v_mfma_f32_16x16x32_bf16 v[184:187], a[56:59], a[28:31], v[184:187]
    v_mfma_f32_16x16x32_bf16 v[208:211], a[24:27], a[28:31], v[208:211]
    ds_read_b128 a[108:111], v4 offset:256
    v_mfma_f32_16x16x32_bf16 v[216:219], a[60:63], a[28:31], v[216:219]
    v_mfma_f32_16x16x32_bf16 v[220:223], a[60:63], a[64:67], v[220:223]
    ds_read_b128 a[76:79], v4 offset:2048
    v_mfma_f32_16x16x32_bf16 v[212:215], a[24:27], a[64:67], v[212:215]
    v_mfma_f32_16x16x32_bf16 v[188:191], a[56:59], a[64:67], v[188:191]
    v_mfma_f32_16x16x32_bf16 v[180:183], a[20:23], a[64:67], v[180:183]
    ds_read_b128 a[112:115], v4 offset:2304
    v_mfma_f32_16x16x32_bf16 v[156:159], a[52:55], a[64:67], v[156:159]
    v_mfma_f32_16x16x32_bf16 v[148:151], a[16:19], a[64:67], v[148:151]
    ds_read_b128 a[80:83], v4 offset:4096
    v_mfma_f32_16x16x32_bf16 v[124:127], a[48:51], a[64:67], v[124:127]
    v_mfma_f32_16x16x32_bf16 v[116:119], a[12:15], a[64:67], v[116:119]
    buffer_load_dwordx4 a[164:167], v12, s[4:7], s15 offen offset:16
    v_mfma_f32_16x16x32_bf16 v[92:95], a[44:47], a[64:67], v[92:95]
    ds_read_b128 a[116:119], v4 offset:4352
    v_mfma_f32_16x16x32_bf16 v[84:87], a[8:11], a[64:67], v[84:87]
    v_mfma_f32_16x16x32_bf16 v[60:63], a[40:43], a[64:67], v[60:63]
    ds_read_b128 a[84:87], v4 offset:6144
    v_mfma_f32_16x16x32_bf16 v[52:55], a[4:7], a[64:67], v[52:55]
    v_mfma_f32_16x16x32_bf16 v[28:31], a[36:39], a[64:67], v[28:31]
    v_mfma_f32_16x16x32_bf16 v[20:23], a[0:3], a[64:67], v[20:23]
    ds_read_b128 a[120:123], v4 offset:6400
    v_mfma_f32_16x16x32_bf16 v[32:35], a[0:3], a[32:35], v[32:35]
    v_mfma_f32_16x16x32_bf16 v[40:43], a[36:39], a[32:35], v[40:43]
    ds_read_b128 a[88:91], v4 offset:8192
    v_mfma_f32_16x16x32_bf16 v[64:67], a[4:7], a[32:35], v[64:67]
    v_mfma_f32_16x16x32_bf16 v[72:75], a[40:43], a[32:35], v[72:75]
    v_mfma_f32_16x16x32_bf16 v[96:99], a[8:11], a[32:35], v[96:99]
    ds_read_b128 a[124:127], v4 offset:8448
    v_mfma_f32_16x16x32_bf16 v[104:107], a[44:47], a[32:35], v[104:107]
    v_mfma_f32_16x16x32_bf16 v[128:131], a[12:15], a[32:35], v[128:131]
    ds_read_b128 a[92:95], v4 offset:10240
    v_mfma_f32_16x16x32_bf16 v[136:139], a[48:51], a[32:35], v[136:139]
    buffer_load_dwordx4 a[168:171], v12, s[4:7], s15 offen offset:2048
    v_mfma_f32_16x16x32_bf16 v[160:163], a[16:19], a[32:35], v[160:163]
    v_mfma_f32_16x16x32_bf16 v[168:171], a[52:55], a[32:35], v[168:171]
    ds_read_b128 a[128:131], v4 offset:10496
    v_mfma_f32_16x16x32_bf16 v[192:195], a[20:23], a[32:35], v[192:195]
    v_mfma_f32_16x16x32_bf16 v[200:203], a[56:59], a[32:35], v[200:203]
    ds_read_b128 a[96:99], v4 offset:12288
    v_mfma_f32_16x16x32_bf16 v[224:227], a[24:27], a[32:35], v[224:227]
    v_mfma_f32_16x16x32_bf16 v[232:235], a[60:63], a[32:35], v[232:235]
    v_mfma_f32_16x16x32_bf16 v[236:239], a[60:63], a[68:71], v[236:239]
    ds_read_b128 a[132:135], v4 offset:12544
    v_mfma_f32_16x16x32_bf16 v[228:231], a[24:27], a[68:71], v[228:231]
    s_add_u32 s41, s40, 30720
    s_cmp_eq_u32 s41, 153600
    s_cselect_b32 s41, 0, s41
    v_mfma_f32_16x16x32_bf16 v[204:207], a[56:59], a[68:71], v[204:207]
    v_mfma_f32_16x16x32_bf16 v[196:199], a[20:23], a[68:71], v[196:199]
    v_mfma_f32_16x16x32_bf16 v[172:175], a[52:55], a[68:71], v[172:175]
    v_mfma_f32_16x16x32_bf16 v[164:167], a[16:19], a[68:71], v[164:167]
    v_add_u32 v4, s41, v2
    v_mfma_f32_16x16x32_bf16 v[140:143], a[48:51], a[68:71], v[140:143]
    v_mfma_f32_16x16x32_bf16 v[132:135], a[12:15], a[68:71], v[132:135]
    buffer_load_dwordx4 a[172:175], v12, s[4:7], s15 offen offset:2064
    v_mfma_f32_16x16x32_bf16 v[108:111], a[44:47], a[68:71], v[108:111]
    v_mfma_f32_16x16x32_bf16 v[100:103], a[8:11], a[68:71], v[100:103]
    v_add_u32 v5, s41, v3
    v_mfma_f32_16x16x32_bf16 v[76:79], a[40:43], a[68:71], v[76:79]
    v_mfma_f32_16x16x32_bf16 v[68:71], a[4:7], a[68:71], v[68:71]
    v_mfma_f32_16x16x32_bf16 v[44:47], a[36:39], a[68:71], v[44:47]
    v_mfma_f32_16x16x32_bf16 v[36:39], a[0:3], a[68:71], v[36:39]
    s_waitcnt vmcnt(14) lgkmcnt(0)
    s_barrier
    v_mfma_f32_16x16x32_bf16 v[16:19], a[72:75], a[100:103], v[16:19]
    ds_read_b128 a[0:3], v4 offset:0
    v_mfma_f32_16x16x32_bf16 v[24:27], a[108:111], a[100:103], v[24:27]
    v_mfma_f32_16x16x32_bf16 v[48:51], a[76:79], a[100:103], v[48:51]
    ds_read_b128 a[28:31], v5 offset:0
    v_mfma_f32_16x16x32_bf16 v[56:59], a[112:115], a[100:103], v[56:59]
    v_mfma_f32_16x16x32_bf16 v[80:83], a[80:83], a[100:103], v[80:83]
    ds_read_b128 a[64:67], v5 offset:256
    v_mfma_f32_16x16x32_bf16 v[88:91], a[116:119], a[100:103], v[88:91]
    v_mfma_f32_16x16x32_bf16 v[112:115], a[84:87], a[100:103], v[112:115]
    v_mfma_f32_16x16x32_bf16 v[120:123], a[120:123], a[100:103], v[120:123]
    ds_read_b128 a[32:35], v5 offset:2048
    v_mfma_f32_16x16x32_bf16 v[144:147], a[88:91], a[100:103], v[144:147]
    v_mfma_f32_16x16x32_bf16 v[152:155], a[124:127], a[100:103], v[152:155]
    ds_read_b128 a[68:71], v5 offset:2304
    v_mfma_f32_16x16x32_bf16 v[176:179], a[92:95], a[100:103], v[176:179]
    v_mfma_f32_16x16x32_bf16 v[184:187], a[128:131], a[100:103], v[184:187]
    v_mfma_f32_16x16x32_bf16 v[208:211], a[96:99], a[100:103], v[208:211]
    ds_read_b128 a[36:39], v4 offset:256
    v_mfma_f32_16x16x32_bf16 v[216:219], a[132:135], a[100:103], v[216:219]
    v_mfma_f32_16x16x32_bf16 v[220:223], a[132:135], a[136:139], v[220:223]
    ds_read_b128 a[4:7], v4 offset:2048
    v_mfma_f32_16x16x32_bf16 v[212:215], a[96:99], a[136:139], v[212:215]
    v_mfma_f32_16x16x32_bf16 v[188:191], a[128:131], a[136:139], v[188:191]
    v_mfma_f32_16x16x32_bf16 v[180:183], a[92:95], a[136:139], v[180:183]
    ds_read_b128 a[40:43], v4 offset:2304
    v_mfma_f32_16x16x32_bf16 v[156:159], a[124:127], a[136:139], v[156:159]
    v_mfma_f32_16x16x32_bf16 v[148:151], a[88:91], a[136:139], v[148:151]
    ds_read_b128 a[8:11], v4 offset:4096
    v_mfma_f32_16x16x32_bf16 v[124:127], a[120:123], a[136:139], v[124:127]
    v_mfma_f32_16x16x32_bf16 v[116:119], a[84:87], a[136:139], v[116:119]
    v_mfma_f32_16x16x32_bf16 v[92:95], a[116:119], a[136:139], v[92:95]
    ds_read_b128 a[44:47], v4 offset:4352
    v_mfma_f32_16x16x32_bf16 v[84:87], a[80:83], a[136:139], v[84:87]
    v_mfma_f32_16x16x32_bf16 v[60:63], a[112:115], a[136:139], v[60:63]
    ds_read_b128 a[12:15], v4 offset:6144
    v_mfma_f32_16x16x32_bf16 v[52:55], a[76:79], a[136:139], v[52:55]
    v_mfma_f32_16x16x32_bf16 v[28:31], a[108:111], a[136:139], v[28:31]
    v_mfma_f32_16x16x32_bf16 v[20:23], a[72:75], a[136:139], v[20:23]
    ds_read_b128 a[48:51], v4 offset:6400
    v_mfma_f32_16x16x32_bf16 v[32:35], a[72:75], a[104:107], v[32:35]
    v_mfma_f32_16x16x32_bf16 v[40:43], a[108:111], a[104:107], v[40:43]
    ds_read_b128 a[16:19], v4 offset:8192
    v_mfma_f32_16x16x32_bf16 v[64:67], a[76:79], a[104:107], v[64:67]
    v_mfma_f32_16x16x32_bf16 v[72:75], a[112:115], a[104:107], v[72:75]
    v_mfma_f32_16x16x32_bf16 v[96:99], a[80:83], a[104:107], v[96:99]
    ds_read_b128 a[52:55], v4 offset:8448
    v_mfma_f32_16x16x32_bf16 v[104:107], a[116:119], a[104:107], v[104:107]
    v_mfma_f32_16x16x32_bf16 v[128:131], a[84:87], a[104:107], v[128:131]
    ds_read_b128 a[20:23], v4 offset:10240
    v_mfma_f32_16x16x32_bf16 v[136:139], a[120:123], a[104:107], v[136:139]
    v_mfma_f32_16x16x32_bf16 v[160:163], a[88:91], a[104:107], v[160:163]
    v_mfma_f32_16x16x32_bf16 v[168:171], a[124:127], a[104:107], v[168:171]
    ds_read_b128 a[56:59], v4 offset:10496
    v_mfma_f32_16x16x32_bf16 v[192:195], a[92:95], a[104:107], v[192:195]
    v_mfma_f32_16x16x32_bf16 v[200:203], a[128:131], a[104:107], v[200:203]
    ds_read_b128 a[24:27], v4 offset:12288
    v_mfma_f32_16x16x32_bf16 v[224:227], a[96:99], a[104:107], v[224:227]
    v_mfma_f32_16x16x32_bf16 v[232:235], a[132:135], a[104:107], v[232:235]
    v_mfma_f32_16x16x32_bf16 v[236:239], a[132:135], a[140:143], v[236:239]
    ds_read_b128 a[60:63], v4 offset:12544
    v_mfma_f32_16x16x32_bf16 v[228:231], a[96:99], a[140:143], v[228:231]
    s_add_u32 s40, s41, 30720
    s_cmp_eq_u32 s40, 153600
    s_cselect_b32 s40, 0, s40
    v_mfma_f32_16x16x32_bf16 v[204:207], a[128:131], a[140:143], v[204:207]
    v_mfma_f32_16x16x32_bf16 v[196:199], a[92:95], a[140:143], v[196:199]
    v_mfma_f32_16x16x32_bf16 v[172:175], a[124:127], a[140:143], v[172:175]
    v_mfma_f32_16x16x32_bf16 v[164:167], a[88:91], a[140:143], v[164:167]
    v_add_u32 v4, s40, v2
    v_mfma_f32_16x16x32_bf16 v[140:143], a[120:123], a[140:143], v[140:143]
    v_mfma_f32_16x16x32_bf16 v[132:135], a[84:87], a[140:143], v[132:135]
    v_mfma_f32_16x16x32_bf16 v[108:111], a[116:119], a[140:143], v[108:111]
    v_mfma_f32_16x16x32_bf16 v[100:103], a[80:83], a[140:143], v[100:103]
    v_add_u32 v5, s40, v3
    v_mfma_f32_16x16x32_bf16 v[76:79], a[112:115], a[140:143], v[76:79]
    v_mfma_f32_16x16x32_bf16 v[68:71], a[76:79], a[140:143], v[68:71]
    v_mfma_f32_16x16x32_bf16 v[44:47], a[108:111], a[140:143], v[44:47]
    v_mfma_f32_16x16x32_bf16 v[36:39], a[72:75], a[140:143], v[36:39]
    s_waitcnt vmcnt(8) lgkmcnt(0)
    s_barrier
    v_mfma_f32_16x16x32_bf16 v[16:19], a[0:3], a[28:31], v[16:19]
    ds_read_b128 a[72:75], v4 offset:0
    v_mfma_f32_16x16x32_bf16 v[24:27], a[36:39], a[28:31], v[24:27]
    v_mfma_f32_16x16x32_bf16 v[48:51], a[4:7], a[28:31], v[48:51]
    ds_read_b128 a[100:103], v5 offset:0
    v_mfma_f32_16x16x32_bf16 v[56:59], a[40:43], a[28:31], v[56:59]
    v_mfma_f32_16x16x32_bf16 v[80:83], a[8:11], a[28:31], v[80:83]
    ds_read_b128 a[136:139], v5 offset:256
    v_mfma_f32_16x16x32_bf16 v[88:91], a[44:47], a[28:31], v[88:91]
    v_mfma_f32_16x16x32_bf16 v[112:115], a[12:15], a[28:31], v[112:115]
    v_mfma_f32_16x16x32_bf16 v[120:123], a[48:51], a[28:31], v[120:123]
    ds_read_b128 a[104:107], v5 offset:2048
    v_mfma_f32_16x16x32_bf16 v[144:147], a[16:19], a[28:31], v[144:147]
    v_mfma_f32_16x16x32_bf16 v[152:155], a[52:55], a[28:31], v[152:155]
    ds_read_b128 a[140:143], v5 offset:2304
    v_mfma_f32_16x16x32_bf16 v[176:179], a[20:23], a[28:31], v[176:179]
    v_mfma_f32_16x16x32_bf16 v[184:187], a[56:59], a[28:31], v[184:187]
    v_mfma_f32_16x16x32_bf16 v[208:211], a[24:27], a[28:31], v[208:211]
    ds_read_b128 a[108:111], v4 offset:256
    v_mfma_f32_16x16x32_bf16 v[216:219], a[60:63], a[28:31], v[216:219]
    v_mfma_f32_16x16x32_bf16 v[220:223], a[60:63], a[64:67], v[220:223]
    ds_read_b128 a[76:79], v4 offset:2048
    v_mfma_f32_16x16x32_bf16 v[212:215], a[24:27], a[64:67], v[212:215]
    v_mfma_f32_16x16x32_bf16 v[188:191], a[56:59], a[64:67], v[188:191]
    v_mfma_f32_16x16x32_bf16 v[180:183], a[20:23], a[64:67], v[180:183]
    ds_read_b128 a[112:115], v4 offset:2304
    v_mfma_f32_16x16x32_bf16 v[156:159], a[52:55], a[64:67], v[156:159]
    v_mfma_f32_16x16x32_bf16 v[148:151], a[16:19], a[64:67], v[148:151]
    ds_read_b128 a[80:83], v4 offset:4096
    v_mfma_f32_16x16x32_bf16 v[124:127], a[48:51], a[64:67], v[124:127]
    v_mfma_f32_16x16x32_bf16 v[116:119], a[12:15], a[64:67], v[116:119]
    v_mfma_f32_16x16x32_bf16 v[92:95], a[44:47], a[64:67], v[92:95]
    ds_read_b128 a[116:119], v4 offset:4352
    v_mfma_f32_16x16x32_bf16 v[84:87], a[8:11], a[64:67], v[84:87]
    v_mfma_f32_16x16x32_bf16 v[60:63], a[40:43], a[64:67], v[60:63]
    ds_read_b128 a[84:87], v4 offset:6144
    v_mfma_f32_16x16x32_bf16 v[52:55], a[4:7], a[64:67], v[52:55]
    v_mfma_f32_16x16x32_bf16 v[28:31], a[36:39], a[64:67], v[28:31]
    v_mfma_f32_16x16x32_bf16 v[20:23], a[0:3], a[64:67], v[20:23]
    ds_read_b128 a[120:123], v4 offset:6400
    v_mfma_f32_16x16x32_bf16 v[32:35], a[0:3], a[32:35], v[32:35]
    v_mfma_f32_16x16x32_bf16 v[40:43], a[36:39], a[32:35], v[40:43]
    ds_read_b128 a[88:91], v4 offset:8192
    v_mfma_f32_16x16x32_bf16 v[64:67], a[4:7], a[32:35], v[64:67]
    v_mfma_f32_16x16x32_bf16 v[72:75], a[40:43], a[32:35], v[72:75]
    v_mfma_f32_16x16x32_bf16 v[96:99], a[8:11], a[32:35], v[96:99]
    ds_read_b128 a[124:127], v4 offset:8448
    v_mfma_f32_16x16x32_bf16 v[104:107], a[44:47], a[32:35], v[104:107]
    v_mfma_f32_16x16x32_bf16 v[128:131], a[12:15], a[32:35], v[128:131]
    ds_read_b128 a[92:95], v4 offset:10240
    v_mfma_f32_16x16x32_bf16 v[136:139], a[48:51], a[32:35], v[136:139]
    v_mfma_f32_16x16x32_bf16 v[160:163], a[16:19], a[32:35], v[160:163]
    v_mfma_f32_16x16x32_bf16 v[168:171], a[52:55], a[32:35], v[168:171]
    ds_read_b128 a[128:131], v4 offset:10496
    v_mfma_f32_16x16x32_bf16 v[192:195], a[20:23], a[32:35], v[192:195]
    v_mfma_f32_16x16x32_bf16 v[200:203], a[56:59], a[32:35], v[200:203]
    ds_read_b128 a[96:99], v4 offset:12288
    v_mfma_f32_16x16x32_bf16 v[224:227], a[24:27], a[32:35], v[224:227]
    v_mfma_f32_16x16x32_bf16 v[232:235], a[60:63], a[32:35], v[232:235]
    v_mfma_f32_16x16x32_bf16 v[236:239], a[60:63], a[68:71], v[236:239]
    ds_read_b128 a[132:135], v4 offset:12544
    v_mfma_f32_16x16x32_bf16 v[228:231], a[24:27], a[68:71], v[228:231]
    s_add_u32 s41, s40, 30720
    s_cmp_eq_u32 s41, 153600
    s_cselect_b32 s41, 0, s41
    v_mfma_f32_16x16x32_bf16 v[204:207], a[56:59], a[68:71], v[204:207]
    v_mfma_f32_16x16x32_bf16 v[196:199], a[20:23], a[68:71], v[196:199]
    v_mfma_f32_16x16x32_bf16 v[172:175], a[52:55], a[68:71], v[172:175]
    v_mfma_f32_16x16x32_bf16 v[164:167], a[16:19], a[68:71], v[164:167]
    v_add_u32 v4, s41, v2
    v_mfma_f32_16x16x32_bf16 v[140:143], a[48:51], a[68:71], v[140:143]
    v_mfma_f32_16x16x32_bf16 v[132:135], a[12:15], a[68:71], v[132:135]
    v_mfma_f32_16x16x32_bf16 v[108:111], a[44:47], a[68:71], v[108:111]
    v_mfma_f32_16x16x32_bf16 v[100:103], a[8:11], a[68:71], v[100:103]
    v_add_u32 v5, s41, v3
    v_mfma_f32_16x16x32_bf16 v[76:79], a[40:43], a[68:71], v[76:79]
    v_mfma_f32_16x16x32_bf16 v[68:71], a[4:7], a[68:71], v[68:71]
    v_mfma_f32_16x16x32_bf16 v[44:47], a[36:39], a[68:71], v[44:47]
    v_mfma_f32_16x16x32_bf16 v[36:39], a[0:3], a[68:71], v[36:39]
    s_waitcnt lgkmcnt(0)
    v_mfma_f32_16x16x32_bf16 v[16:19], a[72:75], a[100:103], v[16:19]
    v_mfma_f32_16x16x32_bf16 v[24:27], a[108:111], a[100:103], v[24:27]
    v_mfma_f32_16x16x32_bf16 v[48:51], a[76:79], a[100:103], v[48:51]
    v_mfma_f32_16x16x32_bf16 v[56:59], a[112:115], a[100:103], v[56:59]
    v_mfma_f32_16x16x32_bf16 v[80:83], a[80:83], a[100:103], v[80:83]
    v_mfma_f32_16x16x32_bf16 v[88:91], a[116:119], a[100:103], v[88:91]
    v_mfma_f32_16x16x32_bf16 v[112:115], a[84:87], a[100:103], v[112:115]
    v_mfma_f32_16x16x32_bf16 v[120:123], a[120:123], a[100:103], v[120:123]
    v_mfma_f32_16x16x32_bf16 v[144:147], a[88:91], a[100:103], v[144:147]
    v_mfma_f32_16x16x32_bf16 v[152:155], a[124:127], a[100:103], v[152:155]
    v_mfma_f32_16x16x32_bf16 v[176:179], a[92:95], a[100:103], v[176:179]
    v_mfma_f32_16x16x32_bf16 v[184:187], a[128:131], a[100:103], v[184:187]
    v_mfma_f32_16x16x32_bf16 v[208:211], a[96:99], a[100:103], v[208:211]
    v_mfma_f32_16x16x32_bf16 v[216:219], a[132:135], a[100:103], v[216:219]
    v_mfma_f32_16x16x32_bf16 v[220:223], a[132:135], a[136:139], v[220:223]
    v_mfma_f32_16x16x32_bf16 v[212:215], a[96:99], a[136:139], v[212:215]
    v_mfma_f32_16x16x32_bf16 v[188:191], a[128:131], a[136:139], v[188:191]
    v_mfma_f32_16x16x32_bf16 v[180:183], a[92:95], a[136:139], v[180:183]
    v_mfma_f32_16x16x32_bf16 v[156:159], a[124:127], a[136:139], v[156:159]
    v_mfma_f32_16x16x32_bf16 v[148:151], a[88:91], a[136:139], v[148:151]
    v_mfma_f32_16x16x32_bf16 v[124:127], a[120:123], a[136:139], v[124:127]
    v_mfma_f32_16x16x32_bf16 v[116:119], a[84:87], a[136:139], v[116:119]
    v_mfma_f32_16x16x32_bf16 v[92:95], a[116:119], a[136:139], v[92:95]
    v_mfma_f32_16x16x32_bf16 v[84:87], a[80:83], a[136:139], v[84:87]
    v_mfma_f32_16x16x32_bf16 v[60:63], a[112:115], a[136:139], v[60:63]
    v_mfma_f32_16x16x32_bf16 v[52:55], a[76:79], a[136:139], v[52:55]
    v_mfma_f32_16x16x32_bf16 v[28:31], a[108:111], a[136:139], v[28:31]
    v_mfma_f32_16x16x32_bf16 v[20:23], a[72:75], a[136:139], v[20:23]
    v_mfma_f32_16x16x32_bf16 v[32:35], a[72:75], a[104:107], v[32:35]
    v_mfma_f32_16x16x32_bf16 v[40:43], a[108:111], a[104:107], v[40:43]
    v_mfma_f32_16x16x32_bf16 v[64:67], a[76:79], a[104:107], v[64:67]
    v_mfma_f32_16x16x32_bf16 v[72:75], a[112:115], a[104:107], v[72:75]
    v_mfma_f32_16x16x32_bf16 v[96:99], a[80:83], a[104:107], v[96:99]
    v_mfma_f32_16x16x32_bf16 v[104:107], a[116:119], a[104:107], v[104:107]
    v_mfma_f32_16x16x32_bf16 v[128:131], a[84:87], a[104:107], v[128:131]
    v_mfma_f32_16x16x32_bf16 v[136:139], a[120:123], a[104:107], v[136:139]
    v_mfma_f32_16x16x32_bf16 v[160:163], a[88:91], a[104:107], v[160:163]
    v_mfma_f32_16x16x32_bf16 v[168:171], a[124:127], a[104:107], v[168:171]
    v_mfma_f32_16x16x32_bf16 v[192:195], a[92:95], a[104:107], v[192:195]
    v_mfma_f32_16x16x32_bf16 v[200:203], a[128:131], a[104:107], v[200:203]
    v_mfma_f32_16x16x32_bf16 v[224:227], a[96:99], a[104:107], v[224:227]
    v_mfma_f32_16x16x32_bf16 v[232:235], a[132:135], a[104:107], v[232:235]
    v_mfma_f32_16x16x32_bf16 v[236:239], a[132:135], a[140:143], v[236:239]
    v_mfma_f32_16x16x32_bf16 v[228:231], a[96:99], a[140:143], v[228:231]
    v_mfma_f32_16x16x32_bf16 v[204:207], a[128:131], a[140:143], v[204:207]
    v_mfma_f32_16x16x32_bf16 v[196:199], a[92:95], a[140:143], v[196:199]
    v_mfma_f32_16x16x32_bf16 v[172:175], a[124:127], a[140:143], v[172:175]
    v_mfma_f32_16x16x32_bf16 v[164:167], a[88:91], a[140:143], v[164:167]
    v_mfma_f32_16x16x32_bf16 v[140:143], a[120:123], a[140:143], v[140:143]
    v_mfma_f32_16x16x32_bf16 v[132:135], a[84:87], a[140:143], v[132:135]
    v_mfma_f32_16x16x32_bf16 v[108:111], a[116:119], a[140:143], v[108:111]
    v_mfma_f32_16x16x32_bf16 v[100:103], a[80:83], a[140:143], v[100:103]
    v_mfma_f32_16x16x32_bf16 v[76:79], a[112:115], a[140:143], v[76:79]
    v_mfma_f32_16x16x32_bf16 v[68:71], a[76:79], a[140:143], v[68:71]
    v_mfma_f32_16x16x32_bf16 v[44:47], a[108:111], a[140:143], v[44:47]
    v_mfma_f32_16x16x32_bf16 v[36:39], a[72:75], a[140:143], v[36:39]
    s_waitcnt vmcnt(0)
    v_and_b32 v2, 1, v11
    v_lshlrev_b32 v2, 5, v2
    v_lshrrev_b32 v3, 1, v11
    v_lshl_add_u32 v2, v3, 4, v2
    v_add_u32 v2, v2, v10
    v_lshlrev_b32 v2, 4, v2
    v_lshlrev_b32 v3, 4, v11
    v_add_u32 v3, 153600, v3
    v_accvgpr_read_b32 v4, a144
    v_accvgpr_read_b32 v5, a145
    v_accvgpr_read_b32 v6, a146
    v_accvgpr_read_b32 v7, a147
    v_pk_add_f32 v[4:5], v[4:5], v[6:7]
    v_accvgpr_read_b32 v6, a148
    v_accvgpr_read_b32 v7, a149
    v_pk_add_f32 v[4:5], v[4:5], v[6:7]
    v_accvgpr_read_b32 v6, a150
    v_accvgpr_read_b32 v7, a151
    v_pk_add_f32 v[4:5], v[4:5], v[6:7]
    v_mov_b32 v6, v4
    v_mov_b32 v7, v5
    s_nop 0
    v_permlane16_swap_b32 v4, v6
    v_permlane16_swap_b32 v5, v7
    v_pk_add_f32 v[4:5], v[4:5], v[6:7]
    v_mov_b32 v6, v4
    v_mov_b32 v7, v5
    s_nop 0
    v_permlane32_swap_b32 v4, v6
    v_permlane32_swap_b32 v5, v7
    v_pk_add_f32 v[4:5], v[4:5], v[6:7]
    v_mul_f32 v4, 0x3a800000, v4
    v_mul_f32 v5, 0x3a800000, v5
    v_fma_f32 v5, -v4, v4, v5
    v_max_f32 v5, 0, v5
    v_add_f32 v5, 0x3727c5ac, v5
    v_rsq_f32 v240, v5
    s_nop 0
    v_mul_f32 v241, -v4, v240
    v_accvgpr_read_b32 v4, a152
    v_accvgpr_read_b32 v5, a153
    v_accvgpr_read_b32 v6, a154
    v_accvgpr_read_b32 v7, a155
    v_pk_add_f32 v[4:5], v[4:5], v[6:7]
    v_accvgpr_read_b32 v6, a156
    v_accvgpr_read_b32 v7, a157
    v_pk_add_f32 v[4:5], v[4:5], v[6:7]
    v_accvgpr_read_b32 v6, a158
    v_accvgpr_read_b32 v7, a159
    v_pk_add_f32 v[4:5], v[4:5], v[6:7]
    v_mov_b32 v6, v4
    v_mov_b32 v7, v5
    s_nop 0
    v_permlane16_swap_b32 v4, v6
    v_permlane16_swap_b32 v5, v7
    v_pk_add_f32 v[4:5], v[4:5], v[6:7]
    v_mov_b32 v6, v4
    v_mov_b32 v7, v5
    s_nop 0
    v_permlane32_swap_b32 v4, v6
    v_permlane32_swap_b32 v5, v7
    v_pk_add_f32 v[4:5], v[4:5], v[6:7]
    v_mul_f32 v4, 0x3a800000, v4
    v_mul_f32 v5, 0x3a800000, v5
    v_fma_f32 v5, -v4, v4, v5
    v_max_f32 v5, 0, v5
    v_add_f32 v5, 0x3727c5ac, v5
    v_rsq_f32 v242, v5
    s_nop 0
    v_mul_f32 v243, -v4, v242
    v_accvgpr_read_b32 v4, a160
    v_accvgpr_read_b32 v5, a161
    v_accvgpr_read_b32 v6, a162
    v_accvgpr_read_b32 v7, a163
    v_pk_add_f32 v[4:5], v[4:5], v[6:7]
    v_accvgpr_read_b32 v6, a164
    v_accvgpr_read_b32 v7, a165
    v_pk_add_f32 v[4:5], v[4:5], v[6:7]
    v_accvgpr_read_b32 v6, a166
    v_accvgpr_read_b32 v7, a167
    v_pk_add_f32 v[4:5], v[4:5], v[6:7]
    v_mov_b32 v6, v4
    v_mov_b32 v7, v5
    s_nop 0
    v_permlane16_swap_b32 v4, v6
    v_permlane16_swap_b32 v5, v7
    v_pk_add_f32 v[4:5], v[4:5], v[6:7]
    v_mov_b32 v6, v4
    v_mov_b32 v7, v5
    s_nop 0
    v_permlane32_swap_b32 v4, v6
    v_permlane32_swap_b32 v5, v7
    v_pk_add_f32 v[4:5], v[4:5], v[6:7]
    v_mul_f32 v4, 0x3a800000, v4
    v_mul_f32 v5, 0x3a800000, v5
    v_fma_f32 v5, -v4, v4, v5
    v_max_f32 v5, 0, v5
    v_add_f32 v5, 0x3727c5ac, v5
    v_rsq_f32 v244, v5
    s_nop 0
    v_mul_f32 v245, -v4, v244
    v_accvgpr_read_b32 v4, a168
    v_accvgpr_read_b32 v5, a169
    v_accvgpr_read_b32 v6, a170
    v_accvgpr_read_b32 v7, a171
    v_pk_add_f32 v[4:5], v[4:5], v[6:7]
    v_accvgpr_read_b32 v6, a172
    v_accvgpr_read_b32 v7, a173
    v_pk_add_f32 v[4:5], v[4:5], v[6:7]
    v_accvgpr_read_b32 v6, a174
    v_accvgpr_read_b32 v7, a175
    v_pk_add_f32 v[4:5], v[4:5], v[6:7]
    v_mov_b32 v6, v4
    v_mov_b32 v7, v5
    s_nop 0
    v_permlane16_swap_b32 v4, v6
    v_permlane16_swap_b32 v5, v7
    v_pk_add_f32 v[4:5], v[4:5], v[6:7]
    v_mov_b32 v6, v4
    v_mov_b32 v7, v5
    s_nop 0
    v_permlane32_swap_b32 v4, v6
    v_permlane32_swap_b32 v5, v7
    v_pk_add_f32 v[4:5], v[4:5], v[6:7]
    v_mul_f32 v4, 0x3a800000, v4
    v_mul_f32 v5, 0x3a800000, v5
    v_fma_f32 v5, -v4, v4, v5
    v_max_f32 v5, 0, v5
    v_add_f32 v5, 0x3727c5ac, v5
    v_rsq_f32 v246, v5
    s_nop 0
    v_mul_f32 v247, -v4, v246
    ds_read_b128 v[8:11], v3 offset:0
    ds_read_b128 v[12:15], v3 offset:128
    s_mov_b32 s24, 0xc0135761
    s_mov_b32 s26, 0xbdd2d3e8
    s_mov_b32 s28, 1.0
    v_mov_b32 v0, s24
    v_mov_b32 v1, s24
    s_mul_i32 s14, s13, 229376
    s_lshl_b32 s15, s20, 10
    s_add_u32 s14, s14, s15
    s_add_u32 s14, s14, 50331648
    s_waitcnt lgkmcnt(0)
    ds_read_b128 v[248:251], v3 offset:64
    ds_read_b128 v[252:255], v3 offset:192
    v_pk_fma_f32 v[4:5], v[8:9], v[240:241], v[12:13] op_sel:[0,1,0] op_sel_hi:[1,1,1]
    v_pk_fma_f32 v[16:17], v[16:17], v[240:241], v[4:5] op_sel_hi:[1,0,1]
    v_pk_fma_f32 v[6:7], v[10:11], v[240:241], v[14:15] op_sel:[0,1,0] op_sel_hi:[1,1,1]
    v_pk_fma_f32 v[18:19], v[18:19], v[240:241], v[6:7] op_sel_hi:[1,0,1]
    v_pk_fma_f32 v[4:5], v[8:9], v[242:243], v[12:13] op_sel:[0,1,0] op_sel_hi:[1,1,1]
    v_pk_fma_f32 v[20:21], v[20:21], v[242:243], v[4:5] op_sel_hi:[1,0,1]
    v_pk_fma_f32 v[6:7], v[10:11], v[242:243], v[14:15] op_sel:[0,1,0] op_sel_hi:[1,1,1]
    v_pk_fma_f32 v[22:23], v[22:23], v[242:243], v[6:7] op_sel_hi:[1,0,1]
    v_pk_fma_f32 v[4:5], v[8:9], v[244:245], v[12:13] op_sel:[0,1,0] op_sel_hi:[1,1,1]
    v_pk_fma_f32 v[32:33], v[32:33], v[244:245], v[4:5] op_sel_hi:[1,0,1]
    v_pk_fma_f32 v[6:7], v[10:11], v[244:245], v[14:15] op_sel:[0,1,0] op_sel_hi:[1,1,1]
    v_pk_fma_f32 v[34:35], v[34:35], v[244:245], v[6:7] op_sel_hi:[1,0,1]
    v_pk_fma_f32 v[4:5], v[8:9], v[246:247], v[12:13] op_sel:[0,1,0] op_sel_hi:[1,1,1]
    v_pk_fma_f32 v[36:37], v[36:37], v[246:247], v[4:5] op_sel_hi:[1,0,1]
    v_pk_fma_f32 v[6:7], v[10:11], v[246:247], v[14:15] op_sel:[0,1,0] op_sel_hi:[1,1,1]
    v_pk_fma_f32 v[38:39], v[38:39], v[246:247], v[6:7] op_sel_hi:[1,0,1]
    s_waitcnt lgkmcnt(0)
    ds_read_b128 v[8:11], v3 offset:256
    ds_read_b128 v[12:15], v3 offset:384
    v_pk_fma_f32 v[4:5], v[248:249], v[240:241], v[252:253] op_sel:[0,1,0] op_sel_hi:[1,1,1]
    v_pk_fma_f32 v[24:25], v[24:25], v[240:241], v[4:5] op_sel_hi:[1,0,1]
    v_pk_fma_f32 v[6:7], v[250:251], v[240:241], v[254:255] op_sel:[0,1,0] op_sel_hi:[1,1,1]
    v_pk_fma_f32 v[26:27], v[26:27], v[240:241], v[6:7] op_sel_hi:[1,0,1]
    v_pk_fma_f32 v[4:5], v[248:249], v[242:243], v[252:253] op_sel:[0,1,0] op_sel_hi:[1,1,1]
    v_pk_fma_f32 v[28:29], v[28:29], v[242:243], v[4:5] op_sel_hi:[1,0,1]
    v_pk_fma_f32 v[6:7], v[250:251], v[242:243], v[254:255] op_sel:[0,1,0] op_sel_hi:[1,1,1]
    v_pk_fma_f32 v[30:31], v[30:31], v[242:243], v[6:7] op_sel_hi:[1,0,1]
    v_pk_fma_f32 v[4:5], v[248:249], v[244:245], v[252:253] op_sel:[0,1,0] op_sel_hi:[1,1,1]
    v_pk_fma_f32 v[40:41], v[40:41], v[244:245], v[4:5] op_sel_hi:[1,0,1]
    v_pk_fma_f32 v[6:7], v[250:251], v[244:245], v[254:255] op_sel:[0,1,0] op_sel_hi:[1,1,1]
    v_pk_fma_f32 v[42:43], v[42:43], v[244:245], v[6:7] op_sel_hi:[1,0,1]
    v_pk_fma_f32 v[4:5], v[248:249], v[246:247], v[252:253] op_sel:[0,1,0] op_sel_hi:[1,1,1]
    v_pk_fma_f32 v[44:45], v[44:45], v[246:247], v[4:5] op_sel_hi:[1,0,1]
    v_pk_fma_f32 v[6:7], v[250:251], v[246:247], v[254:255] op_sel:[0,1,0] op_sel_hi:[1,1,1]
    v_pk_fma_f32 v[46:47], v[46:47], v[246:247], v[6:7] op_sel_hi:[1,0,1]
    v_pk_mul_f32 v[4:5], v[16:17], v[16:17]
    v_pk_mul_f32 v[6:7], v[18:19], v[18:19]
    v_pk_fma_f32 v[4:5], v[4:5], s[26:27], v[0:1] op_sel_hi:[1,0,1]
    v_pk_fma_f32 v[6:7], v[6:7], s[26:27], v[0:1] op_sel_hi:[1,0,1]
    v_pk_mul_f32 v[4:5], v[4:5], v[16:17]
    v_pk_mul_f32 v[6:7], v[6:7], v[18:19]
    v_exp_f32 v4, v4
    v_exp_f32 v5, v5
    v_exp_f32 v6, v6
    v_exp_f32 v7, v7
    v_pk_mul_f32 v[16:17], v[16:17], v[24:25]
    v_pk_mul_f32 v[18:19], v[18:19], v[26:27]
    v_pk_add_f32 v[4:5], v[4:5], s[28:29] op_sel_hi:[1,0]
    v_pk_add_f32 v[6:7], v[6:7], s[28:29] op_sel_hi:[1,0]
    v_rcp_f32 v4, v4
    v_rcp_f32 v5, v5
    v_rcp_f32 v6, v6
    v_rcp_f32 v7, v7
    v_pk_mul_f32 v[16:17], v[16:17], v[4:5]
    v_pk_mul_f32 v[18:19], v[18:19], v[6:7]
    v_pk_mul_f32 v[4:5], v[20:21], v[20:21]
    v_pk_mul_f32 v[6:7], v[22:23], v[22:23]
    v_pk_fma_f32 v[4:5], v[4:5], s[26:27], v[0:1] op_sel_hi:[1,0,1]
    v_pk_fma_f32 v[6:7], v[6:7], s[26:27], v[0:1] op_sel_hi:[1,0,1]
    v_pk_mul_f32 v[4:5], v[4:5], v[20:21]
    v_pk_mul_f32 v[6:7], v[6:7], v[22:23]
    v_exp_f32 v4, v4
    v_exp_f32 v5, v5
    v_exp_f32 v6, v6
    v_exp_f32 v7, v7
    v_pk_mul_f32 v[20:21], v[20:21], v[28:29]
    v_pk_mul_f32 v[22:23], v[22:23], v[30:31]
    v_pk_add_f32 v[4:5], v[4:5], s[28:29] op_sel_hi:[1,0]
    v_pk_add_f32 v[6:7], v[6:7], s[28:29] op_sel_hi:[1,0]
    v_rcp_f32 v4, v4
    v_rcp_f32 v5, v5
    v_rcp_f32 v6, v6
    v_rcp_f32 v7, v7
    v_pk_mul_f32 v[20:21], v[20:21], v[4:5]
    v_pk_mul_f32 v[22:23], v[22:23], v[6:7]
    v_cvt_pk_bf16_f32 v24, v16, v17
    v_cvt_pk_bf16_f32 v25, v18, v19
    v_cvt_pk_bf16_f32 v26, v20, v21
    v_cvt_pk_bf16_f32 v27, v22, v23
    s_add_u32 s15, s14, 0
    v_permlane32_swap_b32 v24, v26
    v_permlane32_swap_b32 v25, v27
    buffer_store_dwordx4 v[24:27], v2, s[4:7], s15 offen sc0 sc1
    v_pk_mul_f32 v[4:5], v[32:33], v[32:33]
    v_pk_mul_f32 v[6:7], v[34:35], v[34:35]
    v_pk_fma_f32 v[4:5], v[4:5], s[26:27], v[0:1] op_sel_hi:[1,0,1]
    v_pk_fma_f32 v[6:7], v[6:7], s[26:27], v[0:1] op_sel_hi:[1,0,1]
    v_pk_mul_f32 v[4:5], v[4:5], v[32:33]
    v_pk_mul_f32 v[6:7], v[6:7], v[34:35]
    v_exp_f32 v4, v4
    v_exp_f32 v5, v5
    v_exp_f32 v6, v6
    v_exp_f32 v7, v7
    v_pk_mul_f32 v[32:33], v[32:33], v[40:41]
    v_pk_mul_f32 v[34:35], v[34:35], v[42:43]
    v_pk_add_f32 v[4:5], v[4:5], s[28:29] op_sel_hi:[1,0]
    v_pk_add_f32 v[6:7], v[6:7], s[28:29] op_sel_hi:[1,0]
    v_rcp_f32 v4, v4
    v_rcp_f32 v5, v5
    v_rcp_f32 v6, v6
    v_rcp_f32 v7, v7
    v_pk_mul_f32 v[32:33], v[32:33], v[4:5]
    v_pk_mul_f32 v[34:35], v[34:35], v[6:7]
    v_pk_mul_f32 v[4:5], v[36:37], v[36:37]
    v_pk_mul_f32 v[6:7], v[38:39], v[38:39]
    v_pk_fma_f32 v[4:5], v[4:5], s[26:27], v[0:1] op_sel_hi:[1,0,1]
    v_pk_fma_f32 v[6:7], v[6:7], s[26:27], v[0:1] op_sel_hi:[1,0,1]
    v_pk_mul_f32 v[4:5], v[4:5], v[36:37]
    v_pk_mul_f32 v[6:7], v[6:7], v[38:39]
    v_exp_f32 v4, v4
    v_exp_f32 v5, v5
    v_exp_f32 v6, v6
    v_exp_f32 v7, v7
    v_pk_mul_f32 v[36:37], v[36:37], v[44:45]
    v_pk_mul_f32 v[38:39], v[38:39], v[46:47]
    v_pk_add_f32 v[4:5], v[4:5], s[28:29] op_sel_hi:[1,0]
    v_pk_add_f32 v[6:7], v[6:7], s[28:29] op_sel_hi:[1,0]
    v_rcp_f32 v4, v4
    v_rcp_f32 v5, v5
    v_rcp_f32 v6, v6
    v_rcp_f32 v7, v7
    v_pk_mul_f32 v[36:37], v[36:37], v[4:5]
    v_pk_mul_f32 v[38:39], v[38:39], v[6:7]
    v_cvt_pk_bf16_f32 v40, v32, v33
    v_cvt_pk_bf16_f32 v41, v34, v35
    v_cvt_pk_bf16_f32 v42, v36, v37
    v_cvt_pk_bf16_f32 v43, v38, v39
    s_add_u32 s15, s14, 229376
    v_permlane32_swap_b32 v40, v42
    v_permlane32_swap_b32 v41, v43
    buffer_store_dwordx4 v[40:43], v2, s[4:7], s15 offen sc0 sc1
    s_waitcnt lgkmcnt(0)
    ds_read_b128 v[248:251], v3 offset:320
    ds_read_b128 v[252:255], v3 offset:448
    v_pk_fma_f32 v[4:5], v[8:9], v[240:241], v[12:13] op_sel:[0,1,0] op_sel_hi:[1,1,1]
    v_pk_fma_f32 v[48:49], v[48:49], v[240:241], v[4:5] op_sel_hi:[1,0,1]
    v_pk_fma_f32 v[6:7], v[10:11], v[240:241], v[14:15] op_sel:[0,1,0] op_sel_hi:[1,1,1]
    v_pk_fma_f32 v[50:51], v[50:51], v[240:241], v[6:7] op_sel_hi:[1,0,1]
    v_pk_fma_f32 v[4:5], v[8:9], v[242:243], v[12:13] op_sel:[0,1,0] op_sel_hi:[1,1,1]
    v_pk_fma_f32 v[52:53], v[52:53], v[242:243], v[4:5] op_sel_hi:[1,0,1]
    v_pk_fma_f32 v[6:7], v[10:11], v[242:243], v[14:15] op_sel:[0,1,0] op_sel_hi:[1,1,1]
    v_pk_fma_f32 v[54:55], v[54:55], v[242:243], v[6:7] op_sel_hi:[1,0,1]
    v_pk_fma_f32 v[4:5], v[8:9], v[244:245], v[12:13] op_sel:[0,1,0] op_sel_hi:[1,1,1]
    v_pk_fma_f32 v[64:65], v[64:65], v[244:245], v[4:5] op_sel_hi:[1,0,1]
    v_pk_fma_f32 v[6:7], v[10:11], v[244:245], v[14:15] op_sel:[0,1,0] op_sel_hi:[1,1,1]
    v_pk_fma_f32 v[66:67], v[66:67], v[244:245], v[6:7] op_sel_hi:[1,0,1]
    v_pk_fma_f32 v[4:5], v[8:9], v[246:247], v[12:13] op_sel:[0,1,0] op_sel_hi:[1,1,1]
    v_pk_fma_f32 v[68:69], v[68:69], v[246:247], v[4:5] op_sel_hi:[1,0,1]
    v_pk_fma_f32 v[6:7], v[10:11], v[246:247], v[14:15] op_sel:[0,1,0] op_sel_hi:[1,1,1]
    v_pk_fma_f32 v[70:71], v[70:71], v[246:247], v[6:7] op_sel_hi:[1,0,1]
    s_waitcnt lgkmcnt(0)
    ds_read_b128 v[8:11], v3 offset:512
    ds_read_b128 v[12:15], v3 offset:640
    v_pk_fma_f32 v[4:5], v[248:249], v[240:241], v[252:253] op_sel:[0,1,0] op_sel_hi:[1,1,1]
    v_pk_fma_f32 v[56:57], v[56:57], v[240:241], v[4:5] op_sel_hi:[1,0,1]
    v_pk_fma_f32 v[6:7], v[250:251], v[240:241], v[254:255] op_sel:[0,1,0] op_sel_hi:[1,1,1]
    v_pk_fma_f32 v[58:59], v[58:59], v[240:241], v[6:7] op_sel_hi:[1,0,1]
    v_pk_fma_f32 v[4:5], v[248:249], v[242:243], v[252:253] op_sel:[0,1,0] op_sel_hi:[1,1,1]
    v_pk_fma_f32 v[60:61], v[60:61], v[242:243], v[4:5] op_sel_hi:[1,0,1]
    v_pk_fma_f32 v[6:7], v[250:251], v[242:243], v[254:255] op_sel:[0,1,0] op_sel_hi:[1,1,1]
    v_pk_fma_f32 v[62:63], v[62:63], v[242:243], v[6:7] op_sel_hi:[1,0,1]
    v_pk_fma_f32 v[4:5], v[248:249], v[244:245], v[252:253] op_sel:[0,1,0] op_sel_hi:[1,1,1]
    v_pk_fma_f32 v[72:73], v[72:73], v[244:245], v[4:5] op_sel_hi:[1,0,1]
    v_pk_fma_f32 v[6:7], v[250:251], v[244:245], v[254:255] op_sel:[0,1,0] op_sel_hi:[1,1,1]
    v_pk_fma_f32 v[74:75], v[74:75], v[244:245], v[6:7] op_sel_hi:[1,0,1]
    v_pk_fma_f32 v[4:5], v[248:249], v[246:247], v[252:253] op_sel:[0,1,0] op_sel_hi:[1,1,1]
    v_pk_fma_f32 v[76:77], v[76:77], v[246:247], v[4:5] op_sel_hi:[1,0,1]
    v_pk_fma_f32 v[6:7], v[250:251], v[246:247], v[254:255] op_sel:[0,1,0] op_sel_hi:[1,1,1]
    v_pk_fma_f32 v[78:79], v[78:79], v[246:247], v[6:7] op_sel_hi:[1,0,1]
    v_pk_mul_f32 v[4:5], v[48:49], v[48:49]
    v_pk_mul_f32 v[6:7], v[50:51], v[50:51]
    v_pk_fma_f32 v[4:5], v[4:5], s[26:27], v[0:1] op_sel_hi:[1,0,1]
    v_pk_fma_f32 v[6:7], v[6:7], s[26:27], v[0:1] op_sel_hi:[1,0,1]
    v_pk_mul_f32 v[4:5], v[4:5], v[48:49]
    v_pk_mul_f32 v[6:7], v[6:7], v[50:51]
    v_exp_f32 v4, v4
    v_exp_f32 v5, v5
    v_exp_f32 v6, v6
    v_exp_f32 v7, v7
    v_pk_mul_f32 v[48:49], v[48:49], v[56:57]
    v_pk_mul_f32 v[50:51], v[50:51], v[58:59]
    v_pk_add_f32 v[4:5], v[4:5], s[28:29] op_sel_hi:[1,0]
    v_pk_add_f32 v[6:7], v[6:7], s[28:29] op_sel_hi:[1,0]
    v_rcp_f32 v4, v4
    v_rcp_f32 v5, v5
    v_rcp_f32 v6, v6
    v_rcp_f32 v7, v7
    v_pk_mul_f32 v[48:49], v[48:49], v[4:5]
    v_pk_mul_f32 v[50:51], v[50:51], v[6:7]
    v_pk_mul_f32 v[4:5], v[52:53], v[52:53]
    v_pk_mul_f32 v[6:7], v[54:55], v[54:55]
    v_pk_fma_f32 v[4:5], v[4:5], s[26:27], v[0:1] op_sel_hi:[1,0,1]
    v_pk_fma_f32 v[6:7], v[6:7], s[26:27], v[0:1] op_sel_hi:[1,0,1]
    v_pk_mul_f32 v[4:5], v[4:5], v[52:53]
    v_pk_mul_f32 v[6:7], v[6:7], v[54:55]
    v_exp_f32 v4, v4
    v_exp_f32 v5, v5
    v_exp_f32 v6, v6
    v_exp_f32 v7, v7
    v_pk_mul_f32 v[52:53], v[52:53], v[60:61]
    v_pk_mul_f32 v[54:55], v[54:55], v[62:63]
    v_pk_add_f32 v[4:5], v[4:5], s[28:29] op_sel_hi:[1,0]
    v_pk_add_f32 v[6:7], v[6:7], s[28:29] op_sel_hi:[1,0]
    v_rcp_f32 v4, v4
    v_rcp_f32 v5, v5
    v_rcp_f32 v6, v6
    v_rcp_f32 v7, v7
    v_pk_mul_f32 v[52:53], v[52:53], v[4:5]
    v_pk_mul_f32 v[54:55], v[54:55], v[6:7]
    v_cvt_pk_bf16_f32 v56, v48, v49
    v_cvt_pk_bf16_f32 v57, v50, v51
    v_cvt_pk_bf16_f32 v58, v52, v53
    v_cvt_pk_bf16_f32 v59, v54, v55
    s_add_u32 s15, s14, 1024
    v_permlane32_swap_b32 v56, v58
    v_permlane32_swap_b32 v57, v59
    buffer_store_dwordx4 v[56:59], v2, s[4:7], s15 offen sc0 sc1
    v_pk_mul_f32 v[4:5], v[64:65], v[64:65]
    v_pk_mul_f32 v[6:7], v[66:67], v[66:67]
    v_pk_fma_f32 v[4:5], v[4:5], s[26:27], v[0:1] op_sel_hi:[1,0,1]
    v_pk_fma_f32 v[6:7], v[6:7], s[26:27], v[0:1] op_sel_hi:[1,0,1]
    v_pk_mul_f32 v[4:5], v[4:5], v[64:65]
    v_pk_mul_f32 v[6:7], v[6:7], v[66:67]
    v_exp_f32 v4, v4
    v_exp_f32 v5, v5
    v_exp_f32 v6, v6
    v_exp_f32 v7, v7
    v_pk_mul_f32 v[64:65], v[64:65], v[72:73]
    v_pk_mul_f32 v[66:67], v[66:67], v[74:75]
    v_pk_add_f32 v[4:5], v[4:5], s[28:29] op_sel_hi:[1,0]
    v_pk_add_f32 v[6:7], v[6:7], s[28:29] op_sel_hi:[1,0]
    v_rcp_f32 v4, v4
    v_rcp_f32 v5, v5
    v_rcp_f32 v6, v6
    v_rcp_f32 v7, v7
    v_pk_mul_f32 v[64:65], v[64:65], v[4:5]
    v_pk_mul_f32 v[66:67], v[66:67], v[6:7]
    v_pk_mul_f32 v[4:5], v[68:69], v[68:69]
    v_pk_mul_f32 v[6:7], v[70:71], v[70:71]
    v_pk_fma_f32 v[4:5], v[4:5], s[26:27], v[0:1] op_sel_hi:[1,0,1]
    v_pk_fma_f32 v[6:7], v[6:7], s[26:27], v[0:1] op_sel_hi:[1,0,1]
    v_pk_mul_f32 v[4:5], v[4:5], v[68:69]
    v_pk_mul_f32 v[6:7], v[6:7], v[70:71]
    v_exp_f32 v4, v4
    v_exp_f32 v5, v5
    v_exp_f32 v6, v6
    v_exp_f32 v7, v7
    v_pk_mul_f32 v[68:69], v[68:69], v[76:77]
    v_pk_mul_f32 v[70:71], v[70:71], v[78:79]
    v_pk_add_f32 v[4:5], v[4:5], s[28:29] op_sel_hi:[1,0]
    v_pk_add_f32 v[6:7], v[6:7], s[28:29] op_sel_hi:[1,0]
    v_rcp_f32 v4, v4
    v_rcp_f32 v5, v5
    v_rcp_f32 v6, v6
    v_rcp_f32 v7, v7
    v_pk_mul_f32 v[68:69], v[68:69], v[4:5]
    v_pk_mul_f32 v[70:71], v[70:71], v[6:7]
    v_cvt_pk_bf16_f32 v72, v64, v65
    v_cvt_pk_bf16_f32 v73, v66, v67
    v_cvt_pk_bf16_f32 v74, v68, v69
    v_cvt_pk_bf16_f32 v75, v70, v71
    s_add_u32 s15, s14, 230400
    v_permlane32_swap_b32 v72, v74
    v_permlane32_swap_b32 v73, v75
    buffer_store_dwordx4 v[72:75], v2, s[4:7], s15 offen sc0 sc1
    s_waitcnt lgkmcnt(0)
    ds_read_b128 v[248:251], v3 offset:576
    ds_read_b128 v[252:255], v3 offset:704
    v_pk_fma_f32 v[4:5], v[8:9], v[240:241], v[12:13] op_sel:[0,1,0] op_sel_hi:[1,1,1]
    v_pk_fma_f32 v[80:81], v[80:81], v[240:241], v[4:5] op_sel_hi:[1,0,1]
    v_pk_fma_f32 v[6:7], v[10:11], v[240:241], v[14:15] op_sel:[0,1,0] op_sel_hi:[1,1,1]
    v_pk_fma_f32 v[82:83], v[82:83], v[240:241], v[6:7] op_sel_hi:[1,0,1]
    v_pk_fma_f32 v[4:5], v[8:9], v[242:243], v[12:13] op_sel:[0,1,0] op_sel_hi:[1,1,1]
    v_pk_fma_f32 v[84:85], v[84:85], v[242:243], v[4:5] op_sel_hi:[1,0,1]
    v_pk_fma_f32 v[6:7], v[10:11], v[242:243], v[14:15] op_sel:[0,1,0] op_sel_hi:[1,1,1]
    v_pk_fma_f32 v[86:87], v[86:87], v[242:243], v[6:7] op_sel_hi:[1,0,1]
    v_pk_fma_f32 v[4:5], v[8:9], v[244:245], v[12:13] op_sel:[0,1,0] op_sel_hi:[1,1,1]
    v_pk_fma_f32 v[96:97], v[96:97], v[244:245], v[4:5] op_sel_hi:[1,0,1]
    v_pk_fma_f32 v[6:7], v[10:11], v[244:245], v[14:15] op_sel:[0,1,0] op_sel_hi:[1,1,1]
    v_pk_fma_f32 v[98:99], v[98:99], v[244:245], v[6:7] op_sel_hi:[1,0,1]
    v_pk_fma_f32 v[4:5], v[8:9], v[246:247], v[12:13] op_sel:[0,1,0] op_sel_hi:[1,1,1]
    v_pk_fma_f32 v[100:101], v[100:101], v[246:247], v[4:5] op_sel_hi:[1,0,1]
    v_pk_fma_f32 v[6:7], v[10:11], v[246:247], v[14:15] op_sel:[0,1,0] op_sel_hi:[1,1,1]
    v_pk_fma_f32 v[102:103], v[102:103], v[246:247], v[6:7] op_sel_hi:[1,0,1]
    s_waitcnt lgkmcnt(0)
    ds_read_b128 v[8:11], v3 offset:768
    ds_read_b128 v[12:15], v3 offset:896
    v_pk_fma_f32 v[4:5], v[248:249], v[240:241], v[252:253] op_sel:[0,1,0] op_sel_hi:[1,1,1]
    v_pk_fma_f32 v[88:89], v[88:89], v[240:241], v[4:5] op_sel_hi:[1,0,1]
    v_pk_fma_f32 v[6:7], v[250:251], v[240:241], v[254:255] op_sel:[0,1,0] op_sel_hi:[1,1,1]
    v_pk_fma_f32 v[90:91], v[90:91], v[240:241], v[6:7] op_sel_hi:[1,0,1]
    v_pk_fma_f32 v[4:5], v[248:249], v[242:243], v[252:253] op_sel:[0,1,0] op_sel_hi:[1,1,1]
    v_pk_fma_f32 v[92:93], v[92:93], v[242:243], v[4:5] op_sel_hi:[1,0,1]
    v_pk_fma_f32 v[6:7], v[250:251], v[242:243], v[254:255] op_sel:[0,1,0] op_sel_hi:[1,1,1]
    v_pk_fma_f32 v[94:95], v[94:95], v[242:243], v[6:7] op_sel_hi:[1,0,1]
    v_pk_fma_f32 v[4:5], v[248:249], v[244:245], v[252:253] op_sel:[0,1,0] op_sel_hi:[1,1,1]
    v_pk_fma_f32 v[104:105], v[104:105], v[244:245], v[4:5] op_sel_hi:[1,0,1]
    v_pk_fma_f32 v[6:7], v[250:251], v[244:245], v[254:255] op_sel:[0,1,0] op_sel_hi:[1,1,1]
    v_pk_fma_f32 v[106:107], v[106:107], v[244:245], v[6:7] op_sel_hi:[1,0,1]
    v_pk_fma_f32 v[4:5], v[248:249], v[246:247], v[252:253] op_sel:[0,1,0] op_sel_hi:[1,1,1]
    v_pk_fma_f32 v[108:109], v[108:109], v[246:247], v[4:5] op_sel_hi:[1,0,1]
    v_pk_fma_f32 v[6:7], v[250:251], v[246:247], v[254:255] op_sel:[0,1,0] op_sel_hi:[1,1,1]
    v_pk_fma_f32 v[110:111], v[110:111], v[246:247], v[6:7] op_sel_hi:[1,0,1]
    v_pk_mul_f32 v[4:5], v[80:81], v[80:81]
    v_pk_mul_f32 v[6:7], v[82:83], v[82:83]
    v_pk_fma_f32 v[4:5], v[4:5], s[26:27], v[0:1] op_sel_hi:[1,0,1]
    v_pk_fma_f32 v[6:7], v[6:7], s[26:27], v[0:1] op_sel_hi:[1,0,1]
    v_pk_mul_f32 v[4:5], v[4:5], v[80:81]
    v_pk_mul_f32 v[6:7], v[6:7], v[82:83]
    v_exp_f32 v4, v4
    v_exp_f32 v5, v5
    v_exp_f32 v6, v6
    v_exp_f32 v7, v7
    v_pk_mul_f32 v[80:81], v[80:81], v[88:89]
    v_pk_mul_f32 v[82:83], v[82:83], v[90:91]
    v_pk_add_f32 v[4:5], v[4:5], s[28:29] op_sel_hi:[1,0]
    v_pk_add_f32 v[6:7], v[6:7], s[28:29] op_sel_hi:[1,0]
    v_rcp_f32 v4, v4
    v_rcp_f32 v5, v5
    v_rcp_f32 v6, v6
    v_rcp_f32 v7, v7
    v_pk_mul_f32 v[80:81], v[80:81], v[4:5]
    v_pk_mul_f32 v[82:83], v[82:83], v[6:7]
    v_pk_mul_f32 v[4:5], v[84:85], v[84:85]
    v_pk_mul_f32 v[6:7], v[86:87], v[86:87]
    v_pk_fma_f32 v[4:5], v[4:5], s[26:27], v[0:1] op_sel_hi:[1,0,1]
    v_pk_fma_f32 v[6:7], v[6:7], s[26:27], v[0:1] op_sel_hi:[1,0,1]
    v_pk_mul_f32 v[4:5], v[4:5], v[84:85]
    v_pk_mul_f32 v[6:7], v[6:7], v[86:87]
    v_exp_f32 v4, v4
    v_exp_f32 v5, v5
    v_exp_f32 v6, v6
    v_exp_f32 v7, v7
    v_pk_mul_f32 v[84:85], v[84:85], v[92:93]
    v_pk_mul_f32 v[86:87], v[86:87], v[94:95]
    v_pk_add_f32 v[4:5], v[4:5], s[28:29] op_sel_hi:[1,0]
    v_pk_add_f32 v[6:7], v[6:7], s[28:29] op_sel_hi:[1,0]
    v_rcp_f32 v4, v4
    v_rcp_f32 v5, v5
    v_rcp_f32 v6, v6
    v_rcp_f32 v7, v7
    v_pk_mul_f32 v[84:85], v[84:85], v[4:5]
    v_pk_mul_f32 v[86:87], v[86:87], v[6:7]
    v_cvt_pk_bf16_f32 v88, v80, v81
    v_cvt_pk_bf16_f32 v89, v82, v83
    v_cvt_pk_bf16_f32 v90, v84, v85
    v_cvt_pk_bf16_f32 v91, v86, v87
    s_add_u32 s15, s14, 2048
    v_permlane32_swap_b32 v88, v90
    v_permlane32_swap_b32 v89, v91
    buffer_store_dwordx4 v[88:91], v2, s[4:7], s15 offen sc0 sc1
    v_pk_mul_f32 v[4:5], v[96:97], v[96:97]
    v_pk_mul_f32 v[6:7], v[98:99], v[98:99]
    v_pk_fma_f32 v[4:5], v[4:5], s[26:27], v[0:1] op_sel_hi:[1,0,1]
    v_pk_fma_f32 v[6:7], v[6:7], s[26:27], v[0:1] op_sel_hi:[1,0,1]
    v_pk_mul_f32 v[4:5], v[4:5], v[96:97]
    v_pk_mul_f32 v[6:7], v[6:7], v[98:99]
    v_exp_f32 v4, v4
    v_exp_f32 v5, v5
    v_exp_f32 v6, v6
    v_exp_f32 v7, v7
    v_pk_mul_f32 v[96:97], v[96:97], v[104:105]
    v_pk_mul_f32 v[98:99], v[98:99], v[106:107]
    v_pk_add_f32 v[4:5], v[4:5], s[28:29] op_sel_hi:[1,0]
    v_pk_add_f32 v[6:7], v[6:7], s[28:29] op_sel_hi:[1,0]
    v_rcp_f32 v4, v4
    v_rcp_f32 v5, v5
    v_rcp_f32 v6, v6
    v_rcp_f32 v7, v7
    v_pk_mul_f32 v[96:97], v[96:97], v[4:5]
    v_pk_mul_f32 v[98:99], v[98:99], v[6:7]
    v_pk_mul_f32 v[4:5], v[100:101], v[100:101]
    v_pk_mul_f32 v[6:7], v[102:103], v[102:103]
    v_pk_fma_f32 v[4:5], v[4:5], s[26:27], v[0:1] op_sel_hi:[1,0,1]
    v_pk_fma_f32 v[6:7], v[6:7], s[26:27], v[0:1] op_sel_hi:[1,0,1]
    v_pk_mul_f32 v[4:5], v[4:5], v[100:101]
    v_pk_mul_f32 v[6:7], v[6:7], v[102:103]
    v_exp_f32 v4, v4
    v_exp_f32 v5, v5
    v_exp_f32 v6, v6
    v_exp_f32 v7, v7
    v_pk_mul_f32 v[100:101], v[100:101], v[108:109]
    v_pk_mul_f32 v[102:103], v[102:103], v[110:111]
    v_pk_add_f32 v[4:5], v[4:5], s[28:29] op_sel_hi:[1,0]
    v_pk_add_f32 v[6:7], v[6:7], s[28:29] op_sel_hi:[1,0]
    v_rcp_f32 v4, v4
    v_rcp_f32 v5, v5
    v_rcp_f32 v6, v6
    v_rcp_f32 v7, v7
    v_pk_mul_f32 v[100:101], v[100:101], v[4:5]
    v_pk_mul_f32 v[102:103], v[102:103], v[6:7]
    v_cvt_pk_bf16_f32 v104, v96, v97
    v_cvt_pk_bf16_f32 v105, v98, v99
    v_cvt_pk_bf16_f32 v106, v100, v101
    v_cvt_pk_bf16_f32 v107, v102, v103
    s_add_u32 s15, s14, 231424
    v_permlane32_swap_b32 v104, v106
    v_permlane32_swap_b32 v105, v107
    buffer_store_dwordx4 v[104:107], v2, s[4:7], s15 offen sc0 sc1
    s_waitcnt lgkmcnt(0)
    ds_read_b128 v[248:251], v3 offset:832
    ds_read_b128 v[252:255], v3 offset:960
    v_pk_fma_f32 v[4:5], v[8:9], v[240:241], v[12:13] op_sel:[0,1,0] op_sel_hi:[1,1,1]
    v_pk_fma_f32 v[112:113], v[112:113], v[240:241], v[4:5] op_sel_hi:[1,0,1]
    v_pk_fma_f32 v[6:7], v[10:11], v[240:241], v[14:15] op_sel:[0,1,0] op_sel_hi:[1,1,1]
    v_pk_fma_f32 v[114:115], v[114:115], v[240:241], v[6:7] op_sel_hi:[1,0,1]
    v_pk_fma_f32 v[4:5], v[8:9], v[242:243], v[12:13] op_sel:[0,1,0] op_sel_hi:[1,1,1]
    v_pk_fma_f32 v[116:117], v[116:117], v[242:243], v[4:5] op_sel_hi:[1,0,1]
    v_pk_fma_f32 v[6:7], v[10:11], v[242:243], v[14:15] op_sel:[0,1,0] op_sel_hi:[1,1,1]
    v_pk_fma_f32 v[118:119], v[118:119], v[242:243], v[6:7] op_sel_hi:[1,0,1]
    v_pk_fma_f32 v[4:5], v[8:9], v[244:245], v[12:13] op_sel:[0,1,0] op_sel_hi:[1,1,1]
    v_pk_fma_f32 v[128:129], v[128:129], v[244:245], v[4:5] op_sel_hi:[1,0,1]
    v_pk_fma_f32 v[6:7], v[10:11], v[244:245], v[14:15] op_sel:[0,1,0] op_sel_hi:[1,1,1]
    v_pk_fma_f32 v[130:131], v[130:131], v[244:245], v[6:7] op_sel_hi:[1,0,1]
    v_pk_fma_f32 v[4:5], v[8:9], v[246:247], v[12:13] op_sel:[0,1,0] op_sel_hi:[1,1,1]
    v_pk_fma_f32 v[132:133], v[132:133], v[246:247], v[4:5] op_sel_hi:[1,0,1]
    v_pk_fma_f32 v[6:7], v[10:11], v[246:247], v[14:15] op_sel:[0,1,0] op_sel_hi:[1,1,1]
    v_pk_fma_f32 v[134:135], v[134:135], v[246:247], v[6:7] op_sel_hi:[1,0,1]
    s_waitcnt lgkmcnt(0)
    ds_read_b128 v[8:11], v3 offset:1024
    ds_read_b128 v[12:15], v3 offset:1152
    v_pk_fma_f32 v[4:5], v[248:249], v[240:241], v[252:253] op_sel:[0,1,0] op_sel_hi:[1,1,1]
    v_pk_fma_f32 v[120:121], v[120:121], v[240:241], v[4:5] op_sel_hi:[1,0,1]
    v_pk_fma_f32 v[6:7], v[250:251], v[240:241], v[254:255] op_sel:[0,1,0] op_sel_hi:[1,1,1]
    v_pk_fma_f32 v[122:123], v[122:123], v[240:241], v[6:7] op_sel_hi:[1,0,1]
    v_pk_fma_f32 v[4:5], v[248:249], v[242:243], v[252:253] op_sel:[0,1,0] op_sel_hi:[1,1,1]
    v_pk_fma_f32 v[124:125], v[124:125], v[242:243], v[4:5] op_sel_hi:[1,0,1]
    v_pk_fma_f32 v[6:7], v[250:251], v[242:243], v[254:255] op_sel:[0,1,0] op_sel_hi:[1,1,1]
    v_pk_fma_f32 v[126:127], v[126:127], v[242:243], v[6:7] op_sel_hi:[1,0,1]
    v_pk_fma_f32 v[4:5], v[248:249], v[244:245], v[252:253] op_sel:[0,1,0] op_sel_hi:[1,1,1]
    v_pk_fma_f32 v[136:137], v[136:137], v[244:245], v[4:5] op_sel_hi:[1,0,1]
    v_pk_fma_f32 v[6:7], v[250:251], v[244:245], v[254:255] op_sel:[0,1,0] op_sel_hi:[1,1,1]
    v_pk_fma_f32 v[138:139], v[138:139], v[244:245], v[6:7] op_sel_hi:[1,0,1]
    v_pk_fma_f32 v[4:5], v[248:249], v[246:247], v[252:253] op_sel:[0,1,0] op_sel_hi:[1,1,1]
    v_pk_fma_f32 v[140:141], v[140:141], v[246:247], v[4:5] op_sel_hi:[1,0,1]
    v_pk_fma_f32 v[6:7], v[250:251], v[246:247], v[254:255] op_sel:[0,1,0] op_sel_hi:[1,1,1]
    v_pk_fma_f32 v[142:143], v[142:143], v[246:247], v[6:7] op_sel_hi:[1,0,1]
    v_pk_mul_f32 v[4:5], v[112:113], v[112:113]
    v_pk_mul_f32 v[6:7], v[114:115], v[114:115]
    v_pk_fma_f32 v[4:5], v[4:5], s[26:27], v[0:1] op_sel_hi:[1,0,1]
    v_pk_fma_f32 v[6:7], v[6:7], s[26:27], v[0:1] op_sel_hi:[1,0,1]
    v_pk_mul_f32 v[4:5], v[4:5], v[112:113]
    v_pk_mul_f32 v[6:7], v[6:7], v[114:115]
    v_exp_f32 v4, v4
    v_exp_f32 v5, v5
    v_exp_f32 v6, v6
    v_exp_f32 v7, v7
    v_pk_mul_f32 v[112:113], v[112:113], v[120:121]
    v_pk_mul_f32 v[114:115], v[114:115], v[122:123]
    v_pk_add_f32 v[4:5], v[4:5], s[28:29] op_sel_hi:[1,0]
    v_pk_add_f32 v[6:7], v[6:7], s[28:29] op_sel_hi:[1,0]
    v_rcp_f32 v4, v4
    v_rcp_f32 v5, v5
    v_rcp_f32 v6, v6
    v_rcp_f32 v7, v7
    v_pk_mul_f32 v[112:113], v[112:113], v[4:5]
    v_pk_mul_f32 v[114:115], v[114:115], v[6:7]
    v_pk_mul_f32 v[4:5], v[116:117], v[116:117]
    v_pk_mul_f32 v[6:7], v[118:119], v[118:119]
    v_pk_fma_f32 v[4:5], v[4:5], s[26:27], v[0:1] op_sel_hi:[1,0,1]
    v_pk_fma_f32 v[6:7], v[6:7], s[26:27], v[0:1] op_sel_hi:[1,0,1]
    v_pk_mul_f32 v[4:5], v[4:5], v[116:117]
    v_pk_mul_f32 v[6:7], v[6:7], v[118:119]
    v_exp_f32 v4, v4
    v_exp_f32 v5, v5
    v_exp_f32 v6, v6
    v_exp_f32 v7, v7
    v_pk_mul_f32 v[116:117], v[116:117], v[124:125]
    v_pk_mul_f32 v[118:119], v[118:119], v[126:127]
    v_pk_add_f32 v[4:5], v[4:5], s[28:29] op_sel_hi:[1,0]
    v_pk_add_f32 v[6:7], v[6:7], s[28:29] op_sel_hi:[1,0]
    v_rcp_f32 v4, v4
    v_rcp_f32 v5, v5
    v_rcp_f32 v6, v6
    v_rcp_f32 v7, v7
    v_pk_mul_f32 v[116:117], v[116:117], v[4:5]
    v_pk_mul_f32 v[118:119], v[118:119], v[6:7]
    v_cvt_pk_bf16_f32 v120, v112, v113
    v_cvt_pk_bf16_f32 v121, v114, v115
    v_cvt_pk_bf16_f32 v122, v116, v117
    v_cvt_pk_bf16_f32 v123, v118, v119
    s_add_u32 s15, s14, 3072
    v_permlane32_swap_b32 v120, v122
    v_permlane32_swap_b32 v121, v123
    buffer_store_dwordx4 v[120:123], v2, s[4:7], s15 offen sc0 sc1
    v_pk_mul_f32 v[4:5], v[128:129], v[128:129]
    v_pk_mul_f32 v[6:7], v[130:131], v[130:131]
    v_pk_fma_f32 v[4:5], v[4:5], s[26:27], v[0:1] op_sel_hi:[1,0,1]
    v_pk_fma_f32 v[6:7], v[6:7], s[26:27], v[0:1] op_sel_hi:[1,0,1]
    v_pk_mul_f32 v[4:5], v[4:5], v[128:129]
    v_pk_mul_f32 v[6:7], v[6:7], v[130:131]
    v_exp_f32 v4, v4
    v_exp_f32 v5, v5
    v_exp_f32 v6, v6
    v_exp_f32 v7, v7
    v_pk_mul_f32 v[128:129], v[128:129], v[136:137]
    v_pk_mul_f32 v[130:131], v[130:131], v[138:139]
    v_pk_add_f32 v[4:5], v[4:5], s[28:29] op_sel_hi:[1,0]
    v_pk_add_f32 v[6:7], v[6:7], s[28:29] op_sel_hi:[1,0]
    v_rcp_f32 v4, v4
    v_rcp_f32 v5, v5
    v_rcp_f32 v6, v6
    v_rcp_f32 v7, v7
    v_pk_mul_f32 v[128:129], v[128:129], v[4:5]
    v_pk_mul_f32 v[130:131], v[130:131], v[6:7]
    v_pk_mul_f32 v[4:5], v[132:133], v[132:133]
    v_pk_mul_f32 v[6:7], v[134:135], v[134:135]
    v_pk_fma_f32 v[4:5], v[4:5], s[26:27], v[0:1] op_sel_hi:[1,0,1]
    v_pk_fma_f32 v[6:7], v[6:7], s[26:27], v[0:1] op_sel_hi:[1,0,1]
    v_pk_mul_f32 v[4:5], v[4:5], v[132:133]
    v_pk_mul_f32 v[6:7], v[6:7], v[134:135]
    v_exp_f32 v4, v4
    v_exp_f32 v5, v5
    v_exp_f32 v6, v6
    v_exp_f32 v7, v7
    v_pk_mul_f32 v[132:133], v[132:133], v[140:141]
    v_pk_mul_f32 v[134:135], v[134:135], v[142:143]
    v_pk_add_f32 v[4:5], v[4:5], s[28:29] op_sel_hi:[1,0]
    v_pk_add_f32 v[6:7], v[6:7], s[28:29] op_sel_hi:[1,0]
    v_rcp_f32 v4, v4
    v_rcp_f32 v5, v5
    v_rcp_f32 v6, v6
    v_rcp_f32 v7, v7
    v_pk_mul_f32 v[132:133], v[132:133], v[4:5]
    v_pk_mul_f32 v[134:135], v[134:135], v[6:7]
    v_cvt_pk_bf16_f32 v136, v128, v129
    v_cvt_pk_bf16_f32 v137, v130, v131
    v_cvt_pk_bf16_f32 v138, v132, v133
    v_cvt_pk_bf16_f32 v139, v134, v135
    s_add_u32 s15, s14, 232448
    v_permlane32_swap_b32 v136, v138
    v_permlane32_swap_b32 v137, v139
    buffer_store_dwordx4 v[136:139], v2, s[4:7], s15 offen sc0 sc1
    s_waitcnt lgkmcnt(0)
    ds_read_b128 v[248:251], v3 offset:1088
    ds_read_b128 v[252:255], v3 offset:1216
    v_pk_fma_f32 v[4:5], v[8:9], v[240:241], v[12:13] op_sel:[0,1,0] op_sel_hi:[1,1,1]
    v_pk_fma_f32 v[144:145], v[144:145], v[240:241], v[4:5] op_sel_hi:[1,0,1]
    v_pk_fma_f32 v[6:7], v[10:11], v[240:241], v[14:15] op_sel:[0,1,0] op_sel_hi:[1,1,1]
    v_pk_fma_f32 v[146:147], v[146:147], v[240:241], v[6:7] op_sel_hi:[1,0,1]
    v_pk_fma_f32 v[4:5], v[8:9], v[242:243], v[12:13] op_sel:[0,1,0] op_sel_hi:[1,1,1]
    v_pk_fma_f32 v[148:149], v[148:149], v[242:243], v[4:5] op_sel_hi:[1,0,1]
    v_pk_fma_f32 v[6:7], v[10:11], v[242:243], v[14:15] op_sel:[0,1,0] op_sel_hi:[1,1,1]
    v_pk_fma_f32 v[150:151], v[150:151], v[242:243], v[6:7] op_sel_hi:[1,0,1]
    v_pk_fma_f32 v[4:5], v[8:9], v[244:245], v[12:13] op_sel:[0,1,0] op_sel_hi:[1,1,1]
    v_pk_fma_f32 v[160:161], v[160:161], v[244:245], v[4:5] op_sel_hi:[1,0,1]
    v_pk_fma_f32 v[6:7], v[10:11], v[244:245], v[14:15] op_sel:[0,1,0] op_sel_hi:[1,1,1]
    v_pk_fma_f32 v[162:163], v[162:163], v[244:245], v[6:7] op_sel_hi:[1,0,1]
    v_pk_fma_f32 v[4:5], v[8:9], v[246:247], v[12:13] op_sel:[0,1,0] op_sel_hi:[1,1,1]
    v_pk_fma_f32 v[164:165], v[164:165], v[246:247], v[4:5] op_sel_hi:[1,0,1]
    v_pk_fma_f32 v[6:7], v[10:11], v[246:247], v[14:15] op_sel:[0,1,0] op_sel_hi:[1,1,1]
    v_pk_fma_f32 v[166:167], v[166:167], v[246:247], v[6:7] op_sel_hi:[1,0,1]
    s_waitcnt lgkmcnt(0)
    ds_read_b128 v[8:11], v3 offset:1280
    ds_read_b128 v[12:15], v3 offset:1408
    v_pk_fma_f32 v[4:5], v[248:249], v[240:241], v[252:253] op_sel:[0,1,0] op_sel_hi:[1,1,1]
    v_pk_fma_f32 v[152:153], v[152:153], v[240:241], v[4:5] op_sel_hi:[1,0,1]
    v_pk_fma_f32 v[6:7], v[250:251], v[240:241], v[254:255] op_sel:[0,1,0] op_sel_hi:[1,1,1]
    v_pk_fma_f32 v[154:155], v[154:155], v[240:241], v[6:7] op_sel_hi:[1,0,1]
    v_pk_fma_f32 v[4:5], v[248:249], v[242:243], v[252:253] op_sel:[0,1,0] op_sel_hi:[1,1,1]
    v_pk_fma_f32 v[156:157], v[156:157], v[242:243], v[4:5] op_sel_hi:[1,0,1]
    v_pk_fma_f32 v[6:7], v[250:251], v[242:243], v[254:255] op_sel:[0,1,0] op_sel_hi:[1,1,1]
    v_pk_fma_f32 v[158:159], v[158:159], v[242:243], v[6:7] op_sel_hi:[1,0,1]
    v_pk_fma_f32 v[4:5], v[248:249], v[244:245], v[252:253] op_sel:[0,1,0] op_sel_hi:[1,1,1]
    v_pk_fma_f32 v[168:169], v[168:169], v[244:245], v[4:5] op_sel_hi:[1,0,1]
    v_pk_fma_f32 v[6:7], v[250:251], v[244:245], v[254:255] op_sel:[0,1,0] op_sel_hi:[1,1,1]
    v_pk_fma_f32 v[170:171], v[170:171], v[244:245], v[6:7] op_sel_hi:[1,0,1]
    v_pk_fma_f32 v[4:5], v[248:249], v[246:247], v[252:253] op_sel:[0,1,0] op_sel_hi:[1,1,1]
    v_pk_fma_f32 v[172:173], v[172:173], v[246:247], v[4:5] op_sel_hi:[1,0,1]
    v_pk_fma_f32 v[6:7], v[250:251], v[246:247], v[254:255] op_sel:[0,1,0] op_sel_hi:[1,1,1]
    v_pk_fma_f32 v[174:175], v[174:175], v[246:247], v[6:7] op_sel_hi:[1,0,1]
    v_pk_mul_f32 v[4:5], v[144:145], v[144:145]
    v_pk_mul_f32 v[6:7], v[146:147], v[146:147]
    v_pk_fma_f32 v[4:5], v[4:5], s[26:27], v[0:1] op_sel_hi:[1,0,1]
    v_pk_fma_f32 v[6:7], v[6:7], s[26:27], v[0:1] op_sel_hi:[1,0,1]
    v_pk_mul_f32 v[4:5], v[4:5], v[144:145]
    v_pk_mul_f32 v[6:7], v[6:7], v[146:147]
    v_exp_f32 v4, v4
    v_exp_f32 v5, v5
    v_exp_f32 v6, v6
    v_exp_f32 v7, v7
    v_pk_mul_f32 v[144:145], v[144:145], v[152:153]
    v_pk_mul_f32 v[146:147], v[146:147], v[154:155]
    v_pk_add_f32 v[4:5], v[4:5], s[28:29] op_sel_hi:[1,0]
    v_pk_add_f32 v[6:7], v[6:7], s[28:29] op_sel_hi:[1,0]
    v_rcp_f32 v4, v4
    v_rcp_f32 v5, v5
    v_rcp_f32 v6, v6
    v_rcp_f32 v7, v7
    v_pk_mul_f32 v[144:145], v[144:145], v[4:5]
    v_pk_mul_f32 v[146:147], v[146:147], v[6:7]
    v_pk_mul_f32 v[4:5], v[148:149], v[148:149]
    v_pk_mul_f32 v[6:7], v[150:151], v[150:151]
    v_pk_fma_f32 v[4:5], v[4:5], s[26:27], v[0:1] op_sel_hi:[1,0,1]
    v_pk_fma_f32 v[6:7], v[6:7], s[26:27], v[0:1] op_sel_hi:[1,0,1]
    v_pk_mul_f32 v[4:5], v[4:5], v[148:149]
    v_pk_mul_f32 v[6:7], v[6:7], v[150:151]
    v_exp_f32 v4, v4
    v_exp_f32 v5, v5
    v_exp_f32 v6, v6
    v_exp_f32 v7, v7
    v_pk_mul_f32 v[148:149], v[148:149], v[156:157]
    v_pk_mul_f32 v[150:151], v[150:151], v[158:159]
    v_pk_add_f32 v[4:5], v[4:5], s[28:29] op_sel_hi:[1,0]
    v_pk_add_f32 v[6:7], v[6:7], s[28:29] op_sel_hi:[1,0]
    v_rcp_f32 v4, v4
    v_rcp_f32 v5, v5
    v_rcp_f32 v6, v6
    v_rcp_f32 v7, v7
    v_pk_mul_f32 v[148:149], v[148:149], v[4:5]
    v_pk_mul_f32 v[150:151], v[150:151], v[6:7]
    v_cvt_pk_bf16_f32 v152, v144, v145
    v_cvt_pk_bf16_f32 v153, v146, v147
    v_cvt_pk_bf16_f32 v154, v148, v149
    v_cvt_pk_bf16_f32 v155, v150, v151
    s_add_u32 s15, s14, 4096
    v_permlane32_swap_b32 v152, v154
    v_permlane32_swap_b32 v153, v155
    buffer_store_dwordx4 v[152:155], v2, s[4:7], s15 offen sc0 sc1
    v_pk_mul_f32 v[4:5], v[160:161], v[160:161]
    v_pk_mul_f32 v[6:7], v[162:163], v[162:163]
    v_pk_fma_f32 v[4:5], v[4:5], s[26:27], v[0:1] op_sel_hi:[1,0,1]
    v_pk_fma_f32 v[6:7], v[6:7], s[26:27], v[0:1] op_sel_hi:[1,0,1]
    v_pk_mul_f32 v[4:5], v[4:5], v[160:161]
    v_pk_mul_f32 v[6:7], v[6:7], v[162:163]
    v_exp_f32 v4, v4
    v_exp_f32 v5, v5
    v_exp_f32 v6, v6
    v_exp_f32 v7, v7
    v_pk_mul_f32 v[160:161], v[160:161], v[168:169]
    v_pk_mul_f32 v[162:163], v[162:163], v[170:171]
    v_pk_add_f32 v[4:5], v[4:5], s[28:29] op_sel_hi:[1,0]
    v_pk_add_f32 v[6:7], v[6:7], s[28:29] op_sel_hi:[1,0]
    v_rcp_f32 v4, v4
    v_rcp_f32 v5, v5
    v_rcp_f32 v6, v6
    v_rcp_f32 v7, v7
    v_pk_mul_f32 v[160:161], v[160:161], v[4:5]
    v_pk_mul_f32 v[162:163], v[162:163], v[6:7]
    v_pk_mul_f32 v[4:5], v[164:165], v[164:165]
    v_pk_mul_f32 v[6:7], v[166:167], v[166:167]
    v_pk_fma_f32 v[4:5], v[4:5], s[26:27], v[0:1] op_sel_hi:[1,0,1]
    v_pk_fma_f32 v[6:7], v[6:7], s[26:27], v[0:1] op_sel_hi:[1,0,1]
    v_pk_mul_f32 v[4:5], v[4:5], v[164:165]
    v_pk_mul_f32 v[6:7], v[6:7], v[166:167]
    v_exp_f32 v4, v4
    v_exp_f32 v5, v5
    v_exp_f32 v6, v6
    v_exp_f32 v7, v7
    v_pk_mul_f32 v[164:165], v[164:165], v[172:173]
    v_pk_mul_f32 v[166:167], v[166:167], v[174:175]
    v_pk_add_f32 v[4:5], v[4:5], s[28:29] op_sel_hi:[1,0]
    v_pk_add_f32 v[6:7], v[6:7], s[28:29] op_sel_hi:[1,0]
    v_rcp_f32 v4, v4
    v_rcp_f32 v5, v5
    v_rcp_f32 v6, v6
    v_rcp_f32 v7, v7
    v_pk_mul_f32 v[164:165], v[164:165], v[4:5]
    v_pk_mul_f32 v[166:167], v[166:167], v[6:7]
    v_cvt_pk_bf16_f32 v168, v160, v161
    v_cvt_pk_bf16_f32 v169, v162, v163
    v_cvt_pk_bf16_f32 v170, v164, v165
    v_cvt_pk_bf16_f32 v171, v166, v167
    s_add_u32 s15, s14, 233472
    v_permlane32_swap_b32 v168, v170
    v_permlane32_swap_b32 v169, v171
    buffer_store_dwordx4 v[168:171], v2, s[4:7], s15 offen sc0 sc1
    s_waitcnt lgkmcnt(0)
    ds_read_b128 v[248:251], v3 offset:1344
    ds_read_b128 v[252:255], v3 offset:1472
    v_pk_fma_f32 v[4:5], v[8:9], v[240:241], v[12:13] op_sel:[0,1,0] op_sel_hi:[1,1,1]
    v_pk_fma_f32 v[176:177], v[176:177], v[240:241], v[4:5] op_sel_hi:[1,0,1]
    v_pk_fma_f32 v[6:7], v[10:11], v[240:241], v[14:15] op_sel:[0,1,0] op_sel_hi:[1,1,1]
    v_pk_fma_f32 v[178:179], v[178:179], v[240:241], v[6:7] op_sel_hi:[1,0,1]
    v_pk_fma_f32 v[4:5], v[8:9], v[242:243], v[12:13] op_sel:[0,1,0] op_sel_hi:[1,1,1]
    v_pk_fma_f32 v[180:181], v[180:181], v[242:243], v[4:5] op_sel_hi:[1,0,1]
    v_pk_fma_f32 v[6:7], v[10:11], v[242:243], v[14:15] op_sel:[0,1,0] op_sel_hi:[1,1,1]
    v_pk_fma_f32 v[182:183], v[182:183], v[242:243], v[6:7] op_sel_hi:[1,0,1]
    v_pk_fma_f32 v[4:5], v[8:9], v[244:245], v[12:13] op_sel:[0,1,0] op_sel_hi:[1,1,1]
    v_pk_fma_f32 v[192:193], v[192:193], v[244:245], v[4:5] op_sel_hi:[1,0,1]
    v_pk_fma_f32 v[6:7], v[10:11], v[244:245], v[14:15] op_sel:[0,1,0] op_sel_hi:[1,1,1]
    v_pk_fma_f32 v[194:195], v[194:195], v[244:245], v[6:7] op_sel_hi:[1,0,1]
    v_pk_fma_f32 v[4:5], v[8:9], v[246:247], v[12:13] op_sel:[0,1,0] op_sel_hi:[1,1,1]
    v_pk_fma_f32 v[196:197], v[196:197], v[246:247], v[4:5] op_sel_hi:[1,0,1]
    v_pk_fma_f32 v[6:7], v[10:11], v[246:247], v[14:15] op_sel:[0,1,0] op_sel_hi:[1,1,1]
    v_pk_fma_f32 v[198:199], v[198:199], v[246:247], v[6:7] op_sel_hi:[1,0,1]
    s_waitcnt lgkmcnt(0)
    ds_read_b128 v[8:11], v3 offset:1536
    ds_read_b128 v[12:15], v3 offset:1664
    v_pk_fma_f32 v[4:5], v[248:249], v[240:241], v[252:253] op_sel:[0,1,0] op_sel_hi:[1,1,1]
    v_pk_fma_f32 v[184:185], v[184:185], v[240:241], v[4:5] op_sel_hi:[1,0,1]
    v_pk_fma_f32 v[6:7], v[250:251], v[240:241], v[254:255] op_sel:[0,1,0] op_sel_hi:[1,1,1]
    v_pk_fma_f32 v[186:187], v[186:187], v[240:241], v[6:7] op_sel_hi:[1,0,1]
    v_pk_fma_f32 v[4:5], v[248:249], v[242:243], v[252:253] op_sel:[0,1,0] op_sel_hi:[1,1,1]
    v_pk_fma_f32 v[188:189], v[188:189], v[242:243], v[4:5] op_sel_hi:[1,0,1]
    v_pk_fma_f32 v[6:7], v[250:251], v[242:243], v[254:255] op_sel:[0,1,0] op_sel_hi:[1,1,1]
    v_pk_fma_f32 v[190:191], v[190:191], v[242:243], v[6:7] op_sel_hi:[1,0,1]
    v_pk_fma_f32 v[4:5], v[248:249], v[244:245], v[252:253] op_sel:[0,1,0] op_sel_hi:[1,1,1]
    v_pk_fma_f32 v[200:201], v[200:201], v[244:245], v[4:5] op_sel_hi:[1,0,1]
    v_pk_fma_f32 v[6:7], v[250:251], v[244:245], v[254:255] op_sel:[0,1,0] op_sel_hi:[1,1,1]
    v_pk_fma_f32 v[202:203], v[202:203], v[244:245], v[6:7] op_sel_hi:[1,0,1]
    v_pk_fma_f32 v[4:5], v[248:249], v[246:247], v[252:253] op_sel:[0,1,0] op_sel_hi:[1,1,1]
    v_pk_fma_f32 v[204:205], v[204:205], v[246:247], v[4:5] op_sel_hi:[1,0,1]
    v_pk_fma_f32 v[6:7], v[250:251], v[246:247], v[254:255] op_sel:[0,1,0] op_sel_hi:[1,1,1]
    v_pk_fma_f32 v[206:207], v[206:207], v[246:247], v[6:7] op_sel_hi:[1,0,1]
    v_pk_mul_f32 v[4:5], v[176:177], v[176:177]
    v_pk_mul_f32 v[6:7], v[178:179], v[178:179]
    v_pk_fma_f32 v[4:5], v[4:5], s[26:27], v[0:1] op_sel_hi:[1,0,1]
    v_pk_fma_f32 v[6:7], v[6:7], s[26:27], v[0:1] op_sel_hi:[1,0,1]
    v_pk_mul_f32 v[4:5], v[4:5], v[176:177]
    v_pk_mul_f32 v[6:7], v[6:7], v[178:179]
    v_exp_f32 v4, v4
    v_exp_f32 v5, v5
    v_exp_f32 v6, v6
    v_exp_f32 v7, v7
    v_pk_mul_f32 v[176:177], v[176:177], v[184:185]
    v_pk_mul_f32 v[178:179], v[178:179], v[186:187]
    v_pk_add_f32 v[4:5], v[4:5], s[28:29] op_sel_hi:[1,0]
    v_pk_add_f32 v[6:7], v[6:7], s[28:29] op_sel_hi:[1,0]
    v_rcp_f32 v4, v4
    v_rcp_f32 v5, v5
    v_rcp_f32 v6, v6
    v_rcp_f32 v7, v7
    v_pk_mul_f32 v[176:177], v[176:177], v[4:5]
    v_pk_mul_f32 v[178:179], v[178:179], v[6:7]
    v_pk_mul_f32 v[4:5], v[180:181], v[180:181]
    v_pk_mul_f32 v[6:7], v[182:183], v[182:183]
    v_pk_fma_f32 v[4:5], v[4:5], s[26:27], v[0:1] op_sel_hi:[1,0,1]
    v_pk_fma_f32 v[6:7], v[6:7], s[26:27], v[0:1] op_sel_hi:[1,0,1]
    v_pk_mul_f32 v[4:5], v[4:5], v[180:181]
    v_pk_mul_f32 v[6:7], v[6:7], v[182:183]
    v_exp_f32 v4, v4
    v_exp_f32 v5, v5
    v_exp_f32 v6, v6
    v_exp_f32 v7, v7
    v_pk_mul_f32 v[180:181], v[180:181], v[188:189]
    v_pk_mul_f32 v[182:183], v[182:183], v[190:191]
    v_pk_add_f32 v[4:5], v[4:5], s[28:29] op_sel_hi:[1,0]
    v_pk_add_f32 v[6:7], v[6:7], s[28:29] op_sel_hi:[1,0]
    v_rcp_f32 v4, v4
    v_rcp_f32 v5, v5
    v_rcp_f32 v6, v6
    v_rcp_f32 v7, v7
    v_pk_mul_f32 v[180:181], v[180:181], v[4:5]
    v_pk_mul_f32 v[182:183], v[182:183], v[6:7]
    v_cvt_pk_bf16_f32 v184, v176, v177
    v_cvt_pk_bf16_f32 v185, v178, v179
    v_cvt_pk_bf16_f32 v186, v180, v181
    v_cvt_pk_bf16_f32 v187, v182, v183
    s_add_u32 s15, s14, 5120
    v_permlane32_swap_b32 v184, v186
    v_permlane32_swap_b32 v185, v187
    buffer_store_dwordx4 v[184:187], v2, s[4:7], s15 offen sc0 sc1
    v_pk_mul_f32 v[4:5], v[192:193], v[192:193]
    v_pk_mul_f32 v[6:7], v[194:195], v[194:195]
    v_pk_fma_f32 v[4:5], v[4:5], s[26:27], v[0:1] op_sel_hi:[1,0,1]
    v_pk_fma_f32 v[6:7], v[6:7], s[26:27], v[0:1] op_sel_hi:[1,0,1]
    v_pk_mul_f32 v[4:5], v[4:5], v[192:193]
    v_pk_mul_f32 v[6:7], v[6:7], v[194:195]
    v_exp_f32 v4, v4
    v_exp_f32 v5, v5
    v_exp_f32 v6, v6
    v_exp_f32 v7, v7
    v_pk_mul_f32 v[192:193], v[192:193], v[200:201]
    v_pk_mul_f32 v[194:195], v[194:195], v[202:203]
    v_pk_add_f32 v[4:5], v[4:5], s[28:29] op_sel_hi:[1,0]
    v_pk_add_f32 v[6:7], v[6:7], s[28:29] op_sel_hi:[1,0]
    v_rcp_f32 v4, v4
    v_rcp_f32 v5, v5
    v_rcp_f32 v6, v6
    v_rcp_f32 v7, v7
    v_pk_mul_f32 v[192:193], v[192:193], v[4:5]
    v_pk_mul_f32 v[194:195], v[194:195], v[6:7]
    v_pk_mul_f32 v[4:5], v[196:197], v[196:197]
    v_pk_mul_f32 v[6:7], v[198:199], v[198:199]
    v_pk_fma_f32 v[4:5], v[4:5], s[26:27], v[0:1] op_sel_hi:[1,0,1]
    v_pk_fma_f32 v[6:7], v[6:7], s[26:27], v[0:1] op_sel_hi:[1,0,1]
    v_pk_mul_f32 v[4:5], v[4:5], v[196:197]
    v_pk_mul_f32 v[6:7], v[6:7], v[198:199]
    v_exp_f32 v4, v4
    v_exp_f32 v5, v5
    v_exp_f32 v6, v6
    v_exp_f32 v7, v7
    v_pk_mul_f32 v[196:197], v[196:197], v[204:205]
    v_pk_mul_f32 v[198:199], v[198:199], v[206:207]
    v_pk_add_f32 v[4:5], v[4:5], s[28:29] op_sel_hi:[1,0]
    v_pk_add_f32 v[6:7], v[6:7], s[28:29] op_sel_hi:[1,0]
    v_rcp_f32 v4, v4
    v_rcp_f32 v5, v5
    v_rcp_f32 v6, v6
    v_rcp_f32 v7, v7
    v_pk_mul_f32 v[196:197], v[196:197], v[4:5]
    v_pk_mul_f32 v[198:199], v[198:199], v[6:7]
    v_cvt_pk_bf16_f32 v200, v192, v193
    v_cvt_pk_bf16_f32 v201, v194, v195
    v_cvt_pk_bf16_f32 v202, v196, v197
    v_cvt_pk_bf16_f32 v203, v198, v199
    s_add_u32 s15, s14, 234496
    v_permlane32_swap_b32 v200, v202
    v_permlane32_swap_b32 v201, v203
    buffer_store_dwordx4 v[200:203], v2, s[4:7], s15 offen sc0 sc1
    s_waitcnt lgkmcnt(0)
    ds_read_b128 v[248:251], v3 offset:1600
    ds_read_b128 v[252:255], v3 offset:1728
    v_pk_fma_f32 v[4:5], v[8:9], v[240:241], v[12:13] op_sel:[0,1,0] op_sel_hi:[1,1,1]
    v_pk_fma_f32 v[208:209], v[208:209], v[240:241], v[4:5] op_sel_hi:[1,0,1]
    v_pk_fma_f32 v[6:7], v[10:11], v[240:241], v[14:15] op_sel:[0,1,0] op_sel_hi:[1,1,1]
    v_pk_fma_f32 v[210:211], v[210:211], v[240:241], v[6:7] op_sel_hi:[1,0,1]
    v_pk_fma_f32 v[4:5], v[8:9], v[242:243], v[12:13] op_sel:[0,1,0] op_sel_hi:[1,1,1]
    v_pk_fma_f32 v[212:213], v[212:213], v[242:243], v[4:5] op_sel_hi:[1,0,1]
    v_pk_fma_f32 v[6:7], v[10:11], v[242:243], v[14:15] op_sel:[0,1,0] op_sel_hi:[1,1,1]
    v_pk_fma_f32 v[214:215], v[214:215], v[242:243], v[6:7] op_sel_hi:[1,0,1]
    v_pk_fma_f32 v[4:5], v[8:9], v[244:245], v[12:13] op_sel:[0,1,0] op_sel_hi:[1,1,1]
    v_pk_fma_f32 v[224:225], v[224:225], v[244:245], v[4:5] op_sel_hi:[1,0,1]
    v_pk_fma_f32 v[6:7], v[10:11], v[244:245], v[14:15] op_sel:[0,1,0] op_sel_hi:[1,1,1]
    v_pk_fma_f32 v[226:227], v[226:227], v[244:245], v[6:7] op_sel_hi:[1,0,1]
    v_pk_fma_f32 v[4:5], v[8:9], v[246:247], v[12:13] op_sel:[0,1,0] op_sel_hi:[1,1,1]
    v_pk_fma_f32 v[228:229], v[228:229], v[246:247], v[4:5] op_sel_hi:[1,0,1]
    v_pk_fma_f32 v[6:7], v[10:11], v[246:247], v[14:15] op_sel:[0,1,0] op_sel_hi:[1,1,1]
    v_pk_fma_f32 v[230:231], v[230:231], v[246:247], v[6:7] op_sel_hi:[1,0,1]
    s_waitcnt lgkmcnt(0)
    v_pk_fma_f32 v[4:5], v[248:249], v[240:241], v[252:253] op_sel:[0,1,0] op_sel_hi:[1,1,1]
    v_pk_fma_f32 v[216:217], v[216:217], v[240:241], v[4:5] op_sel_hi:[1,0,1]
    v_pk_fma_f32 v[6:7], v[250:251], v[240:241], v[254:255] op_sel:[0,1,0] op_sel_hi:[1,1,1]
    v_pk_fma_f32 v[218:219], v[218:219], v[240:241], v[6:7] op_sel_hi:[1,0,1]
    v_pk_fma_f32 v[4:5], v[248:249], v[242:243], v[252:253] op_sel:[0,1,0] op_sel_hi:[1,1,1]
    v_pk_fma_f32 v[220:221], v[220:221], v[242:243], v[4:5] op_sel_hi:[1,0,1]
    v_pk_fma_f32 v[6:7], v[250:251], v[242:243], v[254:255] op_sel:[0,1,0] op_sel_hi:[1,1,1]
    v_pk_fma_f32 v[222:223], v[222:223], v[242:243], v[6:7] op_sel_hi:[1,0,1]
    v_pk_fma_f32 v[4:5], v[248:249], v[244:245], v[252:253] op_sel:[0,1,0] op_sel_hi:[1,1,1]
    v_pk_fma_f32 v[232:233], v[232:233], v[244:245], v[4:5] op_sel_hi:[1,0,1]
    v_pk_fma_f32 v[6:7], v[250:251], v[244:245], v[254:255] op_sel:[0,1,0] op_sel_hi:[1,1,1]
    v_pk_fma_f32 v[234:235], v[234:235], v[244:245], v[6:7] op_sel_hi:[1,0,1]
    v_pk_fma_f32 v[4:5], v[248:249], v[246:247], v[252:253] op_sel:[0,1,0] op_sel_hi:[1,1,1]
    v_pk_fma_f32 v[236:237], v[236:237], v[246:247], v[4:5] op_sel_hi:[1,0,1]
    v_pk_fma_f32 v[6:7], v[250:251], v[246:247], v[254:255] op_sel:[0,1,0] op_sel_hi:[1,1,1]
    v_pk_fma_f32 v[238:239], v[238:239], v[246:247], v[6:7] op_sel_hi:[1,0,1]
    v_pk_mul_f32 v[4:5], v[208:209], v[208:209]
    v_pk_mul_f32 v[6:7], v[210:211], v[210:211]
    v_pk_fma_f32 v[4:5], v[4:5], s[26:27], v[0:1] op_sel_hi:[1,0,1]
    v_pk_fma_f32 v[6:7], v[6:7], s[26:27], v[0:1] op_sel_hi:[1,0,1]
    v_pk_mul_f32 v[4:5], v[4:5], v[208:209]
    v_pk_mul_f32 v[6:7], v[6:7], v[210:211]
    v_exp_f32 v4, v4
    v_exp_f32 v5, v5
    v_exp_f32 v6, v6
    v_exp_f32 v7, v7
    v_pk_mul_f32 v[208:209], v[208:209], v[216:217]
    v_pk_mul_f32 v[210:211], v[210:211], v[218:219]
    v_pk_add_f32 v[4:5], v[4:5], s[28:29] op_sel_hi:[1,0]
    v_pk_add_f32 v[6:7], v[6:7], s[28:29] op_sel_hi:[1,0]
    v_rcp_f32 v4, v4
    v_rcp_f32 v5, v5
    v_rcp_f32 v6, v6
    v_rcp_f32 v7, v7
    v_pk_mul_f32 v[208:209], v[208:209], v[4:5]
    v_pk_mul_f32 v[210:211], v[210:211], v[6:7]
    v_pk_mul_f32 v[4:5], v[212:213], v[212:213]
    v_pk_mul_f32 v[6:7], v[214:215], v[214:215]
    v_pk_fma_f32 v[4:5], v[4:5], s[26:27], v[0:1] op_sel_hi:[1,0,1]
    v_pk_fma_f32 v[6:7], v[6:7], s[26:27], v[0:1] op_sel_hi:[1,0,1]
    v_pk_mul_f32 v[4:5], v[4:5], v[212:213]
    v_pk_mul_f32 v[6:7], v[6:7], v[214:215]
    v_exp_f32 v4, v4
    v_exp_f32 v5, v5
    v_exp_f32 v6, v6
    v_exp_f32 v7, v7
    v_pk_mul_f32 v[212:213], v[212:213], v[220:221]
    v_pk_mul_f32 v[214:215], v[214:215], v[222:223]
    v_pk_add_f32 v[4:5], v[4:5], s[28:29] op_sel_hi:[1,0]
    v_pk_add_f32 v[6:7], v[6:7], s[28:29] op_sel_hi:[1,0]
    v_rcp_f32 v4, v4
    v_rcp_f32 v5, v5
    v_rcp_f32 v6, v6
    v_rcp_f32 v7, v7
    v_pk_mul_f32 v[212:213], v[212:213], v[4:5]
    v_pk_mul_f32 v[214:215], v[214:215], v[6:7]
    v_cvt_pk_bf16_f32 v216, v208, v209
    v_cvt_pk_bf16_f32 v217, v210, v211
    v_cvt_pk_bf16_f32 v218, v212, v213
    v_cvt_pk_bf16_f32 v219, v214, v215
    s_add_u32 s15, s14, 6144
    v_permlane32_swap_b32 v216, v218
    v_permlane32_swap_b32 v217, v219
    buffer_store_dwordx4 v[216:219], v2, s[4:7], s15 offen sc0 sc1
    v_pk_mul_f32 v[4:5], v[224:225], v[224:225]
    v_pk_mul_f32 v[6:7], v[226:227], v[226:227]
    v_pk_fma_f32 v[4:5], v[4:5], s[26:27], v[0:1] op_sel_hi:[1,0,1]
    v_pk_fma_f32 v[6:7], v[6:7], s[26:27], v[0:1] op_sel_hi:[1,0,1]
    v_pk_mul_f32 v[4:5], v[4:5], v[224:225]
    v_pk_mul_f32 v[6:7], v[6:7], v[226:227]
    v_exp_f32 v4, v4
    v_exp_f32 v5, v5
    v_exp_f32 v6, v6
    v_exp_f32 v7, v7
    v_pk_mul_f32 v[224:225], v[224:225], v[232:233]
    v_pk_mul_f32 v[226:227], v[226:227], v[234:235]
    v_pk_add_f32 v[4:5], v[4:5], s[28:29] op_sel_hi:[1,0]
    v_pk_add_f32 v[6:7], v[6:7], s[28:29] op_sel_hi:[1,0]
    v_rcp_f32 v4, v4
    v_rcp_f32 v5, v5
    v_rcp_f32 v6, v6
    v_rcp_f32 v7, v7
    v_pk_mul_f32 v[224:225], v[224:225], v[4:5]
    v_pk_mul_f32 v[226:227], v[226:227], v[6:7]
    v_pk_mul_f32 v[4:5], v[228:229], v[228:229]
    v_pk_mul_f32 v[6:7], v[230:231], v[230:231]
    v_pk_fma_f32 v[4:5], v[4:5], s[26:27], v[0:1] op_sel_hi:[1,0,1]
    v_pk_fma_f32 v[6:7], v[6:7], s[26:27], v[0:1] op_sel_hi:[1,0,1]
    v_pk_mul_f32 v[4:5], v[4:5], v[228:229]
    v_pk_mul_f32 v[6:7], v[6:7], v[230:231]
    v_exp_f32 v4, v4
    v_exp_f32 v5, v5
    v_exp_f32 v6, v6
    v_exp_f32 v7, v7
    v_pk_mul_f32 v[228:229], v[228:229], v[236:237]
    v_pk_mul_f32 v[230:231], v[230:231], v[238:239]
    v_pk_add_f32 v[4:5], v[4:5], s[28:29] op_sel_hi:[1,0]
    v_pk_add_f32 v[6:7], v[6:7], s[28:29] op_sel_hi:[1,0]
    v_rcp_f32 v4, v4
    v_rcp_f32 v5, v5
    v_rcp_f32 v6, v6
    v_rcp_f32 v7, v7
    v_pk_mul_f32 v[228:229], v[228:229], v[4:5]
    v_pk_mul_f32 v[230:231], v[230:231], v[6:7]
    v_cvt_pk_bf16_f32 v232, v224, v225
    v_cvt_pk_bf16_f32 v233, v226, v227
    v_cvt_pk_bf16_f32 v234, v228, v229
    v_cvt_pk_bf16_f32 v235, v230, v231
    s_add_u32 s15, s14, 235520
    v_permlane32_swap_b32 v232, v234
    v_permlane32_swap_b32 v233, v235
    buffer_store_dwordx4 v[232:235], v2, s[4:7], s15 offen sc0 sc1
L_k5_kernel_end:
L_k5_kernel_exit:
    s_endpgm

.globl k6_kernel
.p2align 8
.type k6_kernel,@function
k6_kernel:
    s_cmp_ge_u32 s2, 256
    s_cbranch_scc1 L_k6_kernel_exit
    s_load_dwordx2 s[4:5], s[0:1], 104
    s_load_dwordx2 s[24:25], s[0:1], 88
    v_lshrrev_b32 v1, 6, v0
    s_nop 0
    v_readfirstlane_b32 s22, v1
    s_mov_b32 s6, 268435456
    s_mov_b32 s7, 0x00020000
    s_mov_b32 s26, 4194304
    s_mov_b32 s27, 0x00020000
    s_and_b32 s8, s2, 7
    s_lshr_b32 s9, s2, 3
    s_and_b32 s10, s8, 3
    s_mul_i32 s10, s10, 4
    s_and_b32 s11, s9, 3
    s_add_u32 s10, s10, s11
    s_lshr_b32 s12, s8, 2
    s_mul_i32 s12, s12, 8
    s_lshr_b32 s11, s9, 2
    s_add_u32 s12, s12, s11
    s_mul_i32 s20, s12, 2
    s_mul_i32 s21, s10, 4
    v_and_b32 v6, 63, v0
    v_lshlrev_b32 v6, 4, v6
    s_add_u32 s43, s22, 0
    s_mul_i32 s49, s43, 2048
    s_and_b32 s39, s43, 1
    s_mul_i32 s39, s39, 2048
    s_lshr_b32 s43, s43, 1
    s_add_u32 s44, s43, s20
    s_mul_i32 s44, s44, 229376
    s_add_u32 s44, s44, 20971520
    s_add_u32 s46, s43, s21
    s_mul_i32 s46, s46, 229376
    s_add_u32 s46, s46, 49872896
    s_cmp_lt_u32 s43, 2
    s_cselect_b32 s46, s44, s46
    s_add_u32 s46, s46, s39
    s_add_u32 m0, s49, 0
    s_waitcnt lgkmcnt(0)
    buffer_load_dwordx4 v6, s[4:7], s46 offen offset:0 lds
    buffer_load_dwordx4 v6, s[4:7], s46 offen offset:1024 lds
    s_add_u32 s43, s22, 4
    s_mul_i32 s50, s43, 2048
    s_and_b32 s39, s43, 1
    s_mul_i32 s39, s39, 2048
    s_lshr_b32 s43, s43, 1
    s_add_u32 s44, s43, s20
    s_mul_i32 s44, s44, 229376
    s_add_u32 s44, s44, 20971520
    s_add_u32 s47, s43, s21
    s_mul_i32 s47, s47, 229376
    s_add_u32 s47, s47, 49872896
    s_cmp_lt_u32 s43, 2
    s_cselect_b32 s47, s44, s47
    s_add_u32 s47, s47, s39
    s_add_u32 m0, s50, 0
    s_nop 0
    buffer_load_dwordx4 v6, s[4:7], s47 offen offset:0 lds
    buffer_load_dwordx4 v6, s[4:7], s47 offen offset:1024 lds
    s_add_u32 s43, s22, 8
    s_mul_i32 s51, s43, 2048
    s_and_b32 s39, s43, 1
    s_mul_i32 s39, s39, 2048
    s_lshr_b32 s43, s43, 1
    s_add_u32 s44, s43, s20
    s_mul_i32 s44, s44, 229376
    s_add_u32 s44, s44, 20971520
    s_add_u32 s48, s43, s21
    s_mul_i32 s48, s48, 229376
    s_add_u32 s48, s48, 49872896
    s_cmp_lt_u32 s43, 2
    s_cselect_b32 s48, s44, s48
    s_add_u32 s48, s48, s39
    s_add_u32 m0, s51, 0
    s_nop 0
    buffer_load_dwordx4 v6, s[4:7], s48 offen offset:0 lds
    buffer_load_dwordx4 v6, s[4:7], s48 offen offset:1024 lds
    v_add_u32 v6, 4096, v6
    s_add_u32 m0, s49, 24576
    s_nop 0
    buffer_load_dwordx4 v6, s[4:7], s46 offen offset:0 lds
    buffer_load_dwordx4 v6, s[4:7], s46 offen offset:1024 lds
    s_add_u32 m0, s50, 24576
    s_nop 0
    buffer_load_dwordx4 v6, s[4:7], s47 offen offset:0 lds
    buffer_load_dwordx4 v6, s[4:7], s47 offen offset:1024 lds
    s_add_u32 m0, s51, 24576
    s_nop 0
    buffer_load_dwordx4 v6, s[4:7], s48 offen offset:0 lds
    buffer_load_dwordx4 v6, s[4:7], s48 offen offset:1024 lds
    v_add_u32 v6, 4096, v6
    s_add_u32 m0, s49, 49152
    s_nop 0
    buffer_load_dwordx4 v6, s[4:7], s46 offen offset:0 lds
    buffer_load_dwordx4 v6, s[4:7], s46 offen offset:1024 lds
    s_add_u32 m0, s50, 49152
    s_nop 0
    buffer_load_dwordx4 v6, s[4:7], s47 offen offset:0 lds
    buffer_load_dwordx4 v6, s[4:7], s47 offen offset:1024 lds
    s_add_u32 m0, s51, 49152
    s_nop 0
    buffer_load_dwordx4 v6, s[4:7], s48 offen offset:0 lds
    buffer_load_dwordx4 v6, s[4:7], s48 offen offset:1024 lds
    v_add_u32 v6, 4096, v6
    s_add_u32 m0, s49, 73728
    s_nop 0
    buffer_load_dwordx4 v6, s[4:7], s46 offen offset:0 lds
    buffer_load_dwordx4 v6, s[4:7], s46 offen offset:1024 lds
    s_add_u32 m0, s50, 73728
    s_nop 0
    buffer_load_dwordx4 v6, s[4:7], s47 offen offset:0 lds
    buffer_load_dwordx4 v6, s[4:7], s47 offen offset:1024 lds
    s_add_u32 m0, s51, 73728
    s_nop 0
    buffer_load_dwordx4 v6, s[4:7], s48 offen offset:0 lds
    buffer_load_dwordx4 v6, s[4:7], s48 offen offset:1024 lds
    v_add_u32 v6, 4096, v6
    v_and_b32 v4, 15, v0
    v_lshlrev_b32 v4, 4, v4
    v_bfe_u32 v5, v0, 4, 2
    v_lshl_add_u32 v4, v5, 9, v4
    s_and_b32 s43, s22, 0
    s_mul_i32 s43, s43, 8192
    v_add_u32 v2, s43, v4
    s_lshr_b32 s43, s22, 0
    s_mul_i32 s43, s43, 4096
    s_add_u32 s43, s43, 8192
    v_add_u32 v3, s43, v4
    v_and_b32 v8, 63, v0
    v_lshlrev_b32 v9, 4, v8
    v_and_b32 v10, 15, v8
    v_lshrrev_b32 v11, 5, v8
    v_lshl_add_u32 v10, v11, 4, v10
    v_bfe_u32 v11, v8, 4, 1
    v_lshl_add_u32 v9, v11, 5, v10
    v_lshlrev_b32 v9, 4, v9
    v_lshlrev_b32 v12, 11, v10
    v_lshl_add_u32 v12, v11, 4, v12
    v_lshlrev_b32 v13, 5, v11
    s_add_u32 s13, s21, s22
    s_lshl_b32 s14, s13, 16
    s_lshl_b32 s15, s20, 6
    s_add_u32 s14, s14, s15
    s_lshl_b32 s15, s20, 11
    s_lshl_b32 s16, s13, 16
    s_add_u32 s16, s16, s15
    s_add_u32 s16, s16, 16777216
    s_lshl_b32 s15, s20, 7
    s_add_u32 s15, s15, 151552
    s_mul_i32 s18, s2, 224
    v_lshlrev_b32 v15, 2, v8
    s_cmp_lg_u32 s22, 3
    s_cbranch_scc1 L_ct_k6_skip
    s_getpc_b64 s[28:29]
L_ct_k6:
    v_and_b32 v7, 63, v0
    v_lshlrev_b32 v7, 7, v7
    s_mov_b32 s30, L_k6_kernel_exit-L_ct_k6-4
    v_min_u32 v14, s30, v7
    global_load_dword v200, v14, s[28:29]
L_ct_k6_skip:
    v_mov_b32 v16, 0
    v_mov_b32 v17, 0
    v_mov_b32 v18, 0
    v_mov_b32 v19, 0
    v_mov_b32 v20, 0
    v_mov_b32 v21, 0
    v_mov_b32 v22, 0
    v_mov_b32 v23, 0
    v_mov_b32 v24, 0
    v_mov_b32 v25, 0
    v_mov_b32 v26, 0
    v_mov_b32 v27, 0
    v_mov_b32 v28, 0
    v_mov_b32 v29, 0
    v_mov_b32 v30, 0
    v_mov_b32 v31, 0
    v_mov_b32 v32, 0
    v_mov_b32 v33, 0
    v_mov_b32 v34, 0
    v_mov_b32 v35, 0
    v_mov_b32 v36, 0
    v_mov_b32 v37, 0
    v_mov_b32 v38, 0
    v_mov_b32 v39, 0
    v_mov_b32 v40, 0
    v_mov_b32 v41, 0
    v_mov_b32 v42, 0
    v_mov_b32 v43, 0
    v_mov_b32 v44, 0
    v_mov_b32 v45, 0
    v_mov_b32 v46, 0
    v_mov_b32 v47, 0
    s_mov_b32 s40, 0
    v_mov_b32 v4, v2
    v_mov_b32 v5, v3
    s_waitcnt vmcnt(18)
    s_barrier
    ds_read_b128 v[96:99], v4 offset:0
    ds_read_b128 v[104:107], v5 offset:0
    ds_read_b128 v[116:119], v5 offset:256
    ds_read_b128 v[108:111], v4 offset:256
    ds_read_b128 v[100:103], v4 offset:4096
    ds_read_b128 v[112:115], v4 offset:4352
    ds_read_b128 v[120:123], v4 offset:2048
    ds_read_b128 v[128:131], v5 offset:2048
    ds_read_b128 v[140:143], v5 offset:2304
    ds_read_b128 v[132:135], v4 offset:2304
    ds_read_b128 v[124:127], v4 offset:6144
    ds_read_b128 v[136:139], v4 offset:6400
    s_mov_b32 s40, 24576
    s_mov_b32 s41, 0
    v_add_u32 v4, 24576, v2
    v_add_u32 v5, 24576, v3
    s_waitcnt vmcnt(12) lgkmcnt(0)
    s_barrier
    v_mfma_f32_16x16x32_bf16 v[16:19], v[96:99], v[104:107], v[16:19]
    ds_read_b128 v[144:147], v4 offset:0
    s_add_u32 m0, s49, 98304
    s_nop 0
    buffer_load_dwordx4 v6, s[4:7], s46 offen offset:0 lds
    v_mfma_f32_16x16x32_bf16 v[20:23], v[96:99], v[116:119], v[20:23]
    ds_read_b128 v[152:155], v5 offset:0
    buffer_load_dwordx4 v6, s[4:7], s46 offen offset:1024 lds
    s_add_u32 m0, s50, 98304
    v_mfma_f32_16x16x32_bf16 v[24:27], v[108:111], v[104:107], v[24:27]
    ds_read_b128 v[164:167], v5 offset:256
    buffer_load_dwordx4 v6, s[4:7], s47 offen offset:0 lds
    v_mfma_f32_16x16x32_bf16 v[28:31], v[108:111], v[116:119], v[28:31]
    ds_read_b128 v[156:159], v4 offset:256
    v_mfma_f32_16x16x32_bf16 v[32:35], v[100:103], v[104:107], v[32:35]
    ds_read_b128 v[148:151], v4 offset:4096
    buffer_load_dwordx4 v6, s[4:7], s47 offen offset:1024 lds
    s_add_u32 m0, s51, 98304
    v_mfma_f32_16x16x32_bf16 v[36:39], v[100:103], v[116:119], v[36:39]
    ds_read_b128 v[160:163], v4 offset:4352
    buffer_load_dwordx4 v6, s[4:7], s48 offen offset:0 lds
    v_mfma_f32_16x16x32_bf16 v[40:43], v[112:115], v[104:107], v[40:43]
    ds_read_b128 v[168:171], v4 offset:2048
    buffer_load_dwordx4 v6, s[4:7], s48 offen offset:1024 lds
    v_add_u32 v6, 4096, v6
    v_mfma_f32_16x16x32_bf16 v[44:47], v[112:115], v[116:119], v[44:47]
    ds_read_b128 v[176:179], v5 offset:2048
    s_add_u32 m0, s49, 122880
    v_mfma_f32_16x16x32_bf16 v[16:19], v[120:123], v[128:131], v[16:19]
    ds_read_b128 v[188:191], v5 offset:2304
    buffer_load_dwordx4 v6, s[4:7], s46 offen offset:0 lds
    v_mfma_f32_16x16x32_bf16 v[20:23], v[120:123], v[140:143], v[20:23]
    ds_read_b128 v[180:183], v4 offset:2304
    buffer_load_dwordx4 v6, s[4:7], s46 offen offset:1024 lds
    s_add_u32 m0, s50, 122880
    v_mfma_f32_16x16x32_bf16 v[24:27], v[132:135], v[128:131], v[24:27]
    ds_read_b128 v[172:175], v4 offset:6144
    buffer_load_dwordx4 v6, s[4:7], s47 offen offset:0 lds
    v_mfma_f32_16x16x32_bf16 v[28:31], v[132:135], v[140:143], v[28:31]
    ds_read_b128 v[184:187], v4 offset:6400
    v_mfma_f32_16x16x32_bf16 v[32:35], v[124:127], v[128:131], v[32:35]
    buffer_load_dwordx4 v6, s[4:7], s47 offen offset:1024 lds
    s_add_u32 m0, s51, 122880
    v_mfma_f32_16x16x32_bf16 v[36:39], v[124:127], v[140:143], v[36:39]
    buffer_load_dwordx4 v6, s[4:7], s48 offen offset:0 lds
    s_add_u32 s41, s40, 24576
    s_cmp_eq_u32 s41, 147456
    s_cselect_b32 s41, 0, s41
    v_mfma_f32_16x16x32_bf16 v[40:43], v[136:139], v[128:131], v[40:43]
    buffer_load_dwordx4 v6, s[4:7], s48 offen offset:1024 lds
    v_add_u32 v6, 4096, v6
    v_add_u32 v4, s41, v2
    v_mfma_f32_16x16x32_bf16 v[44:47], v[136:139], v[140:143], v[44:47]
    v_add_u32 v5, s41, v3
    s_waitcnt vmcnt(18) lgkmcnt(0)
    s_barrier
    v_mfma_f32_16x16x32_bf16 v[16:19], v[144:147], v[152:155], v[16:19]
    ds_read_b128 v[96:99], v4 offset:0
    s_add_u32 m0, s49, 0
    s_nop 0
    buffer_load_dwordx4 v6, s[4:7], s46 offen offset:0 lds
    v_mfma_f32_16x16x32_bf16 v[20:23], v[144:147], v[164:167], v[20:23]
    ds_read_b128 v[104:107], v5 offset:0
    buffer_load_dwordx4 v6, s[4:7], s46 offen offset:1024 lds
    s_add_u32 m0, s50, 0
    v_mfma_f32_16x16x32_bf16 v[24:27], v[156:159], v[152:155], v[24:27]
    ds_read_b128 v[116:119], v5 offset:256
    buffer_load_dwordx4 v6, s[4:7], s47 offen offset:0 lds
    v_mfma_f32_16x16x32_bf16 v[28:31], v[156:159], v[164:167], v[28:31]
    ds_read_b128 v[108:111], v4 offset:256
    v_mfma_f32_16x16x32_bf16 v[32:35], v[148:151], v[152:155], v[32:35]
    ds_read_b128 v[100:103], v4 offset:4096
    buffer_load_dwordx4 v6, s[4:7], s47 offen offset:1024 lds
    s_add_u32 m0, s51, 0
    v_mfma_f32_16x16x32_bf16 v[36:39], v[148:151], v[164:167], v[36:39]
    ds_read_b128 v[112:115], v4 offset:4352
    buffer_load_dwordx4 v6, s[4:7], s48 offen offset:0 lds
    v_mfma_f32_16x16x32_bf16 v[40:43], v[160:163], v[152:155], v[40:43]
    ds_read_b128 v[120:123], v4 offset:2048
    buffer_load_dwordx4 v6, s[4:7], s48 offen offset:1024 lds
    v_add_u32 v6, 4096, v6
    v_mfma_f32_16x16x32_bf16 v[44:47], v[160:163], v[164:167], v[44:47]
    ds_read_b128 v[128:131], v5 offset:2048
    s_add_u32 m0, s49, 24576
    v_mfma_f32_16x16x32_bf16 v[16:19], v[168:171], v[176:179], v[16:19]
    ds_read_b128 v[140:143], v5 offset:2304
    buffer_load_dwordx4 v6, s[4:7], s46 offen offset:0 lds
    v_mfma_f32_16x16x32_bf16 v[20:23], v[168:171], v[188:191], v[20:23]
    ds_read_b128 v[132:135], v4 offset:2304
    buffer_load_dwordx4 v6, s[4:7], s46 offen offset:1024 lds
    s_add_u32 m0, s50, 24576
    v_mfma_f32_16x16x32_bf16 v[24:27], v[180:183], v[176:179], v[24:27]
    ds_read_b128 v[124:127], v4 offset:6144
    buffer_load_dwordx4 v6, s[4:7], s47 offen offset:0 lds
    v_mfma_f32_16x16x32_bf16 v[28:31], v[180:183], v[188:191], v[28:31]
    ds_read_b128 v[136:139], v4 offset:6400
    v_mfma_f32_16x16x32_bf16 v[32:35], v[172:175], v[176:179], v[32:35]
    buffer_load_dwordx4 v6, s[4:7], s47 offen offset:1024 lds
    s_add_u32 m0, s51, 24576
    v_mfma_f32_16x16x32_bf16 v[36:39], v[172:175], v[188:191], v[36:39]
    buffer_load_dwordx4 v6, s[4:7], s48 offen offset:0 lds
    s_add_u32 s40, s41, 24576
    s_cmp_eq_u32 s40, 147456
    s_cselect_b32 s40, 0, s40
    v_mfma_f32_16x16x32_bf16 v[40:43], v[184:187], v[176:179], v[40:43]
    buffer_load_dwordx4 v6, s[4:7], s48 offen offset:1024 lds
    v_add_u32 v6, 4096, v6
    v_add_u32 v4, s40, v2
    v_mfma_f32_16x16x32_bf16 v[44:47], v[184:187], v[188:191], v[44:47]
    v_add_u32 v5, s40, v3
    s_mov_b32 s42, 24
.p2align 6
L_k6_loop:
    s_waitcnt vmcnt(24) lgkmcnt(0)
    s_barrier
    v_mfma_f32_16x16x32_bf16 v[16:19], v[96:99], v[104:107], v[16:19]
    ds_read_b128 v[144:147], v4 offset:0
    s_add_u32 m0, s41, s49
    v_mfma_f32_16x16x32_bf16 v[20:23], v[96:99], v[116:119], v[20:23]
    ds_read_b128 v[152:155], v5 offset:0
    buffer_load_dwordx4 v6, s[4:7], s46 offen offset:0 lds
    v_mfma_f32_16x16x32_bf16 v[24:27], v[108:111], v[104:107], v[24:27]
    ds_read_b128 v[164:167], v5 offset:256
    v_mfma_f32_16x16x32_bf16 v[28:31], v[108:111], v[116:119], v[28:31]
    ds_read_b128 v[156:159], v4 offset:256
    buffer_load_dwordx4 v6, s[4:7], s46 offen offset:1024 lds
    v_mfma_f32_16x16x32_bf16 v[32:35], v[100:103], v[104:107], v[32:35]
    ds_read_b128 v[148:151], v4 offset:4096
    v_mfma_f32_16x16x32_bf16 v[36:39], v[100:103], v[116:119], v[36:39]
    ds_read_b128 v[160:163], v4 offset:4352
    s_add_u32 m0, s41, s50
    v_mfma_f32_16x16x32_bf16 v[40:43], v[112:115], v[104:107], v[40:43]
    ds_read_b128 v[168:171], v4 offset:2048
    buffer_load_dwordx4 v6, s[4:7], s47 offen offset:0 lds
    v_mfma_f32_16x16x32_bf16 v[44:47], v[112:115], v[116:119], v[44:47]
    ds_read_b128 v[176:179], v5 offset:2048
    v_mfma_f32_16x16x32_bf16 v[16:19], v[120:123], v[128:131], v[16:19]
    ds_read_b128 v[188:191], v5 offset:2304
    v_mfma_f32_16x16x32_bf16 v[20:23], v[120:123], v[140:143], v[20:23]
    ds_read_b128 v[180:183], v4 offset:2304
    buffer_load_dwordx4 v6, s[4:7], s47 offen offset:1024 lds
    v_mfma_f32_16x16x32_bf16 v[24:27], v[132:135], v[128:131], v[24:27]
    ds_read_b128 v[172:175], v4 offset:6144
    s_add_u32 m0, s41, s51
    v_mfma_f32_16x16x32_bf16 v[28:31], v[132:135], v[140:143], v[28:31]
    ds_read_b128 v[184:187], v4 offset:6400
    buffer_load_dwordx4 v6, s[4:7], s48 offen offset:0 lds
    v_mfma_f32_16x16x32_bf16 v[32:35], v[124:127], v[128:131], v[32:35]
    s_add_u32 s41, s40, 24576
    s_cmp_eq_u32 s41, 147456
    s_cselect_b32 s41, 0, s41
    v_mfma_f32_16x16x32_bf16 v[36:39], v[124:127], v[140:143], v[36:39]
    v_add_u32 v4, s41, v2
    v_mfma_f32_16x16x32_bf16 v[40:43], v[136:139], v[128:131], v[40:43]
    buffer_load_dwordx4 v6, s[4:7], s48 offen offset:1024 lds
    v_add_u32 v6, 4096, v6
    v_add_u32 v5, s41, v3
    v_mfma_f32_16x16x32_bf16 v[44:47], v[136:139], v[140:143], v[44:47]
    s_waitcnt vmcnt(24) lgkmcnt(0)
    s_barrier
    v_mfma_f32_16x16x32_bf16 v[16:19], v[144:147], v[152:155], v[16:19]
    ds_read_b128 v[96:99], v4 offset:0
    s_add_u32 m0, s40, s49
    v_mfma_f32_16x16x32_bf16 v[20:23], v[144:147], v[164:167], v[20:23]
    ds_read_b128 v[104:107], v5 offset:0
    buffer_load_dwordx4 v6, s[4:7], s46 offen offset:0 lds
    v_mfma_f32_16x16x32_bf16 v[24:27], v[156:159], v[152:155], v[24:27]
    ds_read_b128 v[116:119], v5 offset:256
    v_mfma_f32_16x16x32_bf16 v[28:31], v[156:159], v[164:167], v[28:31]
    ds_read_b128 v[108:111], v4 offset:256
    buffer_load_dwordx4 v6, s[4:7], s46 offen offset:1024 lds
    v_mfma_f32_16x16x32_bf16 v[32:35], v[148:151], v[152:155], v[32:35]
    ds_read_b128 v[100:103], v4 offset:4096
    v_mfma_f32_16x16x32_bf16 v[36:39], v[148:151], v[164:167], v[36:39]
    ds_read_b128 v[112:115], v4 offset:4352
    s_add_u32 m0, s40, s50
    v_mfma_f32_16x16x32_bf16 v[40:43], v[160:163], v[152:155], v[40:43]
    ds_read_b128 v[120:123], v4 offset:2048
    buffer_load_dwordx4 v6, s[4:7], s47 offen offset:0 lds
    v_mfma_f32_16x16x32_bf16 v[44:47], v[160:163], v[164:167], v[44:47]
    ds_read_b128 v[128:131], v5 offset:2048
    v_mfma_f32_16x16x32_bf16 v[16:19], v[168:171], v[176:179], v[16:19]
    ds_read_b128 v[140:143], v5 offset:2304
    v_mfma_f32_16x16x32_bf16 v[20:23], v[168:171], v[188:191], v[20:23]
    ds_read_b128 v[132:135], v4 offset:2304
    buffer_load_dwordx4 v6, s[4:7], s47 offen offset:1024 lds
    v_mfma_f32_16x16x32_bf16 v[24:27], v[180:183], v[176:179], v[24:27]
    ds_read_b128 v[124:127], v4 offset:6144
    s_add_u32 m0, s40, s51
    v_mfma_f32_16x16x32_bf16 v[28:31], v[180:183], v[188:191], v[28:31]
    ds_read_b128 v[136:139], v4 offset:6400
    buffer_load_dwordx4 v6, s[4:7], s48 offen offset:0 lds
    v_mfma_f32_16x16x32_bf16 v[32:35], v[172:175], v[176:179], v[32:35]
    s_add_u32 s40, s41, 24576
    s_cmp_eq_u32 s40, 147456
    s_cselect_b32 s40, 0, s40
    v_mfma_f32_16x16x32_bf16 v[36:39], v[172:175], v[188:191], v[36:39]
    v_add_u32 v4, s40, v2
    v_mfma_f32_16x16x32_bf16 v[40:43], v[184:187], v[176:179], v[40:43]
    buffer_load_dwordx4 v6, s[4:7], s48 offen offset:1024 lds
    v_add_u32 v6, 4096, v6
    v_add_u32 v5, s40, v3
    v_mfma_f32_16x16x32_bf16 v[44:47], v[184:187], v[188:191], v[44:47]
    s_sub_u32 s42, s42, 1
    s_cmp_lg_u32 s42, 0
    s_cbranch_scc1 L_k6_loop
    s_waitcnt vmcnt(24) lgkmcnt(0)
    s_barrier
    v_mfma_f32_16x16x32_bf16 v[16:19], v[96:99], v[104:107], v[16:19]
    ds_read_b128 v[144:147], v4 offset:0
    v_mfma_f32_16x16x32_bf16 v[20:23], v[96:99], v[116:119], v[20:23]
    ds_read_b128 v[152:155], v5 offset:0
    v_mfma_f32_16x16x32_bf16 v[24:27], v[108:111], v[104:107], v[24:27]
    ds_read_b128 v[164:167], v5 offset:256
    buffer_load_dwordx4 v[48:51], v9, s[4:7], s16 offen offset:0
    v_mfma_f32_16x16x32_bf16 v[28:31], v[108:111], v[116:119], v[28:31]
    ds_read_b128 v[156:159], v4 offset:256
    v_mfma_f32_16x16x32_bf16 v[32:35], v[100:103], v[104:107], v[32:35]
    ds_read_b128 v[148:151], v4 offset:4096
    v_mfma_f32_16x16x32_bf16 v[36:39], v[100:103], v[116:119], v[36:39]
    ds_read_b128 v[160:163], v4 offset:4352
    v_mfma_f32_16x16x32_bf16 v[40:43], v[112:115], v[104:107], v[40:43]
    ds_read_b128 v[168:171], v4 offset:2048
    buffer_load_dwordx4 v[52:55], v9, s[4:7], s16 offen offset:1024
    v_mfma_f32_16x16x32_bf16 v[44:47], v[112:115], v[116:119], v[44:47]
    ds_read_b128 v[176:179], v5 offset:2048
    v_mfma_f32_16x16x32_bf16 v[16:19], v[120:123], v[128:131], v[16:19]
    ds_read_b128 v[188:191], v5 offset:2304
    v_mfma_f32_16x16x32_bf16 v[20:23], v[120:123], v[140:143], v[20:23]
    ds_read_b128 v[180:183], v4 offset:2304
    v_mfma_f32_16x16x32_bf16 v[24:27], v[132:135], v[128:131], v[24:27]
    ds_read_b128 v[172:175], v4 offset:6144
    buffer_load_dwordx4 v[56:59], v9, s[4:7], s16 offen offset:2048
    v_mfma_f32_16x16x32_bf16 v[28:31], v[132:135], v[140:143], v[28:31]
    ds_read_b128 v[184:187], v4 offset:6400
    v_mfma_f32_16x16x32_bf16 v[32:35], v[124:127], v[128:131], v[32:35]
    s_add_u32 s41, s40, 24576
    s_cmp_eq_u32 s41, 147456
    s_cselect_b32 s41, 0, s41
    v_mfma_f32_16x16x32_bf16 v[36:39], v[124:127], v[140:143], v[36:39]
    v_add_u32 v4, s41, v2
    v_mfma_f32_16x16x32_bf16 v[40:43], v[136:139], v[128:131], v[40:43]
    buffer_load_dwordx4 v[60:63], v9, s[4:7], s16 offen offset:3072
    v_add_u32 v5, s41, v3
    v_mfma_f32_16x16x32_bf16 v[44:47], v[136:139], v[140:143], v[44:47]
    s_waitcnt vmcnt(22) lgkmcnt(0)
    s_barrier
    v_mfma_f32_16x16x32_bf16 v[16:19], v[144:147], v[152:155], v[16:19]
    ds_read_b128 v[96:99], v4 offset:0
    v_mfma_f32_16x16x32_bf16 v[20:23], v[144:147], v[164:167], v[20:23]
    ds_read_b128 v[104:107], v5 offset:0
    v_mfma_f32_16x16x32_bf16 v[24:27], v[156:159], v[152:155], v[24:27]
    ds_read_b128 v[116:119], v5 offset:256
    buffer_load_dwordx4 v[64:67], v13, s[4:7], s15 offen offset:0
    v_mfma_f32_16x16x32_bf16 v[28:31], v[156:159], v[164:167], v[28:31]
    ds_read_b128 v[108:111], v4 offset:256
    v_mfma_f32_16x16x32_bf16 v[32:35], v[148:151], v[152:155], v[32:35]
    ds_read_b128 v[100:103], v4 offset:4096
    v_mfma_f32_16x16x32_bf16 v[36:39], v[148:151], v[164:167], v[36:39]
    ds_read_b128 v[112:115], v4 offset:4352
    v_mfma_f32_16x16x32_bf16 v[40:43], v[160:163], v[152:155], v[40:43]
    ds_read_b128 v[120:123], v4 offset:2048
    buffer_load_dwordx4 v[68:71], v13, s[4:7], s15 offen offset:16
    v_mfma_f32_16x16x32_bf16 v[44:47], v[160:163], v[164:167], v[44:47]
    ds_read_b128 v[128:131], v5 offset:2048
    v_mfma_f32_16x16x32_bf16 v[16:19], v[168:171], v[176:179], v[16:19]
    ds_read_b128 v[140:143], v5 offset:2304
    v_mfma_f32_16x16x32_bf16 v[20:23], v[168:171], v[188:191], v[20:23]
    ds_read_b128 v[132:135], v4 offset:2304
    v_mfma_f32_16x16x32_bf16 v[24:27], v[180:183], v[176:179], v[24:27]
    ds_read_b128 v[124:127], v4 offset:6144
    buffer_load_dwordx4 v[72:75], v13, s[4:7], s15 offen offset:64
    v_mfma_f32_16x16x32_bf16 v[28:31], v[180:183], v[188:191], v[28:31]
    ds_read_b128 v[136:139], v4 offset:6400
    v_mfma_f32_16x16x32_bf16 v[32:35], v[172:175], v[176:179], v[32:35]
    s_add_u32 s40, s41, 24576
    s_cmp_eq_u32 s40, 147456
    s_cselect_b32 s40, 0, s40
    v_mfma_f32_16x16x32_bf16 v[36:39], v[172:175], v[188:191], v[36:39]
    v_add_u32 v4, s40, v2
    v_mfma_f32_16x16x32_bf16 v[40:43], v[184:187], v[176:179], v[40:43]
    buffer_load_dwordx4 v[76:79], v13, s[4:7], s15 offen offset:80
    v_add_u32 v5, s40, v3
    v_mfma_f32_16x16x32_bf16 v[44:47], v[184:187], v[188:191], v[44:47]
    s_waitcnt vmcnt(20) lgkmcnt(0)
    s_barrier
    v_mfma_f32_16x16x32_bf16 v[16:19], v[96:99], v[104:107], v[16:19]
    ds_read_b128 v[144:147], v4 offset:0
    v_mfma_f32_16x16x32_bf16 v[20:23], v[96:99], v[116:119], v[20:23]
    ds_read_b128 v[152:155], v5 offset:0
    v_mfma_f32_16x16x32_bf16 v[24:27], v[108:111], v[104:107], v[24:27]
    ds_read_b128 v[164:167], v5 offset:256
    buffer_load_dwordx4 v[80:83], v13, s[4:7], s15 offen offset:128
    v_mfma_f32_16x16x32_bf16 v[28:31], v[108:111], v[116:119], v[28:31]
    ds_read_b128 v[156:159], v4 offset:256
    v_mfma_f32_16x16x32_bf16 v[32:35], v[100:103], v[104:107], v[32:35]
    ds_read_b128 v[148:151], v4 offset:4096
    v_mfma_f32_16x16x32_bf16 v[36:39], v[100:103], v[116:119], v[36:39]
    ds_read_b128 v[160:163], v4 offset:4352
    v_mfma_f32_16x16x32_bf16 v[40:43], v[112:115], v[104:107], v[40:43]
    ds_read_b128 v[168:171], v4 offset:2048
    buffer_load_dwordx4 v[84:87], v13, s[4:7], s15 offen offset:144
    v_mfma_f32_16x16x32_bf16 v[44:47], v[112:115], v[116:119], v[44:47]
    ds_read_b128 v[176:179], v5 offset:2048
    v_mfma_f32_16x16x32_bf16 v[16:19], v[120:123], v[128:131], v[16:19]
    ds_read_b128 v[188:191], v5 offset:2304
    v_mfma_f32_16x16x32_bf16 v[20:23], v[120:123], v[140:143], v[20:23]
    ds_read_b128 v[180:183], v4 offset:2304
    v_mfma_f32_16x16x32_bf16 v[24:27], v[132:135], v[128:131], v[24:27]
    ds_read_b128 v[172:175], v4 offset:6144
    buffer_load_dwordx4 v[88:91], v13, s[4:7], s15 offen offset:192
    v_mfma_f32_16x16x32_bf16 v[28:31], v[132:135], v[140:143], v[28:31]
    ds_read_b128 v[184:187], v4 offset:6400
    v_mfma_f32_16x16x32_bf16 v[32:35], v[124:127], v[128:131], v[32:35]
    s_add_u32 s41, s40, 24576
    s_cmp_eq_u32 s41, 147456
    s_cselect_b32 s41, 0, s41
    v_mfma_f32_16x16x32_bf16 v[36:39], v[124:127], v[140:143], v[36:39]
    v_add_u32 v4, s41, v2
    v_mfma_f32_16x16x32_bf16 v[40:43], v[136:139], v[128:131], v[40:43]
    buffer_load_dwordx4 v[92:95], v13, s[4:7], s15 offen offset:208
    v_add_u32 v5, s41, v3
    v_mfma_f32_16x16x32_bf16 v[44:47], v[136:139], v[140:143], v[44:47]
    s_waitcnt vmcnt(18) lgkmcnt(0)
    s_barrier
    v_mfma_f32_16x16x32_bf16 v[16:19], v[144:147], v[152:155], v[16:19]
    ds_read_b128 v[96:99], v4 offset:0
    v_mfma_f32_16x16x32_bf16 v[20:23], v[144:147], v[164:167], v[20:23]
    ds_read_b128 v[104:107], v5 offset:0
    v_mfma_f32_16x16x32_bf16 v[24:27], v[156:159], v[152:155], v[24:27]
    ds_read_b128 v[116:119], v5 offset:256
    v_mfma_f32_16x16x32_bf16 v[28:31], v[156:159], v[164:167], v[28:31]
    ds_read_b128 v[108:111], v4 offset:256
    v_mfma_f32_16x16x32_bf16 v[32:35], v[148:151], v[152:155], v[32:35]
    ds_read_b128 v[100:103], v4 offset:4096
    v_mfma_f32_16x16x32_bf16 v[36:39], v[148:151], v[164:167], v[36:39]
    ds_read_b128 v[112:115], v4 offset:4352
    v_mfma_f32_16x16x32_bf16 v[40:43], v[160:163], v[152:155], v[40:43]
    ds_read_b128 v[120:123], v4 offset:2048
    v_mfma_f32_16x16x32_bf16 v[44:47], v[160:163], v[164:167], v[44:47]
    ds_read_b128 v[128:131], v5 offset:2048
    v_mfma_f32_16x16x32_bf16 v[16:19], v[168:171], v[176:179], v[16:19]
    ds_read_b128 v[140:143], v5 offset:2304
    v_mfma_f32_16x16x32_bf16 v[20:23], v[168:171], v[188:191], v[20:23]
    ds_read_b128 v[132:135], v4 offset:2304
    v_mfma_f32_16x16x32_bf16 v[24:27], v[180:183], v[176:179], v[24:27]
    ds_read_b128 v[124:127], v4 offset:6144
    v_mfma_f32_16x16x32_bf16 v[28:31], v[180:183], v[188:191], v[28:31]
    ds_read_b128 v[136:139], v4 offset:6400
    v_mfma_f32_16x16x32_bf16 v[32:35], v[172:175], v[176:179], v[32:35]
    s_add_u32 s40, s41, 24576
    s_cmp_eq_u32 s40, 147456
    s_cselect_b32 s40, 0, s40
    v_mfma_f32_16x16x32_bf16 v[36:39], v[172:175], v[188:191], v[36:39]
    v_add_u32 v4, s40, v2
    v_mfma_f32_16x16x32_bf16 v[40:43], v[184:187], v[176:179], v[40:43]
    v_add_u32 v5, s40, v3
    v_mfma_f32_16x16x32_bf16 v[44:47], v[184:187], v[188:191], v[44:47]
    s_waitcnt vmcnt(12) lgkmcnt(0)
    s_barrier
    v_mfma_f32_16x16x32_bf16 v[16:19], v[96:99], v[104:107], v[16:19]
    ds_read_b128 v[144:147], v4 offset:0
    v_mfma_f32_16x16x32_bf16 v[20:23], v[96:99], v[116:119], v[20:23]
    ds_read_b128 v[152:155], v5 offset:0
    v_mfma_f32_16x16x32_bf16 v[24:27], v[108:111], v[104:107], v[24:27]
    ds_read_b128 v[164:167], v5 offset:256
    v_mfma_f32_16x16x32_bf16 v[28:31], v[108:111], v[116:119], v[28:31]
    ds_read_b128 v[156:159], v4 offset:256
    v_mfma_f32_16x16x32_bf16 v[32:35], v[100:103], v[104:107], v[32:35]
    ds_read_b128 v[148:151], v4 offset:4096
    v_mfma_f32_16x16x32_bf16 v[36:39], v[100:103], v[116:119], v[36:39]
    ds_read_b128 v[160:163], v4 offset:4352
    v_mfma_f32_16x16x32_bf16 v[40:43], v[112:115], v[104:107], v[40:43]
    ds_read_b128 v[168:171], v4 offset:2048
    v_mfma_f32_16x16x32_bf16 v[44:47], v[112:115], v[116:119], v[44:47]
    ds_read_b128 v[176:179], v5 offset:2048
    v_mfma_f32_16x16x32_bf16 v[16:19], v[120:123], v[128:131], v[16:19]
    ds_read_b128 v[188:191], v5 offset:2304
    v_mfma_f32_16x16x32_bf16 v[20:23], v[120:123], v[140:143], v[20:23]
    ds_read_b128 v[180:183], v4 offset:2304
    v_mfma_f32_16x16x32_bf16 v[24:27], v[132:135], v[128:131], v[24:27]
    ds_read_b128 v[172:175], v4 offset:6144
    v_mfma_f32_16x16x32_bf16 v[28:31], v[132:135], v[140:143], v[28:31]
    ds_read_b128 v[184:187], v4 offset:6400
    v_mfma_f32_16x16x32_bf16 v[32:35], v[124:127], v[128:131], v[32:35]
    s_add_u32 s41, s40, 24576
    s_cmp_eq_u32 s41, 147456
    s_cselect_b32 s41, 0, s41
    v_mfma_f32_16x16x32_bf16 v[36:39], v[124:127], v[140:143], v[36:39]
    v_add_u32 v4, s41, v2
    v_mfma_f32_16x16x32_bf16 v[40:43], v[136:139], v[128:131], v[40:43]
    v_add_u32 v5, s41, v3
    v_mfma_f32_16x16x32_bf16 v[44:47], v[136:139], v[140:143], v[44:47]
    s_waitcnt lgkmcnt(0)
    v_mfma_f32_16x16x32_bf16 v[16:19], v[144:147], v[152:155], v[16:19]
    v_mfma_f32_16x16x32_bf16 v[20:23], v[144:147], v[164:167], v[20:23]
    v_mfma_f32_16x16x32_bf16 v[24:27], v[156:159], v[152:155], v[24:27]
    v_mfma_f32_16x16x32_bf16 v[28:31], v[156:159], v[164:167], v[28:31]
    v_mfma_f32_16x16x32_bf16 v[32:35], v[148:151], v[152:155], v[32:35]
    v_mfma_f32_16x16x32_bf16 v[36:39], v[148:151], v[164:167], v[36:39]
    v_mfma_f32_16x16x32_bf16 v[40:43], v[160:163], v[152:155], v[40:43]
    v_mfma_f32_16x16x32_bf16 v[44:47], v[160:163], v[164:167], v[44:47]
    v_mfma_f32_16x16x32_bf16 v[16:19], v[168:171], v[176:179], v[16:19]
    v_mfma_f32_16x16x32_bf16 v[20:23], v[168:171], v[188:191], v[20:23]
    v_mfma_f32_16x16x32_bf16 v[24:27], v[180:183], v[176:179], v[24:27]
    v_mfma_f32_16x16x32_bf16 v[28:31], v[180:183], v[188:191], v[28:31]
    v_mfma_f32_16x16x32_bf16 v[32:35], v[172:175], v[176:179], v[32:35]
    v_mfma_f32_16x16x32_bf16 v[36:39], v[172:175], v[188:191], v[36:39]
    v_mfma_f32_16x16x32_bf16 v[40:43], v[184:187], v[176:179], v[40:43]
    v_mfma_f32_16x16x32_bf16 v[44:47], v[184:187], v[188:191], v[44:47]
    s_nop 1
    v_permlane32_swap_b32 v16, v20
    v_permlane32_swap_b32 v17, v21
    v_permlane32_swap_b32 v18, v22
    v_permlane32_swap_b32 v19, v23
    v_permlane32_swap_b32 v24, v28
    v_permlane32_swap_b32 v25, v29
    v_permlane32_swap_b32 v26, v30
    v_permlane32_swap_b32 v27, v31
    v_permlane32_swap_b32 v32, v36
    v_permlane32_swap_b32 v33, v37
    v_permlane32_swap_b32 v34, v38
    v_permlane32_swap_b32 v35, v39
    v_permlane32_swap_b32 v40, v44
    v_permlane32_swap_b32 v41, v45
    v_permlane32_swap_b32 v42, v46
    v_permlane32_swap_b32 v43, v47
    s_waitcnt vmcnt(0) lgkmcnt(0)
    v_lshlrev_b32 v96, 16, v48
    v_and_b32 v97, 0xffff0000, v48
    v_pk_fma_f32 v[16:17], v[16:17], v[64:65], v[96:97]
    v_cvt_pk_bf16_f32 v48, v16, v17
    v_lshlrev_b32 v98, 16, v49
    v_and_b32 v99, 0xffff0000, v49
    v_pk_fma_f32 v[18:19], v[18:19], v[66:67], v[98:99]
    v_cvt_pk_bf16_f32 v49, v18, v19
    v_lshlrev_b32 v96, 16, v50
    v_and_b32 v97, 0xffff0000, v50
    v_pk_fma_f32 v[20:21], v[20:21], v[68:69], v[96:97]
    v_cvt_pk_bf16_f32 v50, v20, v21
    v_lshlrev_b32 v98, 16, v51
    v_and_b32 v99, 0xffff0000, v51
    v_pk_fma_f32 v[22:23], v[22:23], v[70:71], v[98:99]
    v_cvt_pk_bf16_f32 v51, v22, v23
    buffer_store_dwordx4 v[48:51], v12, s[24:27], s14 offen offset:0
    v_lshlrev_b32 v96, 16, v52
    v_and_b32 v97, 0xffff0000, v52
    v_pk_fma_f32 v[24:25], v[24:25], v[72:73], v[96:97]
    v_cvt_pk_bf16_f32 v52, v24, v25
    v_lshlrev_b32 v98, 16, v53
    v_and_b32 v99, 0xffff0000, v53
    v_pk_fma_f32 v[26:27], v[26:27], v[74:75], v[98:99]
    v_cvt_pk_bf16_f32 v53, v26, v27
    v_lshlrev_b32 v96, 16, v54
    v_and_b32 v97, 0xffff0000, v54
    v_pk_fma_f32 v[28:29], v[28:29], v[76:77], v[96:97]
    v_cvt_pk_bf16_f32 v54, v28, v29
    v_lshlrev_b32 v98, 16, v55
    v_and_b32 v99, 0xffff0000, v55
    v_pk_fma_f32 v[30:31], v[30:31], v[78:79], v[98:99]
    v_cvt_pk_bf16_f32 v55, v30, v31
    buffer_store_dwordx4 v[52:55], v12, s[24:27], s14 offen offset:32
    v_lshlrev_b32 v96, 16, v56
    v_and_b32 v97, 0xffff0000, v56
    v_pk_fma_f32 v[32:33], v[32:33], v[80:81], v[96:97]
    v_cvt_pk_bf16_f32 v56, v32, v33
    v_lshlrev_b32 v98, 16, v57
    v_and_b32 v99, 0xffff0000, v57
    v_pk_fma_f32 v[34:35], v[34:35], v[82:83], v[98:99]
    v_cvt_pk_bf16_f32 v57, v34, v35
    v_lshlrev_b32 v96, 16, v58
    v_and_b32 v97, 0xffff0000, v58
    v_pk_fma_f32 v[36:37], v[36:37], v[84:85], v[96:97]
    v_cvt_pk_bf16_f32 v58, v36, v37
    v_lshlrev_b32 v98, 16, v59
    v_and_b32 v99, 0xffff0000, v59
    v_pk_fma_f32 v[38:39], v[38:39], v[86:87], v[98:99]
    v_cvt_pk_bf16_f32 v59, v38, v39
    buffer_store_dwordx4 v[56:59], v12, s[24:27], s14 offen offset:64
    v_lshlrev_b32 v96, 16, v60
    v_and_b32 v97, 0xffff0000, v60
    v_pk_fma_f32 v[40:41], v[40:41], v[88:89], v[96:97]
    v_cvt_pk_bf16_f32 v60, v40, v41
    v_lshlrev_b32 v98, 16, v61
    v_and_b32 v99, 0xffff0000, v61
    v_pk_fma_f32 v[42:43], v[42:43], v[90:91], v[98:99]
    v_cvt_pk_bf16_f32 v61, v42, v43
    v_lshlrev_b32 v96, 16, v62
    v_and_b32 v97, 0xffff0000, v62
    v_pk_fma_f32 v[44:45], v[44:45], v[92:93], v[96:97]
    v_cvt_pk_bf16_f32 v62, v44, v45
    v_lshlrev_b32 v98, 16, v63
    v_and_b32 v99, 0xffff0000, v63
    v_pk_fma_f32 v[46:47], v[46:47], v[94:95], v[98:99]
    v_cvt_pk_bf16_f32 v63, v46, v47
    buffer_store_dwordx4 v[60:63], v12, s[24:27], s14 offen offset:96
L_k6_kernel_end:
L_k6_kernel_exit:
    s_endpgm

L_code_end:
s_endpgm
.section .rodata,"a"
.p2align 6
.amdhsa_kernel k1_kernel
  .amdhsa_next_free_vgpr 192
  .amdhsa_next_free_sgpr 80
  .amdhsa_accum_offset 192
  .amdhsa_group_segment_fixed_size 0
  .amdhsa_kernarg_size 112
  .amdhsa_user_sgpr_count 2
  .amdhsa_user_sgpr_kernarg_segment_ptr 1
  .amdhsa_system_sgpr_workgroup_id_x 1
.end_amdhsa_kernel
.p2align 6
.amdhsa_kernel k3_kernel
  .amdhsa_next_free_vgpr 256
  .amdhsa_next_free_sgpr 80
  .amdhsa_accum_offset 256
  .amdhsa_group_segment_fixed_size 0
  .amdhsa_kernarg_size 112
  .amdhsa_user_sgpr_count 2
  .amdhsa_user_sgpr_kernarg_segment_ptr 1
  .amdhsa_system_sgpr_workgroup_id_x 1
.end_amdhsa_kernel
.p2align 6
.amdhsa_kernel k4_kernel
  .amdhsa_next_free_vgpr 208
  .amdhsa_next_free_sgpr 64
  .amdhsa_accum_offset 208
  .amdhsa_group_segment_fixed_size 0
  .amdhsa_kernarg_size 112
  .amdhsa_user_sgpr_count 2
  .amdhsa_user_sgpr_kernarg_segment_ptr 1
  .amdhsa_system_sgpr_workgroup_id_x 1
.end_amdhsa_kernel
.p2align 6
.amdhsa_kernel k5_kernel
  .amdhsa_next_free_vgpr 432
  .amdhsa_next_free_sgpr 64
  .amdhsa_accum_offset 256
  .amdhsa_group_segment_fixed_size 0
  .amdhsa_kernarg_size 112
  .amdhsa_user_sgpr_count 2
  .amdhsa_user_sgpr_kernarg_segment_ptr 1
  .amdhsa_system_sgpr_workgroup_id_x 1
.end_amdhsa_kernel
.p2align 6
.amdhsa_kernel k6_kernel
  .amdhsa_next_free_vgpr 208
  .amdhsa_next_free_sgpr 64
  .amdhsa_accum_offset 208
  .amdhsa_group_segment_fixed_size 0
  .amdhsa_kernarg_size 112
  .amdhsa_user_sgpr_count 2
  .amdhsa_user_sgpr_kernarg_segment_ptr 1
  .amdhsa_system_sgpr_workgroup_id_x 1
.end_amdhsa_kernel
```
